```python
import torch

def _softmax(x, axis=-1):
    return torch.softmax(x, dim=axis)
def _gelu(x):
    return torch.nn.functional.gelu(x, approximate="tanh")
def _silu(x):
    return torch.nn.functional.silu(x)
def _sigmoid(x):
    return torch.sigmoid(x)
def _layernorm(x, axis=-1, eps=1e-5):
    m = x.mean(dim=axis, keepdim=True)
    v = x.var(dim=axis, keepdim=True, unbiased=False)
    return (x - m) / torch.sqrt(v + eps)
def _scatter_add(tgt, idx, src, axis=0):
    return tgt.clone().index_add_(axis, idx, src)
def _segment_sum(src, seg, n):
    out = torch.zeros((n,) + src.shape[1:], dtype=src.dtype)
    return out.index_add_(0, seg, src)
def _pad(x, pw):
    flat = tuple(v for pair in reversed(pw) for v in pair)
    return torch.nn.functional.pad(x, flat)

kernel_name = 'recurrent_scan__sliding_local_dilated__glu_gated_geglu__prompt'

def setup_inputs():

    _w = (lambda a: (lambda t: t.to(torch.bfloat16) if t.is_floating_point() else t)(torch.as_tensor(a)))
    def _A_setup():
        B, S, D = 1, 2048, 512
        return {
            "x": _w((lambda *s: torch.randn(*s, dtype=torch.bfloat16) * 0.05)(B, S, D)),
            "wqkv": _w((lambda *s: torch.randn(*s, dtype=torch.bfloat16) * 0.2)(D, 3 * D)),
            "wo": _w((lambda *s: torch.randn(*s, dtype=torch.bfloat16) * 0.2)(D, D)),
        }
    _A_in = _A_setup()

    def _B_setup():
        B, S, Dm, Df = 1, 2048, 512, 1792
        return {
            "x": _w((lambda *s: torch.randn(*s, dtype=torch.bfloat16) * 0.05)(B, S, Dm)),
            "w_gate": _w((lambda *s: torch.randn(*s, dtype=torch.bfloat16) * 0.1)(Dm, Df) * (Dm ** -0.5)),
            "w_up": _w((lambda *s: torch.randn(*s, dtype=torch.bfloat16) * 0.1)(Dm, Df) * (Dm ** -0.5)),
            "w_down": _w((lambda *s: torch.randn(*s, dtype=torch.bfloat16) * 0.1)(Df, Dm) * (Df ** -0.5)),
        }
    _B_in = _B_setup()

    return {
        "A_x": _A_in["x"],
        "A_wqkv": _A_in["wqkv"],
        "A_wo": _A_in["wo"],
        "B_x": _B_in["x"],
        "B_w_gate": _B_in["w_gate"],
        "B_w_up": _B_in["w_up"],
        "B_w_down": _B_in["w_down"],
    }

def reference(A_x, A_wqkv, A_wo, B_x, B_w_gate, B_w_up, B_w_down):
    def _A_ref(x, wqkv, wo):
        B, S, D = x.shape
        H = 32; Dh = D // H
        W, dil = 8, 2
        qkv = (lambda x, *d: x.permute(*d))((x @ wqkv).reshape(B, S, 3, H, Dh), 2, 0, 3, 1, 4)
        q, k, v = qkv[0], qkv[1], qkv[2]
        scale = Dh ** -0.5
        pos = torch.arange(S)
        off = torch.arange(W) * dil
        idx = pos[:, None] - off[None, :]
        mask = idx >= 0
        idx_c = torch.where(mask, idx, 0).reshape(-1)
        kg = k[:, :, idx_c, :].reshape(B, H, S, W, Dh)
        vg = v[:, :, idx_c, :].reshape(B, H, S, W, Dh)
        logits = torch.einsum("bhsd,bhswd->bhsw", q, kg) * scale
        logits = torch.where(mask[None, None, :, :], logits, -1e9)
        attn = _softmax(logits, axis=-1)
        o = torch.einsum("bhsw,bhswd->bhsd", attn, vg)
        return (lambda x, *d: x.permute(*d))(o, 0, 2, 1, 3).reshape(B, S, D) @ wo

    def _B_ref(x, w_gate, w_up, w_down):
        g = torch.einsum("bsd,df->bsf", x, w_gate)
        u = torch.einsum("bsd,df->bsf", x, w_up)
        h = _gelu(g) * u
        return torch.einsum("bsf,fd->bsd", h, w_down)

    x = A_x
    xn = _layernorm(x, axis=-1)
    s = _A_ref(xn, A_wqkv, A_wo)
    g = _silu(_B_ref(xn, B_w_gate, B_w_up, B_w_down))
    return x + s * g
```

```asm
; @launch grid=(256,1,1) block=(256,1,1) lds=163840
.amdgcn_target "amdgcn-amd-amdhsa--gfx950"
.text
.globl recurrent_scan__sliding_local_dilated__glu_gated_geglu__prompt_kernel
.p2align 8
.type recurrent_scan__sliding_local_dilated__glu_gated_geglu__prompt_kernel,@function
recurrent_scan__sliding_local_dilated__glu_gated_geglu__prompt_kernel:
    s_cmp_ge_u32 s2, 0x100
    s_cbranch_scc1 L_end
    s_load_dwordx16 s[4:19], s[0:1], 0
    s_load_dwordx4 s[20:23], s[0:1], 64
    s_getpc_b64 s[68:69]
L_pc:
    v_lshrrev_b32_e32 v20, 6, v0
    v_and_b32_e32 v0, 63, v0
    v_readfirstlane_b32 s56, v20
    s_lshr_b32 s71, s2, 3
    s_lshl_b32 s70, s71, 2
    s_add_u32 s70, s70, s56
    s_lshl_b32 s70, s70, 3
    v_add_u32_e32 v20, s70, v0
    v_min_u32_e32 v20, (L_codeend-L_pc)/128, v20
    v_lshlrev_b32_e64 v20, 7, v20
    s_mov_b64 exec, 0xff
    global_load_dword v21, v20, s[68:69]
    s_mov_b64 exec, -1
    s_and_b32 s68, s2, 7
    s_lshr_b32 s59, s68, 2
    s_lshl_b32 s59, s59, 3
    s_and_b32 s70, s71, 7
    s_add_u32 s59, s59, s70
    s_and_b32 s57, s56, 1
    s_lshr_b32 s58, s56, 1
    s_lshl_b32 s62, s59, 1
    s_add_u32 s62, s62, s58
    v_lshrrev_b32_e32 v192, 3, v0
    v_lshlrev_b32_e32 v192, 11, v192
    v_and_b32_e32 v193, 7, v0
    v_lshrrev_b32_e32 v194, 4, v0
    v_xor_b32_e64 v193, v193, v194
    v_lshl_add_u32 v196, v193, 4, v192
    v_xor_b32_e64 v197, 64, v196
    v_add_u32_e32 v198, 0x7800, v196
    v_add_u32_e32 v199, 0xb400, v197
    v_add_u32_e32 v197, 0x3c00, v197
    s_lshl_b32 s73, s62, 6
    s_add_u32 s73, s73, s57
    s_lshl_b32 s73, s73, 10
    s_lshl_b32 s72, s56, 15
    s_add_u32 s72, s72, 0x8000
    v_lshlrev_b32_e64 v1, 4, v0
    s_waitcnt lgkmcnt(0)
    s_mov_b32 s24, s4
    s_and_b32 s25, s5, 0xffff
    s_mov_b32 s26, 0x200000
    s_mov_b32 s27, 0x20000
    s_add_u32 m0, s72, 0x0
    s_add_u32 s81, s73, 0
    buffer_load_dwordx4 v196, s[24:27], s81 offen offset:0 lds
    s_lshl_b32 s74, s56, 12
    s_and_b32 s60, s68, 3
    s_lshl_b32 s60, s60, 2
    s_lshr_b32 s70, s71, 3
    s_add_u32 s60, s60, s70
    s_and_b32 s61, s60, 1
    s_xor_b32 s61, s61, 1
    s_lshr_b32 s60, s60, 1
    s_lshr_b32 s64, s68, 1
    s_lshl_b32 s64, s64, 3
    s_and_b32 s70, s71, 7
    buffer_load_dwordx4 v197, s[24:27], s81 offen offset:1024 lds
    s_add_u32 s64, s64, s70
    s_and_b32 s65, s68, 1
    s_lshl_b32 s65, s65, 2
    s_lshr_b32 s70, s71, 3
    s_add_u32 s65, s65, s70
    s_mov_b32 s66, s58
    s_lshl_b32 s63, s62, 1
    s_add_u32 s63, s63, s57
    s_cmp_eq_u32 s58, 0
    s_cselect_b32 s28, s12, s14
    s_cselect_b32 s29, s13, s15
    s_and_b32 s29, s29, 0xffff
    s_mov_b32 s30, 0x1c0000
    buffer_load_dwordx4 v198, s[24:27], s81 offen offset:2048 lds
    s_mov_b32 s31, 0x20000
    v_lshrrev_b32_e32 v200, 2, v0
    v_and_b32_e32 v201, 3, v0
    s_lshl_b32 s70, s58, 1
    v_xor_b32_e32 v202, s70, v201
    v_lshlrev_b32_e64 v202, 4, v202
    v_mul_u32_u24_e32 v10, 0xe00, v200
    v_add_u32_e64 v10, v10, v202
    v_add_u32_e32 v11, 0xdc00, v10
    v_add_u32_e32 v12, 0x1b800, v10
    v_add_u32_e32 v13, 0x29400, v10
    buffer_load_dwordx4 v199, s[24:27], s81 offen offset:3072 lds
    v_lshlrev_b32_e64 v202, 4, v201
    v_mul_u32_u24_e32 v14, 0xc00, v200
    v_add_u32_e64 v14, v14, v202
    v_add_u32_e32 v15, 0xbc00, v14
    v_add_u32_e32 v16, 0x17800, v14
    v_add_u32_e32 v17, 0x23400, v14
    s_mul_i32 s75, s57, 229376
    s_mul_i32 s68, s60, 320
    s_lshl_b32 s69, s60, 7
    s_add_u32 s69, s69, 2560
    s_cmp_eq_u32 s61, 1
    s_cselect_b32 s68, s69, s68
    s_add_u32 m0, s72, 0x1000
    s_add_u32 s81, s73, 128
    buffer_load_dwordx4 v196, s[24:27], s81 offen offset:0 lds
    s_add_u32 s75, s75, s68
    s_mul_i32 s76, s57, 196608
    s_lshl_b32 s68, s60, 7
    s_lshl_b32 s69, s58, 6
    s_add_u32 s76, s76, s68
    s_add_u32 s76, s76, s69
    s_mov_b32 s32, s6
    s_and_b32 s33, s7, 0xffff
    s_mov_b32 s34, 0x180000
    s_mov_b32 s35, 0x20000
    s_mov_b32 s36, s16
    buffer_load_dwordx4 v197, s[24:27], s81 offen offset:1024 lds
    s_and_b32 s37, s17, 0xffff
    s_mov_b32 s38, 0x1c0000
    s_mov_b32 s39, 0x20000
    s_mov_b32 s40, s8
    s_and_b32 s41, s9, 0xffff
    s_mov_b32 s42, 0x80000
    s_mov_b32 s43, 0x20000
    s_mov_b32 s44, s22
    s_and_b32 s45, s23, 0xffff
    s_mov_b32 s46, 0x1200000
    s_mov_b32 s47, 0x20000
    buffer_load_dwordx4 v198, s[24:27], s81 offen offset:2048 lds
    s_mov_b32 s48, s18
    s_and_b32 s49, s19, 0xffff
    s_mov_b32 s50, 0x200000
    s_mov_b32 s51, 0x20000
    s_mov_b32 s52, s20
    s_and_b32 s53, s21, 0xffff
    s_mov_b32 s54, 0x100
    s_mov_b32 s55, 0x20000
    v_mov_b32_e32 v254, 0
    v_cmp_eq_u32 vcc, 0, v0
    v_mov_b32_e32 v18, 0x7ffffff0
    s_mov_b32 s78, 0x3f803f80
    v_cndmask_b32 v18, v18, v254, vcc
    s_mov_b32 s79, 0x00003f80
    buffer_load_dwordx4 v199, s[24:27], s81 offen offset:3072 lds
    s_mov_b32 s80, 0x3f800000
    v_bfe_u32 v204, v0, 4, 1
    v_lshrrev_b32_e64 v205, 5, v0
    v_bfe_u32 v206, v0, 2, 2
    v_and_b32_e64 v207, 3, v0
    v_lshl_add_u32 v195, v205, 2, v206
    v_lshlrev_b32_e64 v195, 6, v195
    v_lshl_add_u32 v195, v207, 3, v195
    v_lshl_add_u32 v8, v204, 5, v195
    v_lshl_add_u32 v6, v204, 13, v8
    v_xor_b32_e64 v7, 32, v6
    s_add_u32 m0, s72, 0x2000
    s_add_u32 s81, s73, 256
    buffer_load_dwordx4 v196, s[24:27], s81 offen offset:0 lds
    s_mul_i32 s77, s63, 0x1c000
    s_mul_i32 s68, s60, 10240
    s_lshl_b32 s69, s60, 12
    s_add_u32 s69, s69, 81920
    s_cmp_eq_u32 s61, 1
    s_cselect_b32 s68, s69, s68
    s_add_u32 s77, s77, s68
    s_add_u32 s77, s77, 0x800000
    v_and_b32_e64 v212, 31, v0
    v_bfe_u32 v213, v0, 1, 3
    v_xor_b32_e32 v213, v213, v205
    v_lshlrev_b32_e32 v212, 7, v212
    buffer_load_dwordx4 v197, s[24:27], s81 offen offset:1024 lds
    v_add_u32_e32 v212, s72, v212
    v_xor_b32_e32 v208, 0, v213
    v_lshl_add_u32 v208, v208, 4, v212
    v_xor_b32_e64 v209, 2, v213
    v_lshl_add_u32 v209, v209, 4, v212
    v_xor_b32_e64 v210, 4, v213
    v_lshl_add_u32 v210, v210, 4, v212
    v_xor_b32_e64 v211, 6, v213
    v_lshl_add_u32 v211, v211, 4, v212
    v_mov_b32_e32 v216, 0
    v_mov_b32_e32 v217, 0
    buffer_load_dwordx4 v198, s[24:27], s81 offen offset:2048 lds
    v_mov_b32_e32 v218, 0
    v_mov_b32_e32 v219, 0
    v_and_b32_e32 v232, 31, v0
    v_lshrrev_b32_e32 v233, 5, v0
    v_lshlrev_b32_e32 v233, 3, v233
    v_sub_u32_e32 v232, v232, v233
    v_mov_b32_e32 v244, 0
    v_cmp_eq_u32 vcc, 0, v232
    v_mov_b32_e32 v233, 0x3f80
    s_nop 0
    v_cndmask_b32 v244, v244, v233, vcc
    v_cmp_eq_u32 vcc, 1, v232
    v_mov_b32_e32 v233, 0x3f800000
    s_nop 0
    v_cndmask_b32 v244, v244, v233, vcc
    v_mov_b32_e32 v245, 0
    v_cmp_eq_u32 vcc, 2, v232
    v_mov_b32_e32 v233, 0x3f80
    s_nop 0
    v_cndmask_b32 v245, v245, v233, vcc
    v_cmp_eq_u32 vcc, 3, v232
    v_mov_b32_e32 v233, 0x3f800000
    s_nop 0
    v_cndmask_b32 v245, v245, v233, vcc
    v_mov_b32_e32 v246, 0
    v_cmp_eq_u32 vcc, 4, v232
    v_mov_b32_e32 v233, 0x3f80
    s_nop 0
    v_cndmask_b32 v246, v246, v233, vcc
    v_cmp_eq_u32 vcc, 5, v232
    v_mov_b32_e32 v233, 0x3f800000
    s_nop 0
    v_cndmask_b32 v246, v246, v233, vcc
    v_mov_b32_e32 v247, 0
    v_cmp_eq_u32 vcc, 6, v232
    v_mov_b32_e32 v233, 0x3f80
    s_nop 0
    v_cndmask_b32 v247, v247, v233, vcc
    v_cmp_eq_u32 vcc, 7, v232
    v_mov_b32_e32 v233, 0x3f800000
    s_nop 0
    v_cndmask_b32 v247, v247, v233, vcc
    v_mov_b32_e32 v248, 0
    v_cmp_eq_u32 vcc, 16, v232
    v_mov_b32_e32 v233, 0x3f80
    s_nop 0
    v_cndmask_b32 v248, v248, v233, vcc
    v_cmp_eq_u32 vcc, 17, v232
    v_mov_b32_e32 v233, 0x3f800000
    s_nop 0
    v_cndmask_b32 v248, v248, v233, vcc
    buffer_load_dwordx4 v199, s[24:27], s81 offen offset:3072 lds
    v_mov_b32_e32 v249, 0
    v_cmp_eq_u32 vcc, 18, v232
    v_mov_b32_e32 v233, 0x3f80
    s_nop 0
    v_cndmask_b32 v249, v249, v233, vcc
    v_cmp_eq_u32 vcc, 19, v232
    v_mov_b32_e32 v233, 0x3f800000
    s_nop 0
    v_cndmask_b32 v249, v249, v233, vcc
    v_mov_b32_e32 v250, 0
    v_cmp_eq_u32 vcc, 20, v232
    v_mov_b32_e32 v233, 0x3f80
    s_nop 0
    v_cndmask_b32 v250, v250, v233, vcc
    v_cmp_eq_u32 vcc, 21, v232
    v_mov_b32_e32 v233, 0x3f800000
    s_nop 0
    v_cndmask_b32 v250, v250, v233, vcc
    v_mov_b32_e32 v251, 0
    v_cmp_eq_u32 vcc, 22, v232
    v_mov_b32_e32 v233, 0x3f80
    s_nop 0
    v_cndmask_b32 v251, v251, v233, vcc
    v_cmp_eq_u32 vcc, 23, v232
    v_mov_b32_e32 v233, 0x3f800000
    s_nop 0
    v_cndmask_b32 v251, v251, v233, vcc
    s_cmp_eq_u32 s61, 1
    s_cselect_b32 s92, s32, s28
    s_cselect_b32 s93, s33, s29
    s_cselect_b32 s94, s34, s30
    s_cselect_b64 s[68:69], -1, 0
    s_mov_b32 s95, 0x20000
    s_nop 0
    v_cndmask_b32 v224, v10, v14, s[68:69]
    v_cndmask_b32 v225, v11, v15, s[68:69]
    v_cndmask_b32 v226, v12, v16, s[68:69]
    v_cndmask_b32 v227, v13, v17, s[68:69]
    s_add_u32 s68, s76, 1024
    s_cmp_eq_u32 s61, 1
    s_cselect_b32 s99, s68, s75
    s_mov_b32 s100, 0x60000
    s_mov_b32 s69, 0x70000
    s_cselect_b32 s100, s100, s69
    s_movk_i32 s101, 1024
    s_cselect_b32 s101, s101, 64
    s_and_b32 s17, s2, 3
    s_mul_i32 s18, s17, 640
    s_mul_i32 s19, s17, 256
    s_add_u32 s19, s19, 2560
    s_add_u32 m0, s72, 0x3000
    s_add_u32 s81, s73, 384
    buffer_load_dwordx4 v196, s[24:27], s81 offen offset:0 lds
    v_lshrrev_b32_e64 v241, 3, v0
    v_mov_b32_e32 v228, 0x7ffffff0
    s_add_u32 s17, s18, 384
    v_cmp_eq_u32 vcc, 0, v241
    v_mov_b32_e32 v242, s17
    s_nop 0
    v_cndmask_b32 v228, v228, v242, vcc
    v_and_b32_e64 v241, 7, v0
    v_mul_u32_u24_e32 v241, 0xe00, v241
    v_add_u32_e32 v228, v228, v241
    s_and_b32 s17, s2, 3
    s_mul_i32 s18, s17, 256
    s_add_u32 s18, s18, 2048
    v_lshrrev_b32_e32 v241, 2, v0
    v_lshlrev_b32_e32 v229, 7, v241
    buffer_load_dwordx4 v197, s[24:27], s81 offen offset:1024 lds
    v_add_u32_e32 v229, s18, v229
    v_cmp_gt_u32 vcc, 2, v241
    v_mov_b32_e32 v242, 0x7ffffff0
    s_nop 0
    v_cndmask_b32 v229, v242, v229, vcc
    v_and_b32_e64 v241, 3, v0
    v_mul_u32_u24_e32 v241, 0xc00, v241
    v_add_u32_e32 v229, v229, v241
    s_and_b32 s17, s2, 3
    s_mul_i32 s18, s17, 640
    s_mul_i32 s19, s17, 256
    s_add_u32 s19, s19, 2560
    v_lshrrev_b32_e64 v241, 3, v0
    v_mov_b32_e32 v230, 0x7ffffff0
    buffer_load_dwordx4 v198, s[24:27], s81 offen offset:2048 lds
    s_add_u32 s17, s18, 128
    v_cmp_eq_u32 vcc, 0, v241
    v_mov_b32_e32 v242, s17
    s_nop 0
    v_cndmask_b32 v230, v230, v242, vcc
    s_add_u32 s17, s19, 0
    v_cmp_eq_u32 vcc, 1, v241
    v_mov_b32_e64 v242, s17
    s_nop 0
    v_cndmask_b32 v230, v230, v242, vcc
    s_add_u32 s17, s19, 128
    v_cmp_eq_u32 vcc, 2, v241
    v_mov_b32_e32 v242, s17
    s_nop 0
    v_cndmask_b32 v230, v230, v242, vcc
    v_and_b32_e64 v241, 7, v0
    v_mul_u32_u24_e32 v241, 0xe00, v241
    v_add_u32_e32 v230, v230, v241
    s_and_b32 s17, s2, 3
    s_mul_i32 s18, s17, 640
    s_mul_i32 s19, s17, 256
    s_add_u32 s19, s19, 2560
    v_lshrrev_b32_e64 v241, 3, v0
    buffer_load_dwordx4 v199, s[24:27], s81 offen offset:3072 lds
    v_mov_b32_e32 v231, 0x7ffffff0
    s_add_u32 s17, s18, 512
    v_cmp_eq_u32 vcc, 0, v241
    v_mov_b32_e32 v242, s17
    s_nop 0
    v_cndmask_b32 v231, v231, v242, vcc
    v_and_b32_e64 v241, 7, v0
    v_mul_u32_u24_e32 v241, 0xe00, v241
    v_add_u32_e32 v231, v231, v241
    s_and_b32 s17, s2, 3
    s_mul_i32 s18, s17, 256
    s_add_u32 s18, s18, 0
    v_lshrrev_b32_e32 v241, 2, v0
    v_lshlrev_b32_e64 v232, 7, v241
    v_add_u32_e32 v232, s18, v232
    s_add_u32 m0, s72, 0x4000
    s_add_u32 s81, s73, 512
    buffer_load_dwordx4 v196, s[24:27], s81 offen offset:0 lds
    v_cmp_gt_u32 vcc, 2, v241
    v_mov_b32_e32 v242, 0x7ffffff0
    s_nop 0
    v_cndmask_b32 v232, v242, v232, vcc
    v_and_b32_e64 v241, 3, v0
    v_mul_u32_u24_e32 v241, 0xc00, v241
    v_add_u32_e32 v232, v232, v241
    s_and_b32 s17, s2, 3
    s_mul_i32 s18, s17, 640
    s_mul_i32 s19, s17, 256
    s_add_u32 s19, s19, 2560
    v_lshrrev_b32_e64 v241, 3, v0
    v_mov_b32_e32 v233, 0x7ffffff0
    s_add_u32 s17, s18, 0
    v_cmp_eq_u32 vcc, 0, v241
    v_mov_b32_e64 v242, s17
    s_nop 0
    v_cndmask_b32 v233, v233, v242, vcc
    buffer_load_dwordx4 v197, s[24:27], s81 offen offset:1024 lds
    s_add_u32 s17, s18, 256
    v_cmp_eq_u32 vcc, 1, v241
    v_mov_b32_e32 v242, s17
    s_nop 0
    v_cndmask_b32 v233, v233, v242, vcc
    v_and_b32_e64 v241, 7, v0
    v_mul_u32_u24_e32 v241, 0xe00, v241
    v_add_u32_e32 v233, v233, v241
    s_and_b32 s17, s2, 3
    s_mul_i32 s18, s17, 256
    s_add_u32 s18, s18, 1024
    v_lshrrev_b32_e32 v241, 2, v0
    v_lshlrev_b32_e32 v234, 7, v241
    v_add_u32_e32 v234, s18, v234
    v_cmp_gt_u32 vcc, 2, v241
    v_mov_b32_e32 v242, 0x7ffffff0
    s_nop 0
    v_cndmask_b32 v234, v242, v234, vcc
    buffer_load_dwordx4 v198, s[24:27], s81 offen offset:2048 lds
    v_and_b32_e64 v241, 3, v0
    v_mul_u32_u24_e32 v241, 0xc00, v241
    v_add_u32_e32 v234, v234, v241
    s_lshr_b32 s17, s2, 3
    s_lshl_b32 s20, s17, 1
    s_add_u32 s20, s20, s57
    s_mul_i32 s20, s20, 28672
    s_lshl_b32 s21, s17, 2
    s_add_u32 s21, s21, s56
    s_mul_i32 s21, s21, 12288
    buffer_load_dwordx4 v199, s[24:27], s81 offen offset:3072 lds
    s_or_b32 s68, s2, s56
    s_cmp_lg_u32 s68, 0
    s_cbranch_scc1 L_nonce_done
    s_load_dword s68, s[22:23], 0
    s_waitcnt lgkmcnt(0)
    s_mul_i32 s68, s68, 0x9e3779b1
    s_add_u32 s68, s68, 0x85ebca6b
    s_cmp_eq_u32 s68, 0
    s_cselect_b32 s68, 0x5bd1e995, s68
    v_mov_b32_e32 v22, s68
    buffer_store_dword v22, v18, s[52:55], 0 offen sc1
    buffer_store_dword v22, v18, s[44:47], 0 offen sc1
L_nonce_done:
    s_waitcnt vmcnt(16)
    ds_read_b128 v[64:67], v208 offset:0
    ds_read_b128 v[68:71], v209 offset:0
    ds_read_b128 v[72:75], v210 offset:0
    ds_read_b128 v[76:79], v211 offset:0
    s_add_u32 m0, s72, 0x5000
    s_add_u32 s81, s73, 640
    buffer_load_dwordx4 v196, s[24:27], s81 offen offset:0 lds
    buffer_load_dwordx4 v197, s[24:27], s81 offen offset:1024 lds
    buffer_load_dwordx4 v198, s[24:27], s81 offen offset:2048 lds
    buffer_load_dwordx4 v199, s[24:27], s81 offen offset:3072 lds
    s_waitcnt vmcnt(16)
    ds_read_b128 v[80:83], v208 offset:4096
    ds_read_b128 v[84:87], v209 offset:4096
    ds_read_b128 v[88:91], v210 offset:4096
    ds_read_b128 v[92:95], v211 offset:4096
    s_add_u32 m0, s72, 0x6000
    s_add_u32 s81, s73, 768
    buffer_load_dwordx4 v196, s[24:27], s81 offen offset:0 lds
    buffer_load_dwordx4 v197, s[24:27], s81 offen offset:1024 lds
    buffer_load_dwordx4 v198, s[24:27], s81 offen offset:2048 lds
    buffer_load_dwordx4 v199, s[24:27], s81 offen offset:3072 lds
    s_waitcnt lgkmcnt(4)
    v_dot2c_f32_bf16 v216, s78, v64
    v_dot2c_f32_bf16 v218, v64, v64
    v_dot2c_f32_bf16 v217, s78, v65
    v_dot2c_f32_bf16 v219, v65, v65
    v_dot2c_f32_bf16 v216, s78, v66
    v_dot2c_f32_bf16 v218, v66, v66
    v_dot2c_f32_bf16 v217, s78, v67
    v_dot2c_f32_bf16 v219, v67, v67
    v_dot2c_f32_bf16 v216, s78, v68
    v_dot2c_f32_bf16 v218, v68, v68
    v_dot2c_f32_bf16 v217, s78, v69
    v_dot2c_f32_bf16 v219, v69, v69
    v_dot2c_f32_bf16 v216, s78, v70
    v_dot2c_f32_bf16 v218, v70, v70
    v_dot2c_f32_bf16 v217, s78, v71
    v_dot2c_f32_bf16 v219, v71, v71
    v_dot2c_f32_bf16 v216, s78, v72
    v_dot2c_f32_bf16 v218, v72, v72
    v_dot2c_f32_bf16 v217, s78, v73
    v_dot2c_f32_bf16 v219, v73, v73
    v_dot2c_f32_bf16 v216, s78, v74
    v_dot2c_f32_bf16 v218, v74, v74
    v_dot2c_f32_bf16 v217, s78, v75
    v_dot2c_f32_bf16 v219, v75, v75
    v_dot2c_f32_bf16 v216, s78, v76
    v_dot2c_f32_bf16 v218, v76, v76
    v_dot2c_f32_bf16 v217, s78, v77
    v_dot2c_f32_bf16 v219, v77, v77
    v_dot2c_f32_bf16 v216, s78, v78
    v_dot2c_f32_bf16 v218, v78, v78
    v_dot2c_f32_bf16 v217, s78, v79
    v_dot2c_f32_bf16 v219, v79, v79
    s_waitcnt vmcnt(16)
    ds_read_b128 v[96:99], v208 offset:8192
    ds_read_b128 v[100:103], v209 offset:8192
    ds_read_b128 v[104:107], v210 offset:8192
    ds_read_b128 v[108:111], v211 offset:8192
    s_add_u32 m0, s72, 0x7000
    s_add_u32 s81, s73, 896
    buffer_load_dwordx4 v196, s[24:27], s81 offen offset:0 lds
    buffer_load_dwordx4 v197, s[24:27], s81 offen offset:1024 lds
    buffer_load_dwordx4 v198, s[24:27], s81 offen offset:2048 lds
    buffer_load_dwordx4 v199, s[24:27], s81 offen offset:3072 lds
    buffer_load_dword v238, v233, s[28:31], s20 offen
    buffer_load_dword v238, v234, s[32:35], s21 offen
    s_waitcnt lgkmcnt(4)
    v_dot2c_f32_bf16 v216, s78, v80
    v_dot2c_f32_bf16 v218, v80, v80
    v_dot2c_f32_bf16 v217, s78, v81
    v_dot2c_f32_bf16 v219, v81, v81
    v_dot2c_f32_bf16 v216, s78, v82
    v_dot2c_f32_bf16 v218, v82, v82
    v_dot2c_f32_bf16 v217, s78, v83
    v_dot2c_f32_bf16 v219, v83, v83
    v_dot2c_f32_bf16 v216, s78, v84
    v_dot2c_f32_bf16 v218, v84, v84
    v_dot2c_f32_bf16 v217, s78, v85
    v_dot2c_f32_bf16 v219, v85, v85
    v_dot2c_f32_bf16 v216, s78, v86
    v_dot2c_f32_bf16 v218, v86, v86
    v_dot2c_f32_bf16 v217, s78, v87
    v_dot2c_f32_bf16 v219, v87, v87
    v_dot2c_f32_bf16 v216, s78, v88
    v_dot2c_f32_bf16 v218, v88, v88
    v_dot2c_f32_bf16 v217, s78, v89
    v_dot2c_f32_bf16 v219, v89, v89
    v_dot2c_f32_bf16 v216, s78, v90
    v_dot2c_f32_bf16 v218, v90, v90
    v_dot2c_f32_bf16 v217, s78, v91
    v_dot2c_f32_bf16 v219, v91, v91
    v_dot2c_f32_bf16 v216, s78, v92
    v_dot2c_f32_bf16 v218, v92, v92
    v_dot2c_f32_bf16 v217, s78, v93
    v_dot2c_f32_bf16 v219, v93, v93
    v_dot2c_f32_bf16 v216, s78, v94
    v_dot2c_f32_bf16 v218, v94, v94
    v_dot2c_f32_bf16 v217, s78, v95
    v_dot2c_f32_bf16 v219, v95, v95
    s_waitcnt vmcnt(18)
    ds_read_b128 v[112:115], v208 offset:12288
    ds_read_b128 v[116:119], v209 offset:12288
    ds_read_b128 v[120:123], v210 offset:12288
    ds_read_b128 v[124:127], v211 offset:12288
    s_add_u32 m0, s74, 0x0
    s_mov_b32 s3, s99
    buffer_load_dwordx4 v224, s[92:95], s3 offen offset:0 lds
    buffer_load_dwordx4 v225, s[92:95], s3 offen offset:1024 lds
    buffer_load_dwordx4 v226, s[92:95], s3 offen offset:2048 lds
    buffer_load_dwordx4 v227, s[92:95], s3 offen offset:3072 lds
    s_waitcnt lgkmcnt(4)
    v_dot2c_f32_bf16 v216, s78, v96
    v_dot2c_f32_bf16 v218, v96, v96
    v_dot2c_f32_bf16 v217, s78, v97
    v_dot2c_f32_bf16 v219, v97, v97
    v_dot2c_f32_bf16 v216, s78, v98
    v_dot2c_f32_bf16 v218, v98, v98
    v_dot2c_f32_bf16 v217, s78, v99
    v_dot2c_f32_bf16 v219, v99, v99
    v_dot2c_f32_bf16 v216, s78, v100
    v_dot2c_f32_bf16 v218, v100, v100
    v_dot2c_f32_bf16 v217, s78, v101
    v_dot2c_f32_bf16 v219, v101, v101
    v_dot2c_f32_bf16 v216, s78, v102
    v_dot2c_f32_bf16 v218, v102, v102
    v_dot2c_f32_bf16 v217, s78, v103
    v_dot2c_f32_bf16 v219, v103, v103
    v_dot2c_f32_bf16 v216, s78, v104
    v_dot2c_f32_bf16 v218, v104, v104
    v_dot2c_f32_bf16 v217, s78, v105
    v_dot2c_f32_bf16 v219, v105, v105
    v_dot2c_f32_bf16 v216, s78, v106
    v_dot2c_f32_bf16 v218, v106, v106
    v_dot2c_f32_bf16 v217, s78, v107
    v_dot2c_f32_bf16 v219, v107, v107
    v_dot2c_f32_bf16 v216, s78, v108
    v_dot2c_f32_bf16 v218, v108, v108
    v_dot2c_f32_bf16 v217, s78, v109
    v_dot2c_f32_bf16 v219, v109, v109
    v_dot2c_f32_bf16 v216, s78, v110
    v_dot2c_f32_bf16 v218, v110, v110
    v_dot2c_f32_bf16 v217, s78, v111
    v_dot2c_f32_bf16 v219, v111, v111
    s_waitcnt vmcnt(18)
    ds_read_b128 v[128:131], v208 offset:16384
    ds_read_b128 v[132:135], v209 offset:16384
    ds_read_b128 v[136:139], v210 offset:16384
    ds_read_b128 v[140:143], v211 offset:16384
    s_waitcnt lgkmcnt(4)
    s_barrier
    s_add_u32 m0, s74, 0x4000
    s_add_u32 s3, s3, s100
    buffer_load_dwordx4 v224, s[92:95], s3 offen offset:0 lds
    buffer_load_dwordx4 v225, s[92:95], s3 offen offset:1024 lds
    buffer_load_dwordx4 v226, s[92:95], s3 offen offset:2048 lds
    buffer_load_dwordx4 v227, s[92:95], s3 offen offset:3072 lds
    v_dot2c_f32_bf16 v216, s78, v112
    v_dot2c_f32_bf16 v218, v112, v112
    v_dot2c_f32_bf16 v217, s78, v113
    v_dot2c_f32_bf16 v219, v113, v113
    v_dot2c_f32_bf16 v216, s78, v114
    v_dot2c_f32_bf16 v218, v114, v114
    v_dot2c_f32_bf16 v217, s78, v115
    v_dot2c_f32_bf16 v219, v115, v115
    v_dot2c_f32_bf16 v216, s78, v116
    v_dot2c_f32_bf16 v218, v116, v116
    v_dot2c_f32_bf16 v217, s78, v117
    v_dot2c_f32_bf16 v219, v117, v117
    v_dot2c_f32_bf16 v216, s78, v118
    v_dot2c_f32_bf16 v218, v118, v118
    v_dot2c_f32_bf16 v217, s78, v119
    v_dot2c_f32_bf16 v219, v119, v119
    v_dot2c_f32_bf16 v216, s78, v120
    v_dot2c_f32_bf16 v218, v120, v120
    v_dot2c_f32_bf16 v217, s78, v121
    v_dot2c_f32_bf16 v219, v121, v121
    v_dot2c_f32_bf16 v216, s78, v122
    v_dot2c_f32_bf16 v218, v122, v122
    v_dot2c_f32_bf16 v217, s78, v123
    v_dot2c_f32_bf16 v219, v123, v123
    v_dot2c_f32_bf16 v216, s78, v124
    v_dot2c_f32_bf16 v218, v124, v124
    v_dot2c_f32_bf16 v217, s78, v125
    v_dot2c_f32_bf16 v219, v125, v125
    v_dot2c_f32_bf16 v216, s78, v126
    v_dot2c_f32_bf16 v218, v126, v126
    v_dot2c_f32_bf16 v217, s78, v127
    v_dot2c_f32_bf16 v219, v127, v127
    s_waitcnt vmcnt(18)
    ds_read_b128 v[144:147], v208 offset:20480
    ds_read_b128 v[148:151], v209 offset:20480
    ds_read_b128 v[152:155], v210 offset:20480
    ds_read_b128 v[156:159], v211 offset:20480
    s_add_u32 m0, s74, 0x8000
    s_add_u32 s3, s3, s100
    buffer_load_dwordx4 v224, s[92:95], s3 offen offset:0 lds
    buffer_load_dwordx4 v225, s[92:95], s3 offen offset:1024 lds
    buffer_load_dwordx4 v226, s[92:95], s3 offen offset:2048 lds
    buffer_load_dwordx4 v227, s[92:95], s3 offen offset:3072 lds
    s_waitcnt lgkmcnt(4)
    v_dot2c_f32_bf16 v216, s78, v128
    v_dot2c_f32_bf16 v218, v128, v128
    v_dot2c_f32_bf16 v217, s78, v129
    v_dot2c_f32_bf16 v219, v129, v129
    v_dot2c_f32_bf16 v216, s78, v130
    v_dot2c_f32_bf16 v218, v130, v130
    v_dot2c_f32_bf16 v217, s78, v131
    v_dot2c_f32_bf16 v219, v131, v131
    v_dot2c_f32_bf16 v216, s78, v132
    v_dot2c_f32_bf16 v218, v132, v132
    v_dot2c_f32_bf16 v217, s78, v133
    v_dot2c_f32_bf16 v219, v133, v133
    v_dot2c_f32_bf16 v216, s78, v134
    v_dot2c_f32_bf16 v218, v134, v134
    v_dot2c_f32_bf16 v217, s78, v135
    v_dot2c_f32_bf16 v219, v135, v135
    v_dot2c_f32_bf16 v216, s78, v136
    v_dot2c_f32_bf16 v218, v136, v136
    v_dot2c_f32_bf16 v217, s78, v137
    v_dot2c_f32_bf16 v219, v137, v137
    v_dot2c_f32_bf16 v216, s78, v138
    v_dot2c_f32_bf16 v218, v138, v138
    v_dot2c_f32_bf16 v217, s78, v139
    v_dot2c_f32_bf16 v219, v139, v139
    v_dot2c_f32_bf16 v216, s78, v140
    v_dot2c_f32_bf16 v218, v140, v140
    v_dot2c_f32_bf16 v217, s78, v141
    v_dot2c_f32_bf16 v219, v141, v141
    v_dot2c_f32_bf16 v216, s78, v142
    v_dot2c_f32_bf16 v218, v142, v142
    v_dot2c_f32_bf16 v217, s78, v143
    v_dot2c_f32_bf16 v219, v143, v143
    s_waitcnt vmcnt(18)
    ds_read_b128 v[160:163], v208 offset:24576
    ds_read_b128 v[164:167], v209 offset:24576
    ds_read_b128 v[168:171], v210 offset:24576
    ds_read_b128 v[172:175], v211 offset:24576
    s_add_u32 m0, s74, 0x10000
    s_add_u32 s3, s3, s100
    buffer_load_dwordx4 v224, s[92:95], s3 offen offset:0 lds
    buffer_load_dwordx4 v225, s[92:95], s3 offen offset:1024 lds
    buffer_load_dwordx4 v226, s[92:95], s3 offen offset:2048 lds
    buffer_load_dwordx4 v227, s[92:95], s3 offen offset:3072 lds
    s_waitcnt lgkmcnt(4)
    v_dot2c_f32_bf16 v216, s78, v144
    v_dot2c_f32_bf16 v218, v144, v144
    v_dot2c_f32_bf16 v217, s78, v145
    v_dot2c_f32_bf16 v219, v145, v145
    v_dot2c_f32_bf16 v216, s78, v146
    v_dot2c_f32_bf16 v218, v146, v146
    v_dot2c_f32_bf16 v217, s78, v147
    v_dot2c_f32_bf16 v219, v147, v147
    v_dot2c_f32_bf16 v216, s78, v148
    v_dot2c_f32_bf16 v218, v148, v148
    v_dot2c_f32_bf16 v217, s78, v149
    v_dot2c_f32_bf16 v219, v149, v149
    v_dot2c_f32_bf16 v216, s78, v150
    v_dot2c_f32_bf16 v218, v150, v150
    v_dot2c_f32_bf16 v217, s78, v151
    v_dot2c_f32_bf16 v219, v151, v151
    v_dot2c_f32_bf16 v216, s78, v152
    v_dot2c_f32_bf16 v218, v152, v152
    v_dot2c_f32_bf16 v217, s78, v153
    v_dot2c_f32_bf16 v219, v153, v153
    v_dot2c_f32_bf16 v216, s78, v154
    v_dot2c_f32_bf16 v218, v154, v154
    v_dot2c_f32_bf16 v217, s78, v155
    v_dot2c_f32_bf16 v219, v155, v155
    v_dot2c_f32_bf16 v216, s78, v156
    v_dot2c_f32_bf16 v218, v156, v156
    v_dot2c_f32_bf16 v217, s78, v157
    v_dot2c_f32_bf16 v219, v157, v157
    v_dot2c_f32_bf16 v216, s78, v158
    v_dot2c_f32_bf16 v218, v158, v158
    v_dot2c_f32_bf16 v217, s78, v159
    v_dot2c_f32_bf16 v219, v159, v159
    s_waitcnt vmcnt(18)
    ds_read_b128 v[176:179], v208 offset:28672
    ds_read_b128 v[180:183], v209 offset:28672
    ds_read_b128 v[184:187], v210 offset:28672
    ds_read_b128 v[188:191], v211 offset:28672
    s_waitcnt lgkmcnt(4)
    v_dot2c_f32_bf16 v216, s78, v160
    v_dot2c_f32_bf16 v218, v160, v160
    v_dot2c_f32_bf16 v217, s78, v161
    v_dot2c_f32_bf16 v219, v161, v161
    v_dot2c_f32_bf16 v216, s78, v162
    v_dot2c_f32_bf16 v218, v162, v162
    v_dot2c_f32_bf16 v217, s78, v163
    v_dot2c_f32_bf16 v219, v163, v163
    v_dot2c_f32_bf16 v216, s78, v164
    v_dot2c_f32_bf16 v218, v164, v164
    v_dot2c_f32_bf16 v217, s78, v165
    v_dot2c_f32_bf16 v219, v165, v165
    v_dot2c_f32_bf16 v216, s78, v166
    v_dot2c_f32_bf16 v218, v166, v166
    v_dot2c_f32_bf16 v217, s78, v167
    v_dot2c_f32_bf16 v219, v167, v167
    v_dot2c_f32_bf16 v216, s78, v168
    v_dot2c_f32_bf16 v218, v168, v168
    v_dot2c_f32_bf16 v217, s78, v169
    v_dot2c_f32_bf16 v219, v169, v169
    v_dot2c_f32_bf16 v216, s78, v170
    v_dot2c_f32_bf16 v218, v170, v170
    v_dot2c_f32_bf16 v217, s78, v171
    v_dot2c_f32_bf16 v219, v171, v171
    v_dot2c_f32_bf16 v216, s78, v172
    v_dot2c_f32_bf16 v218, v172, v172
    v_dot2c_f32_bf16 v217, s78, v173
    v_dot2c_f32_bf16 v219, v173, v173
    v_dot2c_f32_bf16 v216, s78, v174
    v_dot2c_f32_bf16 v218, v174, v174
    v_dot2c_f32_bf16 v217, s78, v175
    v_dot2c_f32_bf16 v219, v175, v175
    s_waitcnt lgkmcnt(0)
    v_dot2c_f32_bf16 v216, s78, v176
    v_dot2c_f32_bf16 v218, v176, v176
    v_dot2c_f32_bf16 v217, s78, v177
    v_dot2c_f32_bf16 v219, v177, v177
    v_dot2c_f32_bf16 v216, s78, v178
    v_dot2c_f32_bf16 v218, v178, v178
    v_dot2c_f32_bf16 v217, s78, v179
    v_dot2c_f32_bf16 v219, v179, v179
    v_dot2c_f32_bf16 v216, s78, v180
    v_dot2c_f32_bf16 v218, v180, v180
    v_dot2c_f32_bf16 v217, s78, v181
    v_dot2c_f32_bf16 v219, v181, v181
    v_dot2c_f32_bf16 v216, s78, v182
    v_dot2c_f32_bf16 v218, v182, v182
    v_dot2c_f32_bf16 v217, s78, v183
    v_dot2c_f32_bf16 v219, v183, v183
    v_dot2c_f32_bf16 v216, s78, v184
    v_dot2c_f32_bf16 v218, v184, v184
    v_dot2c_f32_bf16 v217, s78, v185
    v_dot2c_f32_bf16 v219, v185, v185
    v_dot2c_f32_bf16 v216, s78, v186
    v_dot2c_f32_bf16 v218, v186, v186
    v_dot2c_f32_bf16 v217, s78, v187
    v_dot2c_f32_bf16 v219, v187, v187
    v_dot2c_f32_bf16 v216, s78, v188
    v_dot2c_f32_bf16 v218, v188, v188
    v_dot2c_f32_bf16 v217, s78, v189
    v_dot2c_f32_bf16 v219, v189, v189
    v_dot2c_f32_bf16 v216, s78, v190
    v_dot2c_f32_bf16 v218, v190, v190
    v_dot2c_f32_bf16 v217, s78, v191
    v_dot2c_f32_bf16 v219, v191, v191
    s_barrier
    buffer_load_dword v253, v254, s[52:55], 0 offen sc1
    v_add_f32_e32 v216, v216, v217
    v_add_f32_e32 v218, v218, v219
    v_mov_b32_e32 v220, v216
    v_mov_b32_e32 v221, v218
    s_nop 0
    v_permlane32_swap_b32 v220, v216
    v_permlane32_swap_b32 v221, v218
    v_add_f32_e32 v216, v216, v220
    v_add_f32_e32 v218, v218, v221
    s_mov_b32 s68, 0x3b000000
    v_mul_f32_e32 v220, s68, v216
    v_mul_f32_e32 v221, s68, v218
    v_sub_f32_e64 v222, 0, v220
    v_fma_f32 v221, -v220, v220, v221
    v_max_f32_e64 v221, 0, v221
    v_add_f32_e32 v4, 0x3727c5ac, v221
    v_rsq_f32_e32 v5, v4
    v_mov_b32_e32 v208, v222
    v_mov_b32_e32 v209, v222
    v_mov_b32_e32 v210, v222
    v_mov_b32_e32 v211, v222
    v_mov_b32_e32 v212, v222
    v_mov_b32_e32 v213, v222
    v_mov_b32_e32 v214, v222
    v_mov_b32_e32 v215, v222
    v_mov_b32_e32 v216, v222
    v_mov_b32_e32 v217, v222
    v_mov_b32_e32 v218, v222
    v_mov_b32_e32 v219, v222
    v_mov_b32_e32 v220, v222
    v_mov_b32_e32 v221, v222
    v_mov_b32_e32 v222, v222
    v_mov_b32_e64 v223, v222
    s_mov_b32 s69, 0xbdd2d3e8
    v_mul_f32_e32 v2, 0xc0135761, v5
    v_mul_f32_e32 v29, v5, v5
    v_mul_f32_e32 v29, v29, v5
    v_mul_f32_e32 v3, s69, v29
    v_mfma_f32_32x32x16_bf16 v[32:47], v[244:247], v[64:67], v[208:223]
    v_mfma_f32_32x32x16_bf16 v[32:47], v[248:251], v[68:71], v[32:47]
    v_mfma_f32_32x32x16_bf16 v[48:63], v[244:247], v[72:75], v[208:223]
    v_mfma_f32_32x32x16_bf16 v[48:63], v[248:251], v[76:79], v[48:63]
    buffer_load_dword v238, v228, s[28:31], s20 offen
    v_mfma_f32_32x32x16_bf16 v[192:207], v[244:247], v[80:83], v[208:223]
    v_mfma_f32_32x32x16_bf16 v[192:207], v[248:251], v[84:87], v[192:207]
    buffer_load_dword v238, v229, s[32:35], s21 offen
    s_nop 5
    v_cvt_pk_bf16_f32 v64, v32, v33
    v_cvt_pk_bf16_f32 v65, v34, v35
    v_cvt_pk_bf16_f32 v66, v36, v37
    v_cvt_pk_bf16_f32 v67, v38, v39
    v_cvt_pk_bf16_f32 v68, v40, v41
    v_cvt_pk_bf16_f32 v69, v42, v43
    v_cvt_pk_bf16_f32 v70, v44, v45
    v_cvt_pk_bf16_f32 v71, v46, v47
    v_mfma_f32_32x32x16_bf16 v[32:47], v[244:247], v[88:91], v[208:223]
    v_mfma_f32_32x32x16_bf16 v[32:47], v[248:251], v[92:95], v[32:47]
    buffer_load_dword v238, v230, s[28:31], s20 offen
    v_cvt_pk_bf16_f32 v72, v48, v49
    v_cvt_pk_bf16_f32 v73, v50, v51
    v_cvt_pk_bf16_f32 v74, v52, v53
    v_cvt_pk_bf16_f32 v75, v54, v55
    v_cvt_pk_bf16_f32 v76, v56, v57
    v_cvt_pk_bf16_f32 v77, v58, v59
    v_cvt_pk_bf16_f32 v78, v60, v61
    v_cvt_pk_bf16_f32 v79, v62, v63
    v_mfma_f32_32x32x16_bf16 v[48:63], v[244:247], v[96:99], v[208:223]
    v_mfma_f32_32x32x16_bf16 v[48:63], v[248:251], v[100:103], v[48:63]
    buffer_load_dword v238, v231, s[28:31], s20 offen
    v_cvt_pk_bf16_f32 v80, v192, v193
    v_cvt_pk_bf16_f32 v81, v194, v195
    v_cvt_pk_bf16_f32 v82, v196, v197
    v_cvt_pk_bf16_f32 v83, v198, v199
    v_cvt_pk_bf16_f32 v84, v200, v201
    v_cvt_pk_bf16_f32 v85, v202, v203
    v_cvt_pk_bf16_f32 v86, v204, v205
    v_cvt_pk_bf16_f32 v87, v206, v207
    v_mfma_f32_32x32x16_bf16 v[192:207], v[244:247], v[104:107], v[208:223]
    v_mfma_f32_32x32x16_bf16 v[192:207], v[248:251], v[108:111], v[192:207]
    buffer_load_dword v238, v232, s[32:35], s21 offen
    v_cvt_pk_bf16_f32 v88, v32, v33
    v_cvt_pk_bf16_f32 v89, v34, v35
    v_cvt_pk_bf16_f32 v90, v36, v37
    v_cvt_pk_bf16_f32 v91, v38, v39
    v_cvt_pk_bf16_f32 v92, v40, v41
    v_cvt_pk_bf16_f32 v93, v42, v43
    v_cvt_pk_bf16_f32 v94, v44, v45
    v_cvt_pk_bf16_f32 v95, v46, v47
    v_mfma_f32_32x32x16_bf16 v[32:47], v[244:247], v[112:115], v[208:223]
    v_mfma_f32_32x32x16_bf16 v[32:47], v[248:251], v[116:119], v[32:47]
    v_cvt_pk_bf16_f32 v96, v48, v49
    v_cvt_pk_bf16_f32 v97, v50, v51
    v_cvt_pk_bf16_f32 v98, v52, v53
    v_cvt_pk_bf16_f32 v99, v54, v55
    v_cvt_pk_bf16_f32 v100, v56, v57
    v_cvt_pk_bf16_f32 v101, v58, v59
    v_cvt_pk_bf16_f32 v102, v60, v61
    v_cvt_pk_bf16_f32 v103, v62, v63
    v_mfma_f32_32x32x16_bf16 v[48:63], v[244:247], v[120:123], v[208:223]
    v_mfma_f32_32x32x16_bf16 v[48:63], v[248:251], v[124:127], v[48:63]
    v_cvt_pk_bf16_f32 v104, v192, v193
    v_cvt_pk_bf16_f32 v105, v194, v195
    v_cvt_pk_bf16_f32 v106, v196, v197
    v_cvt_pk_bf16_f32 v107, v198, v199
    v_cvt_pk_bf16_f32 v108, v200, v201
    v_cvt_pk_bf16_f32 v109, v202, v203
    v_cvt_pk_bf16_f32 v110, v204, v205
    v_cvt_pk_bf16_f32 v111, v206, v207
    v_mfma_f32_32x32x16_bf16 v[192:207], v[244:247], v[128:131], v[208:223]
    v_mfma_f32_32x32x16_bf16 v[192:207], v[248:251], v[132:135], v[192:207]
    v_cvt_pk_bf16_f32 v112, v32, v33
    v_cvt_pk_bf16_f32 v113, v34, v35
    v_cvt_pk_bf16_f32 v114, v36, v37
    v_cvt_pk_bf16_f32 v115, v38, v39
    v_cvt_pk_bf16_f32 v116, v40, v41
    v_cvt_pk_bf16_f32 v117, v42, v43
    v_cvt_pk_bf16_f32 v118, v44, v45
    v_cvt_pk_bf16_f32 v119, v46, v47
    v_mfma_f32_32x32x16_bf16 v[32:47], v[244:247], v[136:139], v[208:223]
    v_mfma_f32_32x32x16_bf16 v[32:47], v[248:251], v[140:143], v[32:47]
    v_cvt_pk_bf16_f32 v120, v48, v49
    v_cvt_pk_bf16_f32 v121, v50, v51
    v_cvt_pk_bf16_f32 v122, v52, v53
    v_cvt_pk_bf16_f32 v123, v54, v55
    v_cvt_pk_bf16_f32 v124, v56, v57
    v_cvt_pk_bf16_f32 v125, v58, v59
    v_cvt_pk_bf16_f32 v126, v60, v61
    v_cvt_pk_bf16_f32 v127, v62, v63
    v_mfma_f32_32x32x16_bf16 v[48:63], v[244:247], v[144:147], v[208:223]
    v_mfma_f32_32x32x16_bf16 v[48:63], v[248:251], v[148:151], v[48:63]
    v_cvt_pk_bf16_f32 v128, v192, v193
    v_cvt_pk_bf16_f32 v129, v194, v195
    v_cvt_pk_bf16_f32 v130, v196, v197
    v_cvt_pk_bf16_f32 v131, v198, v199
    v_cvt_pk_bf16_f32 v132, v200, v201
    v_cvt_pk_bf16_f32 v133, v202, v203
    v_cvt_pk_bf16_f32 v134, v204, v205
    v_cvt_pk_bf16_f32 v135, v206, v207
    v_mfma_f32_32x32x16_bf16 v[192:207], v[244:247], v[152:155], v[208:223]
    v_mfma_f32_32x32x16_bf16 v[192:207], v[248:251], v[156:159], v[192:207]
    v_cvt_pk_bf16_f32 v136, v32, v33
    v_cvt_pk_bf16_f32 v137, v34, v35
    v_cvt_pk_bf16_f32 v138, v36, v37
    v_cvt_pk_bf16_f32 v139, v38, v39
    v_cvt_pk_bf16_f32 v140, v40, v41
    v_cvt_pk_bf16_f32 v141, v42, v43
    v_cvt_pk_bf16_f32 v142, v44, v45
    v_cvt_pk_bf16_f32 v143, v46, v47
    v_mfma_f32_32x32x16_bf16 v[32:47], v[244:247], v[160:163], v[208:223]
    v_mfma_f32_32x32x16_bf16 v[32:47], v[248:251], v[164:167], v[32:47]
    v_cvt_pk_bf16_f32 v144, v48, v49
    v_cvt_pk_bf16_f32 v145, v50, v51
    v_cvt_pk_bf16_f32 v146, v52, v53
    v_cvt_pk_bf16_f32 v147, v54, v55
    v_cvt_pk_bf16_f32 v148, v56, v57
    v_cvt_pk_bf16_f32 v149, v58, v59
    v_cvt_pk_bf16_f32 v150, v60, v61
    v_cvt_pk_bf16_f32 v151, v62, v63
    v_mfma_f32_32x32x16_bf16 v[48:63], v[244:247], v[168:171], v[208:223]
    v_mfma_f32_32x32x16_bf16 v[48:63], v[248:251], v[172:175], v[48:63]
    v_cvt_pk_bf16_f32 v152, v192, v193
    v_cvt_pk_bf16_f32 v153, v194, v195
    v_cvt_pk_bf16_f32 v154, v196, v197
    v_cvt_pk_bf16_f32 v155, v198, v199
    v_cvt_pk_bf16_f32 v156, v200, v201
    v_cvt_pk_bf16_f32 v157, v202, v203
    v_cvt_pk_bf16_f32 v158, v204, v205
    v_cvt_pk_bf16_f32 v159, v206, v207
    v_mfma_f32_32x32x16_bf16 v[192:207], v[244:247], v[176:179], v[208:223]
    v_mfma_f32_32x32x16_bf16 v[192:207], v[248:251], v[180:183], v[192:207]
    v_cvt_pk_bf16_f32 v160, v32, v33
    v_cvt_pk_bf16_f32 v161, v34, v35
    v_cvt_pk_bf16_f32 v162, v36, v37
    v_cvt_pk_bf16_f32 v163, v38, v39
    v_cvt_pk_bf16_f32 v164, v40, v41
    v_cvt_pk_bf16_f32 v165, v42, v43
    v_cvt_pk_bf16_f32 v166, v44, v45
    v_cvt_pk_bf16_f32 v167, v46, v47
    v_mfma_f32_32x32x16_bf16 v[32:47], v[244:247], v[184:187], v[208:223]
    v_mfma_f32_32x32x16_bf16 v[32:47], v[248:251], v[188:191], v[32:47]
    v_cvt_pk_bf16_f32 v168, v48, v49
    v_cvt_pk_bf16_f32 v169, v50, v51
    v_cvt_pk_bf16_f32 v170, v52, v53
    v_cvt_pk_bf16_f32 v171, v54, v55
    v_cvt_pk_bf16_f32 v172, v56, v57
    v_cvt_pk_bf16_f32 v173, v58, v59
    v_cvt_pk_bf16_f32 v174, v60, v61
    v_cvt_pk_bf16_f32 v175, v62, v63
    v_cvt_pk_bf16_f32 v176, v192, v193
    v_cvt_pk_bf16_f32 v177, v194, v195
    v_cvt_pk_bf16_f32 v178, v196, v197
    v_cvt_pk_bf16_f32 v179, v198, v199
    v_cvt_pk_bf16_f32 v180, v200, v201
    v_cvt_pk_bf16_f32 v181, v202, v203
    v_cvt_pk_bf16_f32 v182, v204, v205
    v_cvt_pk_bf16_f32 v183, v206, v207
    v_cvt_pk_bf16_f32 v184, v32, v33
    v_cvt_pk_bf16_f32 v185, v34, v35
    v_cvt_pk_bf16_f32 v186, v36, v37
    v_cvt_pk_bf16_f32 v187, v38, v39
    v_cvt_pk_bf16_f32 v188, v40, v41
    v_cvt_pk_bf16_f32 v189, v42, v43
    v_cvt_pk_bf16_f32 v190, v44, v45
    v_cvt_pk_bf16_f32 v191, v46, v47
    s_cmp_eq_u32 s61, 0
    s_cbranch_scc1 L_typeB
    s_waitcnt vmcnt(6)
    s_barrier
    ds_read_b64_tr_b16 a[176:177], v8 offset:0
    ds_read_b64_tr_b16 a[178:179], v8 offset:512
    ds_read_b64_tr_b16 a[180:181], v8 offset:1024
    ds_read_b64_tr_b16 a[182:183], v8 offset:1536
    ds_read_b64_tr_b16 a[184:185], v8 offset:2048
    ds_read_b64_tr_b16 a[186:187], v8 offset:2560
    ds_read_b64_tr_b16 a[188:189], v8 offset:3072
    ds_read_b64_tr_b16 a[190:191], v8 offset:3584
    s_waitcnt lgkmcnt(6)
    v_mfma_f32_32x32x16_bf16 v[32:47], a[176:179], v[64:67], 0
    s_waitcnt lgkmcnt(4)
    s_add_u32 m0, s74, 0x18000
    s_add_u32 s81, s76, 0x800
    buffer_load_dwordx4 v14, s[32:35], s81 offen offset:0 lds
    ds_read_b64_tr_b16 a[192:193], v8 offset:4096
    ds_read_b64_tr_b16 a[194:195], v8 offset:4608
    s_lshl_b32 s68, s65, 7
    v_mfma_f32_32x32x16_bf16 v[32:47], a[180:183], v[68:71], v[32:47]
    s_waitcnt lgkmcnt(4)
    ds_read_b64_tr_b16 a[196:197], v8 offset:5120
    ds_read_b64_tr_b16 a[198:199], v8 offset:5632
    s_lshl_b32 s69, s57, 6
    s_add_u32 s68, s68, s69
    s_mul_i32 s84, s66, 0xa0000
    s_add_u32 s84, s84, s68
    s_mul_i32 s85, s66, 0x40000
    v_mfma_f32_32x32x16_bf16 v[32:47], a[184:187], v[72:75], v[32:47]
    s_waitcnt lgkmcnt(4)
    buffer_load_dwordx4 v15, s[32:35], s81 offen offset:1024 lds
    ds_read_b64_tr_b16 a[176:177], v8 offset:6144
    ds_read_b64_tr_b16 a[178:179], v8 offset:6656
    s_add_u32 s85, s85, s68
    s_mov_b32 s86, s85
    v_mfma_f32_32x32x16_bf16 v[32:47], a[188:191], v[76:79], v[32:47]
    s_waitcnt lgkmcnt(4)
    ds_read_b64_tr_b16 a[180:181], v8 offset:7168
    ds_read_b64_tr_b16 a[182:183], v8 offset:7680
    s_lshl_b32 s83, s66, 13
    s_lshl_b32 s69, s57, 10
    s_add_u32 s83, s83, s69
    s_lshl_b32 s68, s64, 1
    s_add_u32 s68, s68, s57
    v_mfma_f32_32x32x16_bf16 v[32:47], a[192:195], v[80:83], v[32:47]
    s_waitcnt lgkmcnt(4)
    buffer_load_dwordx4 v16, s[32:35], s81 offen offset:2048 lds
    ds_read_b64_tr_b16 a[184:185], v8 offset:16384
    ds_read_b64_tr_b16 a[186:187], v8 offset:16896
    s_mul_i32 s69, s68, 0x1c000
    s_add_u32 s69, s69, 0x800000
    v_mfma_f32_32x32x16_bf16 v[32:47], a[196:199], v[84:87], v[32:47]
    s_waitcnt lgkmcnt(4)
    ds_read_b64_tr_b16 a[188:189], v8 offset:17408
    ds_read_b64_tr_b16 a[190:191], v8 offset:17920
    s_mul_i32 s87, s66, 0xa000
    s_add_u32 s87, s87, s69
    s_mul_i32 s88, s66, 0x4000
    s_add_u32 s88, s88, s69
    s_lshl_b32 s89, s68, 15
    s_mul_i32 s69, s66, 0x4000
    v_mfma_f32_32x32x16_bf16 v[32:47], a[176:179], v[88:91], v[32:47]
    s_waitcnt lgkmcnt(4)
    buffer_load_dwordx4 v17, s[32:35], s81 offen offset:3072 lds
    ds_read_b64_tr_b16 a[192:193], v8 offset:18432
    ds_read_b64_tr_b16 a[194:195], v8 offset:18944
    s_add_u32 s89, s89, s69
    s_add_u32 s89, s89, 0x400000
    v_mfma_f32_32x32x16_bf16 v[32:47], a[180:183], v[92:95], v[32:47]
    s_waitcnt lgkmcnt(4)
    ds_read_b64_tr_b16 a[196:197], v8 offset:19456
    ds_read_b64_tr_b16 a[198:199], v8 offset:19968
    v_lshrrev_b32_e32 v252, 2, v0
    v_lshlrev_b32_e32 v252, 10, v252
    v_and_b32_e64 v192, 3, v0
    v_lshl_add_u32 v252, v192, 4, v252
    v_lshrrev_b32_e64 v192, 5, v0
    v_mfma_f32_32x32x16_bf16 v[32:47], a[184:187], v[96:99], v[32:47]
    s_waitcnt lgkmcnt(4)
    s_add_u32 m0, s74, 0x20000
    s_add_u32 s81, s76, 0x60800
    buffer_load_dwordx4 v14, s[32:35], s81 offen offset:0 lds
    ds_read_b64_tr_b16 a[176:177], v8 offset:20480
    ds_read_b64_tr_b16 a[178:179], v8 offset:20992
    v_mfma_f32_32x32x16_bf16 v[32:47], a[188:191], v[100:103], v[32:47]
    s_waitcnt lgkmcnt(4)
    ds_read_b64_tr_b16 a[180:181], v8 offset:21504
    ds_read_b64_tr_b16 a[182:183], v8 offset:22016
    v_bfe_u32 v193, v0, 2, 2
    v_lshl_add_u32 v192, v192, 2, v193
    v_lshlrev_b32_e64 v192, 6, v192
    v_bfe_u32 v193, v0, 4, 1
    v_lshl_add_u32 v192, v193, 5, v192
    v_mfma_f32_32x32x16_bf16 v[32:47], a[192:195], v[104:107], v[32:47]
    s_waitcnt lgkmcnt(4)
    buffer_load_dwordx4 v15, s[32:35], s81 offen offset:1024 lds
    ds_read_b64_tr_b16 a[184:185], v8 offset:22528
    ds_read_b64_tr_b16 a[186:187], v8 offset:23040
    v_and_b32_e32 v193, 3, v0
    v_lshl_add_u32 v192, v193, 3, v192
    s_lshl_b32 s68, s66, 13
    v_mfma_f32_32x32x16_bf16 v[32:47], a[196:199], v[108:111], v[32:47]
    s_waitcnt lgkmcnt(4)
    ds_read_b64_tr_b16 a[188:189], v8 offset:23552
    ds_read_b64_tr_b16 a[190:191], v8 offset:24064
    s_lshl_b32 s69, s66, 10
    s_add_u32 s69, s69, s68
    v_add_u32_e64 v251, s69, v192
    v_xor_b32_e32 v248, 0x400, v251
    v_add_u32_e32 v250, 0x10000, v251
    v_mfma_f32_32x32x16_bf16 v[32:47], a[176:179], v[112:115], v[32:47]
    s_waitcnt lgkmcnt(4)
    buffer_load_dwordx4 v16, s[32:35], s81 offen offset:2048 lds
    ds_read_b64_tr_b16 a[192:193], v8 offset:32768
    ds_read_b64_tr_b16 a[194:195], v8 offset:33280
    v_add_u32_e32 v247, 0x10000, v248
    v_add_u32_e32 v249, 0x20000, v251
    v_mfma_f32_32x32x16_bf16 v[32:47], a[180:183], v[116:119], v[32:47]
    s_waitcnt lgkmcnt(4)
    ds_read_b64_tr_b16 a[196:197], v8 offset:33792
    ds_read_b64_tr_b16 a[198:199], v8 offset:34304
    v_add_u32_e32 v246, 0x20000, v248
    v_lshrrev_b32_e32 v192, 2, v0
    v_and_b32_e32 v193, 3, v0
    v_lshlrev_b32_e32 v28, 10, v192
    v_lshl_add_u32 v28, v193, 7, v28
    v_mfma_f32_32x32x16_bf16 v[32:47], a[184:187], v[120:123], v[32:47]
    s_waitcnt lgkmcnt(4)
    buffer_load_dwordx4 v17, s[32:35], s81 offen offset:3072 lds
    ds_read_b64_tr_b16 a[176:177], v8 offset:34816
    ds_read_b64_tr_b16 a[178:179], v8 offset:35328
    s_and_b32 s68, s2, 1
    s_lshl_b32 s68, s68, 9
    v_add_u32_e32 v28, s68, v28
    v_mfma_f32_32x32x16_bf16 v[32:47], a[188:191], v[124:127], v[32:47]
    s_waitcnt lgkmcnt(4)
    ds_read_b64_tr_b16 a[180:181], v8 offset:35840
    ds_read_b64_tr_b16 a[182:183], v8 offset:36352
    v_mov_b32_e32 v193, 0x7ffffff0
    v_cmp_gt_u32 vcc, 4, v192
    s_nop 1
    v_cndmask_b32 v30, v193, v28, vcc
    v_mfma_f32_32x32x16_bf16 v[32:47], a[192:195], v[128:131], v[32:47]
    s_waitcnt lgkmcnt(4)
    s_add_u32 m0, s74, 0xc000
    s_add_u32 s81, s76, 0xc0800
    buffer_load_dwordx4 v14, s[32:35], s81 offen offset:0 lds
    ds_read_b64_tr_b16 a[184:185], v8 offset:36864
    ds_read_b64_tr_b16 a[186:187], v8 offset:37376
    v_mfma_f32_32x32x16_bf16 v[32:47], a[196:199], v[132:135], v[32:47]
    s_waitcnt lgkmcnt(4)
    ds_read_b64_tr_b16 a[188:189], v8 offset:37888
    ds_read_b64_tr_b16 a[190:191], v8 offset:38400
    v_cmp_gt_u32 vcc, 14, v192
    s_nop 1
    v_cndmask_b32 v28, v193, v28, vcc
    s_lshr_b32 s68, s2, 3
    v_mfma_f32_32x32x16_bf16 v[32:47], a[176:179], v[136:139], v[32:47]
    s_waitcnt lgkmcnt(4)
    buffer_load_dwordx4 v15, s[32:35], s81 offen offset:1024 lds
    ds_read_b64_tr_b16 a[192:193], v8 offset:38912
    ds_read_b64_tr_b16 a[194:195], v8 offset:39424
    s_lshl_b32 s68, s68, 2
    s_add_u32 s68, s68, s56
    v_mfma_f32_32x32x16_bf16 v[32:47], a[180:183], v[140:143], v[32:47]
    s_waitcnt lgkmcnt(4)
    ds_read_b64_tr_b16 a[196:197], v8 offset:39936
    ds_read_b64_tr_b16 a[198:199], v8 offset:40448
    s_mul_i32 s14, s68, 14336
    s_lshl_b32 s15, s68, 12
    v_lshrrev_b32_e32 v193, 5, v0
    v_and_b32_e32 v192, 31, v0
    v_lshlrev_b32_e64 v193, 2, v193
    v_sub_u32_e32 v192, v192, v193
    v_add_u32_e32 v9, 0x10000, v8
    v_mfma_f32_32x32x16_bf16 v[32:47], a[184:187], v[144:147], v[32:47]
    s_waitcnt lgkmcnt(4)
    buffer_load_dwordx4 v16, s[32:35], s81 offen offset:2048 lds
    ds_read_b64_tr_b16 a[176:177], v9 offset:0
    ds_read_b64_tr_b16 a[178:179], v9 offset:512
    v_mov_b32_e32 v194, 0xf149f2ca
    v_mov_b32_e32 v195, 0xffff
    v_mfma_f32_32x32x16_bf16 v[32:47], a[188:191], v[148:151], v[32:47]
    s_waitcnt lgkmcnt(4)
    ds_read_b64_tr_b16 a[180:181], v9 offset:1024
    ds_read_b64_tr_b16 a[182:183], v9 offset:1536
    v_mov_b32_e32 v196, 0xffff0000
    s_cmp_eq_u32 s62, 0
    s_cselect_b32 s10, 0, 8
    v_add_u32_e32 v197, 0, v192
    v_subrev_u32_e32 v198, 1, v192
    v_mfma_f32_32x32x16_bf16 v[32:47], a[192:195], v[152:155], v[32:47]
    s_waitcnt lgkmcnt(4)
    buffer_load_dwordx4 v17, s[32:35], s81 offen offset:3072 lds
    ds_read_b64_tr_b16 a[184:185], v9 offset:2048
    ds_read_b64_tr_b16 a[186:187], v9 offset:2560
    v_mfma_f32_32x32x16_bf16 v[32:47], a[196:199], v[156:159], v[32:47]
    s_waitcnt lgkmcnt(4)
    ds_read_b64_tr_b16 a[188:189], v9 offset:3072
    ds_read_b64_tr_b16 a[190:191], v9 offset:3584
    v_cmp_gt_u32 s[92:93], 8, v197
    v_cmp_gt_u32 s[94:95], 8, v198
    s_nop 0
    v_cndmask_b32 v208, v194, v254, s[92:93]
    v_cndmask_b32 v209, v194, v254, s[94:95]
    v_cndmask_b32 v197, v254, v195, s[92:93]
    v_mfma_f32_32x32x16_bf16 v[32:47], a[176:179], v[160:163], v[32:47]
    s_waitcnt lgkmcnt(4)
    s_add_u32 m0, s74, 0x14000
    s_add_u32 s81, s76, 0x120800
    buffer_load_dwordx4 v14, s[32:35], s81 offen offset:0 lds
    ds_read_b64_tr_b16 a[192:193], v9 offset:4096
    ds_read_b64_tr_b16 a[194:195], v9 offset:4608
    v_mfma_f32_32x32x16_bf16 v[32:47], a[180:183], v[164:167], v[32:47]
    s_waitcnt lgkmcnt(4)
    ds_read_b64_tr_b16 a[196:197], v9 offset:5120
    ds_read_b64_tr_b16 a[198:199], v9 offset:5632
    v_cndmask_b32 v198, v254, v196, s[94:95]
    v_or_b32_e32 v228, v197, v198
    v_subrev_u32_e32 v197, 2, v192
    v_subrev_u32_e64 v198, 3, v192
    v_mfma_f32_32x32x16_bf16 v[32:47], a[184:187], v[168:171], v[32:47]
    s_waitcnt lgkmcnt(4)
    buffer_load_dwordx4 v15, s[32:35], s81 offen offset:1024 lds
    ds_read_b64_tr_b16 a[176:177], v9 offset:6144
    ds_read_b64_tr_b16 a[178:179], v9 offset:6656
    v_mfma_f32_32x32x16_bf16 v[32:47], a[188:191], v[172:175], v[32:47]
    s_waitcnt lgkmcnt(4)
    ds_read_b64_tr_b16 a[180:181], v9 offset:7168
    ds_read_b64_tr_b16 a[182:183], v9 offset:7680
    v_cmp_gt_u32 s[92:93], 8, v197
    v_cmp_gt_u32 s[94:95], 8, v198
    s_nop 0
    v_cndmask_b32 v210, v194, v254, s[92:93]
    v_cndmask_b32 v211, v194, v254, s[94:95]
    v_mfma_f32_32x32x16_bf16 v[32:47], a[192:195], v[176:179], v[32:47]
    s_waitcnt lgkmcnt(4)
    buffer_load_dwordx4 v16, s[32:35], s81 offen offset:2048 lds
    ds_read_b64_tr_b16 a[184:185], v8 offset:8192
    ds_read_b64_tr_b16 a[186:187], v8 offset:8704
    v_cndmask_b32 v197, v254, v195, s[92:93]
    v_cndmask_b32 v198, v254, v196, s[94:95]
    v_or_b32_e32 v229, v197, v198
    v_mfma_f32_32x32x16_bf16 v[32:47], a[196:199], v[180:183], v[32:47]
    s_waitcnt lgkmcnt(4)
    ds_read_b64_tr_b16 a[188:189], v8 offset:9216
    ds_read_b64_tr_b16 a[190:191], v8 offset:9728
    v_subrev_u32_e32 v197, 8, v192
    v_subrev_u32_e32 v198, 9, v192
    v_cmp_gt_u32 s[92:93], 8, v197
    v_cmp_gt_u32 s[94:95], 8, v198
    s_nop 0
    v_mfma_f32_32x32x16_bf16 v[32:47], a[176:179], v[184:187], v[32:47]
    s_waitcnt lgkmcnt(4)
    buffer_load_dwordx4 v17, s[32:35], s81 offen offset:3072 lds
    ds_read_b64_tr_b16 a[192:193], v8 offset:10240
    ds_read_b64_tr_b16 a[194:195], v8 offset:10752
    v_cndmask_b32 v212, v194, v254, s[92:93]
    v_cndmask_b32 v213, v194, v254, s[94:95]
    v_mfma_f32_32x32x16_bf16 v[32:47], a[180:183], v[188:191], v[32:47]
    s_waitcnt lgkmcnt(4)
    ds_read_b64_tr_b16 a[196:197], v8 offset:11264
    ds_read_b64_tr_b16 a[198:199], v8 offset:11776
    v_cndmask_b32 v197, v254, v195, s[92:93]
    v_mfma_f32_32x32x16_bf16 v[48:63], a[184:187], v[64:67], 0
    s_waitcnt lgkmcnt(4)
    s_add_u32 m0, s74, 0x1c000
    s_add_u32 s81, s75, 0x0
    buffer_load_dwordx4 v10, s[28:31], s81 offen offset:0 lds
    ds_read_b64_tr_b16 a[176:177], v8 offset:12288
    ds_read_b64_tr_b16 a[178:179], v8 offset:12800
    v_mfma_f32_32x32x16_bf16 v[48:63], a[188:191], v[68:71], v[48:63]
    s_waitcnt lgkmcnt(4)
    ds_read_b64_tr_b16 a[180:181], v8 offset:13312
    ds_read_b64_tr_b16 a[182:183], v8 offset:13824
    v_cndmask_b32 v198, v254, v196, s[94:95]
    v_or_b32_e32 v230, v197, v198
    v_subrev_u32_e32 v197, 10, v192
    v_subrev_u32_e32 v198, 11, v192
    v_mfma_f32_32x32x16_bf16 v[48:63], a[192:195], v[72:75], v[48:63]
    s_waitcnt lgkmcnt(4)
    buffer_load_dwordx4 v11, s[28:31], s81 offen offset:1024 lds
    ds_read_b64_tr_b16 a[184:185], v8 offset:14336
    ds_read_b64_tr_b16 a[186:187], v8 offset:14848
    v_mfma_f32_32x32x16_bf16 v[48:63], a[196:199], v[76:79], v[48:63]
    s_waitcnt lgkmcnt(4)
    ds_read_b64_tr_b16 a[188:189], v8 offset:15360
    ds_read_b64_tr_b16 a[190:191], v8 offset:15872
    v_cmp_gt_u32 s[92:93], 8, v197
    v_cmp_gt_u32 s[94:95], 8, v198
    s_nop 0
    v_cndmask_b32 v214, v194, v254, s[92:93]
    v_mfma_f32_32x32x16_bf16 v[48:63], a[176:179], v[80:83], v[48:63]
    s_waitcnt lgkmcnt(4)
    buffer_load_dwordx4 v12, s[28:31], s81 offen offset:2048 lds
    ds_read_b64_tr_b16 a[192:193], v8 offset:24576
    ds_read_b64_tr_b16 a[194:195], v8 offset:25088
    v_cndmask_b32 v215, v194, v254, s[94:95]
    v_mfma_f32_32x32x16_bf16 v[48:63], a[180:183], v[84:87], v[48:63]
    s_waitcnt lgkmcnt(4)
    ds_read_b64_tr_b16 a[196:197], v8 offset:25600
    ds_read_b64_tr_b16 a[198:199], v8 offset:26112
    v_cndmask_b32 v197, v254, v195, s[92:93]
    v_cndmask_b32 v198, v254, v196, s[94:95]
    v_or_b32_e32 v231, v197, v198
    v_subrev_u32_e32 v197, 16, v192
    v_subrev_u32_e32 v198, 17, v192
    v_mfma_f32_32x32x16_bf16 v[48:63], a[184:187], v[88:91], v[48:63]
    s_waitcnt lgkmcnt(4)
    buffer_load_dwordx4 v13, s[28:31], s81 offen offset:3072 lds
    ds_read_b64_tr_b16 a[176:177], v8 offset:26624
    ds_read_b64_tr_b16 a[178:179], v8 offset:27136
    v_mul_f32_e32 v20, v5, v32
    v_mfma_f32_32x32x16_bf16 v[48:63], a[188:191], v[92:95], v[48:63]
    s_waitcnt lgkmcnt(4)
    ds_read_b64_tr_b16 a[180:181], v8 offset:27648
    ds_read_b64_tr_b16 a[182:183], v8 offset:28160
    v_mul_f32_e64 v21, v5, v33
    v_cvt_pk_bf16_f32 v20, v20, v21
    v_accvgpr_write_b32 a16, v20
    v_mul_f32_e64 v22, v5, v34
    v_mfma_f32_32x32x16_bf16 v[48:63], a[192:195], v[96:99], v[48:63]
    s_waitcnt lgkmcnt(4)
    s_add_u32 m0, s74, 0x24000
    s_add_u32 s81, s75, 0x70000
    buffer_load_dwordx4 v10, s[28:31], s81 offen offset:0 lds
    ds_read_b64_tr_b16 a[184:185], v8 offset:28672
    ds_read_b64_tr_b16 a[186:187], v8 offset:29184
    v_mfma_f32_32x32x16_bf16 v[48:63], a[196:199], v[100:103], v[48:63]
    s_waitcnt lgkmcnt(4)
    ds_read_b64_tr_b16 a[188:189], v8 offset:29696
    ds_read_b64_tr_b16 a[190:191], v8 offset:30208
    v_cmp_gt_u32 s[92:93], 8, v197
    v_cmp_gt_u32 s[94:95], 8, v198
    s_nop 0
    v_cndmask_b32 v216, v194, v254, s[92:93]
    v_mfma_f32_32x32x16_bf16 v[48:63], a[176:179], v[104:107], v[48:63]
    s_waitcnt lgkmcnt(4)
    buffer_load_dwordx4 v11, s[28:31], s81 offen offset:1024 lds
    ds_read_b64_tr_b16 a[192:193], v8 offset:30720
    ds_read_b64_tr_b16 a[194:195], v8 offset:31232
    v_cndmask_b32 v217, v194, v254, s[94:95]
    v_cndmask_b32 v197, v254, v195, s[92:93]
    v_mfma_f32_32x32x16_bf16 v[48:63], a[180:183], v[108:111], v[48:63]
    s_waitcnt lgkmcnt(4)
    ds_read_b64_tr_b16 a[196:197], v8 offset:31744
    ds_read_b64_tr_b16 a[198:199], v8 offset:32256
    v_cndmask_b32 v198, v254, v196, s[94:95]
    v_or_b32_e32 v232, v197, v198
    v_subrev_u32_e64 v197, 18, v192
    v_subrev_u32_e32 v198, 19, v192
    v_mfma_f32_32x32x16_bf16 v[48:63], a[184:187], v[112:115], v[48:63]
    s_waitcnt lgkmcnt(4)
    buffer_load_dwordx4 v12, s[28:31], s81 offen offset:2048 lds
    ds_read_b64_tr_b16 a[176:177], v8 offset:40960
    ds_read_b64_tr_b16 a[178:179], v8 offset:41472
    v_mul_f32_e32 v23, v5, v35
    v_mfma_f32_32x32x16_bf16 v[48:63], a[188:191], v[116:119], v[48:63]
    s_waitcnt lgkmcnt(4)
    ds_read_b64_tr_b16 a[180:181], v8 offset:41984
    ds_read_b64_tr_b16 a[182:183], v8 offset:42496
    v_cvt_pk_bf16_f32 v22, v22, v23
    v_accvgpr_write_b32 a17, v22
    v_mul_f32_e32 v20, v5, v36
    v_mul_f32_e32 v21, v5, v37
    v_mfma_f32_32x32x16_bf16 v[48:63], a[192:195], v[120:123], v[48:63]
    s_waitcnt lgkmcnt(4)
    buffer_load_dwordx4 v13, s[28:31], s81 offen offset:3072 lds
    ds_read_b64_tr_b16 a[184:185], v8 offset:43008
    ds_read_b64_tr_b16 a[186:187], v8 offset:43520
    v_cvt_pk_bf16_f32 v20, v20, v21
    v_accvgpr_write_b32 a18, v20
    v_mfma_f32_32x32x16_bf16 v[48:63], a[196:199], v[124:127], v[48:63]
    s_waitcnt lgkmcnt(4)
    ds_read_b64_tr_b16 a[188:189], v8 offset:44032
    ds_read_b64_tr_b16 a[190:191], v8 offset:44544
    v_cmp_gt_u32 s[92:93], 8, v197
    v_cmp_gt_u32 s[94:95], 8, v198
    s_nop 0
    v_cndmask_b32 v218, v194, v254, s[92:93]
    v_mfma_f32_32x32x16_bf16 v[48:63], a[176:179], v[128:131], v[48:63]
    s_waitcnt lgkmcnt(4)
    ds_read_b64_tr_b16 a[192:193], v8 offset:45056
    ds_read_b64_tr_b16 a[194:195], v8 offset:45568
    v_cndmask_b32 v219, v194, v254, s[94:95]
    v_cndmask_b32 v197, v254, v195, s[92:93]
    v_cndmask_b32 v198, v254, v196, s[94:95]
    v_or_b32_e32 v233, v197, v198
    v_mfma_f32_32x32x16_bf16 v[48:63], a[180:183], v[132:135], v[48:63]
    s_waitcnt lgkmcnt(4)
    ds_read_b64_tr_b16 a[196:197], v8 offset:46080
    ds_read_b64_tr_b16 a[198:199], v8 offset:46592
    v_subrev_u32_e32 v197, 24, v192
    v_subrev_u32_e32 v198, 25, v192
    v_mul_f32_e64 v22, v5, v38
    v_mul_f32_e32 v23, v5, v39
    v_mfma_f32_32x32x16_bf16 v[48:63], a[184:187], v[136:139], v[48:63]
    s_waitcnt lgkmcnt(4)
    ds_read_b64_tr_b16 a[176:177], v8 offset:47104
    ds_read_b64_tr_b16 a[178:179], v8 offset:47616
    v_cmp_gt_u32 s[92:93], 8, v197
    v_cmp_gt_u32 s[94:95], 8, v198
    s_nop 0
    v_cndmask_b32 v220, v194, v254, s[92:93]
    v_mfma_f32_32x32x16_bf16 v[48:63], a[188:191], v[140:143], v[48:63]
    s_waitcnt lgkmcnt(4)
    ds_read_b64_tr_b16 a[180:181], v8 offset:48128
    ds_read_b64_tr_b16 a[182:183], v8 offset:48640
    v_cndmask_b32 v221, v194, v254, s[94:95]
    v_cndmask_b32 v197, v254, v195, s[92:93]
    v_cndmask_b32 v198, v254, v196, s[94:95]
    v_or_b32_e64 v234, v197, v198
    v_subrev_u32_e32 v197, 26, v192
    v_mfma_f32_32x32x16_bf16 v[48:63], a[192:195], v[144:147], v[48:63]
    s_waitcnt lgkmcnt(4)
    ds_read_b64_tr_b16 a[184:185], v9 offset:8192
    ds_read_b64_tr_b16 a[186:187], v9 offset:8704
    v_cvt_pk_bf16_f32 v22, v22, v23
    v_accvgpr_write_b32 a19, v22
    v_mul_f32_e64 v20, v5, v40
    v_mul_f32_e32 v21, v5, v41
    v_mfma_f32_32x32x16_bf16 v[48:63], a[196:199], v[148:151], v[48:63]
    s_waitcnt lgkmcnt(4)
    ds_read_b64_tr_b16 a[188:189], v9 offset:9216
    ds_read_b64_tr_b16 a[190:191], v9 offset:9728
    v_subrev_u32_e64 v198, 27, v192
    v_cmp_gt_u32 s[92:93], 8, v197
    v_cmp_gt_u32 s[94:95], 8, v198
    s_nop 0
    v_mfma_f32_32x32x16_bf16 v[48:63], a[176:179], v[152:155], v[48:63]
    s_waitcnt lgkmcnt(4)
    ds_read_b64_tr_b16 a[192:193], v9 offset:10240
    ds_read_b64_tr_b16 a[194:195], v9 offset:10752
    v_cndmask_b32 v222, v194, v254, s[92:93]
    v_cndmask_b32 v223, v194, v254, s[94:95]
    v_cndmask_b32 v197, v254, v195, s[92:93]
    v_cndmask_b32 v198, v254, v196, s[94:95]
    v_mfma_f32_32x32x16_bf16 v[48:63], a[180:183], v[156:159], v[48:63]
    s_waitcnt lgkmcnt(4)
    ds_read_b64_tr_b16 a[196:197], v9 offset:11264
    ds_read_b64_tr_b16 a[198:199], v9 offset:11776
    v_cvt_pk_bf16_f32 v20, v20, v21
    v_accvgpr_write_b32 a20, v20
    v_mul_f32_e32 v22, v5, v42
    v_mul_f32_e64 v23, v5, v43
    v_cvt_pk_bf16_f32 v22, v22, v23
    v_mfma_f32_32x32x16_bf16 v[48:63], a[184:187], v[160:163], v[48:63]
    s_waitcnt lgkmcnt(4)
    ds_read_b64_tr_b16 a[176:177], v9 offset:12288
    ds_read_b64_tr_b16 a[178:179], v9 offset:12800
    v_or_b32_e32 v235, v197, v198
    v_add_u32_e32 v197, 8, v192
    v_add_u32_e32 v198, 7, v192
    v_accvgpr_write_b32 a21, v22
    v_mul_f32_e32 v20, v5, v44
    v_mfma_f32_32x32x16_bf16 v[48:63], a[188:191], v[164:167], v[48:63]
    s_waitcnt lgkmcnt(4)
    ds_read_b64_tr_b16 a[180:181], v9 offset:13312
    ds_read_b64_tr_b16 a[182:183], v9 offset:13824
    v_cmp_gt_u32 s[92:93], s10, v197
    v_cmp_gt_u32 s[94:95], s10, v198
    s_nop 0
    v_cndmask_b32 v224, v194, v254, s[92:93]
    v_mfma_f32_32x32x16_bf16 v[48:63], a[192:195], v[168:171], v[48:63]
    s_waitcnt lgkmcnt(4)
    ds_read_b64_tr_b16 a[184:185], v9 offset:14336
    ds_read_b64_tr_b16 a[186:187], v9 offset:14848
    v_cndmask_b32 v225, v194, v254, s[94:95]
    v_cndmask_b32 v197, v254, v195, s[92:93]
    v_cndmask_b32 v198, v254, v196, s[94:95]
    v_or_b32_e32 v236, v197, v198
    v_mfma_f32_32x32x16_bf16 v[48:63], a[196:199], v[172:175], v[48:63]
    s_waitcnt lgkmcnt(4)
    ds_read_b64_tr_b16 a[188:189], v9 offset:15360
    ds_read_b64_tr_b16 a[190:191], v9 offset:15872
    v_mul_f32_e64 v21, v5, v45
    v_cvt_pk_bf16_f32 v20, v20, v21
    v_accvgpr_write_b32 a22, v20
    v_mul_f32_e64 v22, v5, v46
    v_mfma_f32_32x32x16_bf16 v[48:63], a[176:179], v[176:179], v[48:63]
    s_waitcnt lgkmcnt(4)
    v_add_u32_e32 v197, 6, v192
    v_add_u32_e32 v198, 5, v192
    v_cmp_gt_u32 s[92:93], s10, v197
    v_cmp_gt_u32 s[94:95], s10, v198
    s_nop 0
    v_mfma_f32_32x32x16_bf16 v[48:63], a[180:183], v[180:183], v[48:63]
    s_waitcnt vmcnt(8) lgkmcnt(0)
    s_barrier
    ds_read_b64_tr_b16 a[192:193], v9 offset:32768
    ds_read_b64_tr_b16 a[194:195], v9 offset:33280
    ds_read_b64_tr_b16 a[196:197], v9 offset:33792
    ds_read_b64_tr_b16 a[198:199], v9 offset:34304
    v_cndmask_b32 v226, v194, v254, s[92:93]
    v_cndmask_b32 v227, v194, v254, s[94:95]
    v_cndmask_b32 v197, v254, v195, s[92:93]
    v_cndmask_b32 v198, v254, v196, s[94:95]
    v_mfma_f32_32x32x16_bf16 v[48:63], a[184:187], v[184:187], v[48:63]
    ds_read_b64_tr_b16 a[176:177], v9 offset:34816
    ds_read_b64_tr_b16 a[178:179], v9 offset:35328
    v_mul_f32_e64 v23, v5, v47
    v_cvt_pk_bf16_f32 v22, v22, v23
    v_accvgpr_write_b32 a23, v22
    v_or_b32_e64 v237, v197, v198
    v_mfma_f32_32x32x16_bf16 v[48:63], a[188:191], v[188:191], v[48:63]
    s_waitcnt lgkmcnt(4)
    ds_read_b64_tr_b16 a[180:181], v9 offset:35840
    ds_read_b64_tr_b16 a[182:183], v9 offset:36352
    s_lshl_b32 s7, s63, 15
    s_lshl_b32 s69, s60, 12
    s_add_u32 s7, s7, s69
    s_add_u32 s7, s7, 0x400000
    v_mfma_f32_32x32x16_bf16 v[32:47], v[64:67], a[192:195], 0
    s_waitcnt lgkmcnt(4)
    s_add_u32 m0, s74, 0x0
    s_add_u32 s81, s75, 0xe0000
    buffer_load_dwordx4 v10, s[28:31], s81 offen offset:0 lds
    ds_read_b64_tr_b16 a[184:185], v9 offset:36864
    ds_read_b64_tr_b16 a[186:187], v9 offset:37376
    v_mfma_f32_32x32x16_bf16 v[32:47], v[68:71], a[196:199], v[32:47]
    s_waitcnt lgkmcnt(4)
    ds_read_b64_tr_b16 a[188:189], v9 offset:37888
    ds_read_b64_tr_b16 a[190:191], v9 offset:38400
    v_lshrrev_b32_e32 v240, 5, v0
    v_lshlrev_b32_e32 v240, 4, v240
    v_mfma_f32_32x32x16_bf16 v[32:47], v[72:75], a[176:179], v[32:47]
    s_waitcnt lgkmcnt(4)
    buffer_load_dwordx4 v11, s[28:31], s81 offen offset:1024 lds
    ds_read_b64_tr_b16 a[192:193], v9 offset:38912
    ds_read_b64_tr_b16 a[194:195], v9 offset:39424
    ds_bpermute_b32 v192, v240, v5 offset:0
    v_mfma_f32_32x32x16_bf16 v[32:47], v[76:79], a[180:183], v[32:47]
    s_waitcnt lgkmcnt(5)
    ds_read_b64_tr_b16 a[196:197], v9 offset:39936
    ds_read_b64_tr_b16 a[198:199], v9 offset:40448
    ds_bpermute_b32 v193, v240, v5 offset:4
    v_add_u32_e32 v239, 0x20000, v8
    v_mfma_f32_32x32x16_bf16 v[32:47], v[80:83], a[184:187], v[32:47]
    s_waitcnt lgkmcnt(6)
    buffer_load_dwordx4 v12, s[28:31], s81 offen offset:2048 lds
    ds_read_b64_tr_b16 a[176:177], v239 offset:0
    ds_read_b64_tr_b16 a[178:179], v239 offset:512
    ds_bpermute_b32 v194, v240, v5 offset:8
    v_mfma_f32_32x32x16_bf16 v[32:47], v[84:87], a[188:191], v[32:47]
    s_waitcnt lgkmcnt(7)
    ds_read_b64_tr_b16 a[180:181], v239 offset:1024
    ds_read_b64_tr_b16 a[182:183], v239 offset:1536
    ds_bpermute_b32 v195, v240, v5 offset:12
    v_mfma_f32_32x32x16_bf16 v[32:47], v[88:91], a[192:195], v[32:47]
    s_waitcnt lgkmcnt(7)
    buffer_load_dwordx4 v13, s[28:31], s81 offen offset:3072 lds
    ds_read_b64_tr_b16 a[184:185], v239 offset:2048
    ds_read_b64_tr_b16 a[186:187], v239 offset:2560
    ds_bpermute_b32 v196, v240, v5 offset:32
    v_mfma_f32_32x32x16_bf16 v[32:47], v[92:95], a[196:199], v[32:47]
    s_waitcnt lgkmcnt(7)
    ds_read_b64_tr_b16 a[188:189], v239 offset:3072
    ds_read_b64_tr_b16 a[190:191], v239 offset:3584
    ds_bpermute_b32 v197, v240, v5 offset:36
    v_mfma_f32_32x32x16_bf16 v[32:47], v[96:99], a[176:179], v[32:47]
    s_waitcnt lgkmcnt(7)
    s_add_u32 m0, s74, 0x4000
    s_add_u32 s81, s75, 0x150000
    buffer_load_dwordx4 v10, s[28:31], s81 offen offset:0 lds
    ds_read_b64_tr_b16 a[192:193], v239 offset:4096
    ds_read_b64_tr_b16 a[194:195], v239 offset:4608
    v_mfma_f32_32x32x16_bf16 v[32:47], v[100:103], a[180:183], v[32:47]
    s_waitcnt lgkmcnt(6)
    ds_read_b64_tr_b16 a[196:197], v239 offset:5120
    ds_read_b64_tr_b16 a[198:199], v239 offset:5632
    ds_bpermute_b32 v198, v240, v5 offset:40
    v_mfma_f32_32x32x16_bf16 v[32:47], v[104:107], a[184:187], v[32:47]
    s_waitcnt lgkmcnt(6)
    buffer_load_dwordx4 v11, s[28:31], s81 offen offset:1024 lds
    ds_read_b64_tr_b16 a[176:177], v239 offset:6144
    ds_read_b64_tr_b16 a[178:179], v239 offset:6656
    ds_bpermute_b32 v199, v240, v5 offset:44
    v_mfma_f32_32x32x16_bf16 v[32:47], v[108:111], a[188:191], v[32:47]
    s_waitcnt lgkmcnt(6)
    ds_read_b64_tr_b16 a[180:181], v239 offset:7168
    ds_read_b64_tr_b16 a[182:183], v239 offset:7680
    ds_bpermute_b32 v200, v240, v5 offset:64
    v_mfma_f32_32x32x16_bf16 v[32:47], v[112:115], a[192:195], v[32:47]
    s_waitcnt lgkmcnt(7)
    buffer_load_dwordx4 v12, s[28:31], s81 offen offset:2048 lds
    ds_read_b64_tr_b16 a[184:185], v8 offset:49152
    ds_read_b64_tr_b16 a[186:187], v8 offset:49664
    ds_bpermute_b32 v201, v240, v5 offset:68
    v_mfma_f32_32x32x16_bf16 v[32:47], v[116:119], a[196:199], v[32:47]
    s_waitcnt lgkmcnt(7)
    ds_read_b64_tr_b16 a[188:189], v8 offset:50176
    ds_read_b64_tr_b16 a[190:191], v8 offset:50688
    ds_bpermute_b32 v202, v240, v5 offset:72
    v_mfma_f32_32x32x16_bf16 v[32:47], v[120:123], a[176:179], v[32:47]
    s_waitcnt lgkmcnt(7)
    buffer_load_dwordx4 v13, s[28:31], s81 offen offset:3072 lds
    ds_read_b64_tr_b16 a[192:193], v8 offset:51200
    ds_read_b64_tr_b16 a[194:195], v8 offset:51712
    ds_bpermute_b32 v203, v240, v5 offset:76
    v_mfma_f32_32x32x16_bf16 v[32:47], v[124:127], a[180:183], v[32:47]
    s_waitcnt lgkmcnt(7)
    ds_read_b64_tr_b16 a[196:197], v8 offset:52224
    ds_read_b64_tr_b16 a[198:199], v8 offset:52736
    ds_bpermute_b32 v204, v240, v5 offset:96
    v_mfma_f32_32x32x16_bf16 v[32:47], v[128:131], a[184:187], v[32:47]
    s_waitcnt lgkmcnt(7)
    ds_read_b64_tr_b16 a[176:177], v8 offset:53248
    ds_read_b64_tr_b16 a[178:179], v8 offset:53760
    ds_bpermute_b32 v205, v240, v5 offset:100
    v_mfma_f32_32x32x16_bf16 v[32:47], v[132:135], a[188:191], v[32:47]
    s_waitcnt lgkmcnt(7)
    ds_read_b64_tr_b16 a[180:181], v8 offset:54272
    ds_read_b64_tr_b16 a[182:183], v8 offset:54784
    ds_bpermute_b32 v206, v240, v5 offset:104
    v_mfma_f32_32x32x16_bf16 v[32:47], v[136:139], a[192:195], v[32:47]
    s_waitcnt lgkmcnt(7)
    ds_read_b64_tr_b16 a[184:185], v8 offset:55296
    ds_read_b64_tr_b16 a[186:187], v8 offset:55808
    ds_bpermute_b32 v207, v240, v5 offset:108
    v_mfma_f32_32x32x16_bf16 v[32:47], v[140:143], a[196:199], v[32:47]
    s_waitcnt lgkmcnt(7)
    ds_read_b64_tr_b16 a[188:189], v8 offset:56320
    ds_read_b64_tr_b16 a[190:191], v8 offset:56832
    v_mul_f32_e32 v20, v5, v48
    v_mul_f32_e64 v21, v5, v49
    v_cvt_pk_bf16_f32 v20, v20, v21
    v_add_u32_e32 v9, 0x10000, v8
    v_mfma_f32_32x32x16_bf16 v[32:47], v[144:147], a[176:179], v[32:47]
    s_waitcnt lgkmcnt(6)
    ds_read_b64_tr_b16 a[192:193], v9 offset:16384
    ds_read_b64_tr_b16 a[194:195], v9 offset:16896
    v_accvgpr_write_b32 a24, v20
    v_mul_f32_e32 v22, v5, v50
    v_mul_f32_e32 v23, v5, v51
    v_cvt_pk_bf16_f32 v22, v22, v23
    v_mfma_f32_32x32x16_bf16 v[32:47], v[148:151], a[180:183], v[32:47]
    s_waitcnt lgkmcnt(5)
    ds_read_b64_tr_b16 a[196:197], v9 offset:17408
    ds_read_b64_tr_b16 a[198:199], v9 offset:17920
    v_accvgpr_write_b32 a25, v22
    v_mul_f32_e64 v20, v5, v52
    v_mul_f32_e32 v21, v5, v53
    v_cvt_pk_bf16_f32 v20, v20, v21
    v_mfma_f32_32x32x16_bf16 v[32:47], v[152:155], a[184:187], v[32:47]
    s_waitcnt lgkmcnt(4)
    ds_read_b64_tr_b16 a[176:177], v9 offset:18432
    ds_read_b64_tr_b16 a[178:179], v9 offset:18944
    v_accvgpr_write_b32 a26, v20
    v_mul_f32_e64 v22, v5, v54
    v_mul_f32_e32 v23, v5, v55
    v_cvt_pk_bf16_f32 v22, v22, v23
    v_mfma_f32_32x32x16_bf16 v[32:47], v[156:159], a[188:191], v[32:47]
    s_waitcnt lgkmcnt(4)
    ds_read_b64_tr_b16 a[180:181], v9 offset:19456
    ds_read_b64_tr_b16 a[182:183], v9 offset:19968
    v_accvgpr_write_b32 a27, v22
    v_mul_f32_e64 v20, v5, v56
    v_mul_f32_e32 v21, v5, v57
    v_cvt_pk_bf16_f32 v20, v20, v21
    v_mfma_f32_32x32x16_bf16 v[32:47], v[160:163], a[192:195], v[32:47]
    s_waitcnt lgkmcnt(4)
    ds_read_b64_tr_b16 a[184:185], v9 offset:20480
    ds_read_b64_tr_b16 a[186:187], v9 offset:20992
    v_accvgpr_write_b32 a28, v20
    v_mul_f32_e64 v22, v5, v58
    v_mul_f32_e32 v23, v5, v59
    v_cvt_pk_bf16_f32 v22, v22, v23
    v_mfma_f32_32x32x16_bf16 v[32:47], v[164:167], a[196:199], v[32:47]
    s_waitcnt lgkmcnt(4)
    ds_read_b64_tr_b16 a[188:189], v9 offset:21504
    ds_read_b64_tr_b16 a[190:191], v9 offset:22016
    v_accvgpr_write_b32 a29, v22
    v_mul_f32_e64 v20, v5, v60
    v_mul_f32_e32 v21, v5, v61
    v_cvt_pk_bf16_f32 v20, v20, v21
    v_mfma_f32_32x32x16_bf16 v[32:47], v[168:171], a[176:179], v[32:47]
    s_waitcnt lgkmcnt(4)
    ds_read_b64_tr_b16 a[192:193], v9 offset:22528
    ds_read_b64_tr_b16 a[194:195], v9 offset:23040
    v_accvgpr_write_b32 a30, v20
    v_mul_f32_e64 v22, v5, v62
    v_mul_f32_e32 v23, v5, v63
    v_cvt_pk_bf16_f32 v22, v22, v23
    v_mfma_f32_32x32x16_bf16 v[32:47], v[172:175], a[180:183], v[32:47]
    s_waitcnt lgkmcnt(4)
    ds_read_b64_tr_b16 a[196:197], v9 offset:23552
    ds_read_b64_tr_b16 a[198:199], v9 offset:24064
    v_accvgpr_write_b32 a31, v22
    v_mfma_f32_32x32x16_bf16 v[32:47], v[176:179], a[184:187], v[32:47]
    s_waitcnt lgkmcnt(4)
    ds_read_b64_tr_b16 a[176:177], v9 offset:40960
    ds_read_b64_tr_b16 a[178:179], v9 offset:41472
    v_mfma_f32_32x32x16_bf16 v[32:47], v[180:183], a[188:191], v[32:47]
    s_waitcnt lgkmcnt(4)
    ds_read_b64_tr_b16 a[180:181], v9 offset:41984
    ds_read_b64_tr_b16 a[182:183], v9 offset:42496
    v_mfma_f32_32x32x16_bf16 v[32:47], v[184:187], a[192:195], v[32:47]
    s_waitcnt lgkmcnt(4)
    ds_read_b64_tr_b16 a[184:185], v9 offset:43008
    ds_read_b64_tr_b16 a[186:187], v9 offset:43520
    v_mfma_f32_32x32x16_bf16 v[32:47], v[188:191], a[196:199], v[32:47]
    s_waitcnt lgkmcnt(4)
    ds_read_b64_tr_b16 a[188:189], v9 offset:44032
    ds_read_b64_tr_b16 a[190:191], v9 offset:44544
    v_mfma_f32_32x32x16_bf16 v[48:63], v[64:67], a[176:179], 0
    s_waitcnt lgkmcnt(4)
    s_add_u32 m0, s74, 0x8000
    s_add_u32 s81, s75, 0x40
    buffer_load_dwordx4 v10, s[28:31], s81 offen offset:0 lds
    ds_read_b64_tr_b16 a[192:193], v9 offset:45056
    ds_read_b64_tr_b16 a[194:195], v9 offset:45568
    v_mfma_f32_32x32x16_bf16 v[48:63], v[68:71], a[180:183], v[48:63]
    s_waitcnt lgkmcnt(4)
    ds_read_b64_tr_b16 a[196:197], v9 offset:46080
    ds_read_b64_tr_b16 a[198:199], v9 offset:46592
    v_and_b32_e32 v29, 31, v0
    v_mfma_f32_32x32x16_bf16 v[48:63], v[72:75], a[184:187], v[48:63]
    s_waitcnt lgkmcnt(4)
    buffer_load_dwordx4 v11, s[28:31], s81 offen offset:1024 lds
    ds_read_b64_tr_b16 a[176:177], v9 offset:47104
    ds_read_b64_tr_b16 a[178:179], v9 offset:47616
    v_mfma_f32_32x32x16_bf16 v[48:63], v[76:79], a[188:191], v[48:63]
    s_waitcnt lgkmcnt(4)
    ds_read_b64_tr_b16 a[180:181], v9 offset:48128
    ds_read_b64_tr_b16 a[182:183], v9 offset:48640
    v_mul_f32_e32 v20, v192, v32
    v_mul_f32_e32 v21, v193, v33
    v_add_u32_e32 v239, 0x20000, v8
    v_mfma_f32_32x32x16_bf16 v[48:63], v[80:83], a[192:195], v[48:63]
    s_waitcnt lgkmcnt(4)
    buffer_load_dwordx4 v12, s[28:31], s81 offen offset:2048 lds
    ds_read_b64_tr_b16 a[184:185], v239 offset:8192
    ds_read_b64_tr_b16 a[186:187], v239 offset:8704
    v_cvt_pk_bf16_f32 v20, v20, v21
    v_mfma_f32_32x32x16_bf16 v[48:63], v[84:87], a[196:199], v[48:63]
    s_waitcnt lgkmcnt(4)
    ds_read_b64_tr_b16 a[188:189], v239 offset:9216
    ds_read_b64_tr_b16 a[190:191], v239 offset:9728
    v_accvgpr_write_b32 a32, v20
    v_mul_f32_e64 v22, v194, v34
    v_mul_f32_e32 v23, v195, v35
    v_cvt_pk_bf16_f32 v22, v22, v23
    v_mfma_f32_32x32x16_bf16 v[48:63], v[88:91], a[176:179], v[48:63]
    s_waitcnt lgkmcnt(4)
    buffer_load_dwordx4 v13, s[28:31], s81 offen offset:3072 lds
    ds_read_b64_tr_b16 a[192:193], v239 offset:10240
    ds_read_b64_tr_b16 a[194:195], v239 offset:10752
    v_accvgpr_write_b32 a33, v22
    v_mfma_f32_32x32x16_bf16 v[48:63], v[92:95], a[180:183], v[48:63]
    s_waitcnt lgkmcnt(4)
    ds_read_b64_tr_b16 a[196:197], v239 offset:11264
    ds_read_b64_tr_b16 a[198:199], v239 offset:11776
    v_mul_f32_e32 v20, v196, v36
    v_mul_f32_e64 v21, v197, v37
    v_cvt_pk_bf16_f32 v20, v20, v21
    v_accvgpr_write_b32 a34, v20
    v_mfma_f32_32x32x16_bf16 v[48:63], v[96:99], a[184:187], v[48:63]
    s_waitcnt lgkmcnt(4)
    s_add_u32 m0, s74, 0x10000
    s_add_u32 s81, s75, 0x70040
    buffer_load_dwordx4 v10, s[28:31], s81 offen offset:0 lds
    ds_read_b64_tr_b16 a[176:177], v239 offset:12288
    ds_read_b64_tr_b16 a[178:179], v239 offset:12800
    v_mfma_f32_32x32x16_bf16 v[48:63], v[100:103], a[188:191], v[48:63]
    s_waitcnt lgkmcnt(4)
    ds_read_b64_tr_b16 a[180:181], v239 offset:13312
    ds_read_b64_tr_b16 a[182:183], v239 offset:13824
    v_mul_f32_e32 v22, v198, v38
    v_mul_f32_e32 v23, v199, v39
    v_cvt_pk_bf16_f32 v22, v22, v23
    v_accvgpr_write_b32 a35, v22
    v_mfma_f32_32x32x16_bf16 v[48:63], v[104:107], a[192:195], v[48:63]
    s_waitcnt lgkmcnt(4)
    buffer_load_dwordx4 v11, s[28:31], s81 offen offset:1024 lds
    ds_read_b64_tr_b16 a[184:185], v239 offset:14336
    ds_read_b64_tr_b16 a[186:187], v239 offset:14848
    v_mul_f32_e32 v20, v200, v40
    v_mfma_f32_32x32x16_bf16 v[48:63], v[108:111], a[196:199], v[48:63]
    s_waitcnt lgkmcnt(4)
    ds_read_b64_tr_b16 a[188:189], v239 offset:15360
    ds_read_b64_tr_b16 a[190:191], v239 offset:15872
    v_mul_f32_e32 v21, v201, v41
    v_cvt_pk_bf16_f32 v20, v20, v21
    v_accvgpr_write_b32 a36, v20
    v_mul_f32_e32 v22, v202, v42
    v_mfma_f32_32x32x16_bf16 v[48:63], v[112:115], a[176:179], v[48:63]
    s_waitcnt lgkmcnt(4)
    buffer_load_dwordx4 v12, s[28:31], s81 offen offset:2048 lds
    ds_read_b64_tr_b16 a[192:193], v8 offset:57344
    ds_read_b64_tr_b16 a[194:195], v8 offset:57856
    v_mul_f32_e32 v23, v203, v43
    v_mfma_f32_32x32x16_bf16 v[48:63], v[116:119], a[180:183], v[48:63]
    s_waitcnt lgkmcnt(4)
    ds_read_b64_tr_b16 a[196:197], v8 offset:58368
    ds_read_b64_tr_b16 a[198:199], v8 offset:58880
    v_cvt_pk_bf16_f32 v22, v22, v23
    v_accvgpr_write_b32 a37, v22
    v_mul_f32_e64 v20, v204, v44
    v_mul_f32_e32 v21, v205, v45
    v_mfma_f32_32x32x16_bf16 v[48:63], v[120:123], a[184:187], v[48:63]
    s_waitcnt lgkmcnt(4)
    buffer_load_dwordx4 v13, s[28:31], s81 offen offset:3072 lds
    ds_read_b64_tr_b16 a[176:177], v8 offset:59392
    ds_read_b64_tr_b16 a[178:179], v8 offset:59904
    v_cvt_pk_bf16_f32 v20, v20, v21
    v_mfma_f32_32x32x16_bf16 v[48:63], v[124:127], a[188:191], v[48:63]
    s_waitcnt lgkmcnt(4)
    ds_read_b64_tr_b16 a[180:181], v8 offset:60416
    ds_read_b64_tr_b16 a[182:183], v8 offset:60928
    v_accvgpr_write_b32 a38, v20
    v_mul_f32_e32 v22, v206, v46
    v_mul_f32_e64 v23, v207, v47
    v_cvt_pk_bf16_f32 v22, v22, v23
    v_mfma_f32_32x32x16_bf16 v[48:63], v[128:131], a[192:195], v[48:63]
    s_waitcnt lgkmcnt(4)
    ds_read_b64_tr_b16 a[184:185], v8 offset:61440
    ds_read_b64_tr_b16 a[186:187], v8 offset:61952
    v_cmp_lt_u32 vcc, 23, v29
    v_mov_b32_e32 v29, 0x7ffffff0
    s_nop 0
    v_cndmask_b32 v29, v29, v1, vcc
    v_mfma_f32_32x32x16_bf16 v[48:63], v[132:135], a[196:199], v[48:63]
    s_waitcnt lgkmcnt(4)
    ds_read_b64_tr_b16 a[188:189], v8 offset:62464
    ds_read_b64_tr_b16 a[190:191], v8 offset:62976
    v_accvgpr_write_b32 a168, 0
    v_accvgpr_write_b32 a169, 0
    v_accvgpr_write_b32 a172, 0
    v_accvgpr_write_b32 a173, 0
    v_mfma_f32_32x32x16_bf16 v[48:63], v[136:139], a[176:179], v[48:63]
    s_waitcnt lgkmcnt(4)
    ds_read_b64_tr_b16 a[192:193], v8 offset:63488
    ds_read_b64_tr_b16 a[194:195], v8 offset:64000
    v_accvgpr_write_b32 a39, v22
    v_mfma_f32_32x32x16_bf16 v[48:63], v[140:143], a[180:183], v[48:63]
    s_waitcnt lgkmcnt(4)
    ds_read_b64_tr_b16 a[196:197], v8 offset:64512
    ds_read_b64_tr_b16 a[198:199], v8 offset:65024
    v_add_u32_e32 v9, 0x10000, v8
    v_mfma_f32_32x32x16_bf16 v[48:63], v[144:147], a[184:187], v[48:63]
    s_waitcnt lgkmcnt(4)
    ds_read_b64_tr_b16 a[176:177], v9 offset:24576
    ds_read_b64_tr_b16 a[178:179], v9 offset:25088
    v_mfma_f32_32x32x16_bf16 v[48:63], v[148:151], a[188:191], v[48:63]
    s_waitcnt lgkmcnt(4)
    ds_read_b64_tr_b16 a[180:181], v9 offset:25600
    ds_read_b64_tr_b16 a[182:183], v9 offset:26112
    v_mfma_f32_32x32x16_bf16 v[48:63], v[152:155], a[192:195], v[48:63]
    s_waitcnt lgkmcnt(4)
    ds_read_b64_tr_b16 a[184:185], v9 offset:26624
    ds_read_b64_tr_b16 a[186:187], v9 offset:27136
    v_mfma_f32_32x32x16_bf16 v[48:63], v[156:159], a[196:199], v[48:63]
    s_waitcnt lgkmcnt(4)
    ds_read_b64_tr_b16 a[188:189], v9 offset:27648
    ds_read_b64_tr_b16 a[190:191], v9 offset:28160
    v_mfma_f32_32x32x16_bf16 v[48:63], v[160:163], a[176:179], v[48:63]
    s_waitcnt lgkmcnt(4)
    ds_read_b64_tr_b16 a[192:193], v9 offset:28672
    ds_read_b64_tr_b16 a[194:195], v9 offset:29184
    v_mfma_f32_32x32x16_bf16 v[48:63], v[164:167], a[180:183], v[48:63]
    s_waitcnt lgkmcnt(4)
    ds_read_b64_tr_b16 a[196:197], v9 offset:29696
    ds_read_b64_tr_b16 a[198:199], v9 offset:30208
    v_mfma_f32_32x32x16_bf16 v[48:63], v[168:171], a[184:187], v[48:63]
    s_waitcnt lgkmcnt(4)
    ds_read_b64_tr_b16 a[176:177], v9 offset:30720
    ds_read_b64_tr_b16 a[178:179], v9 offset:31232
    v_mfma_f32_32x32x16_bf16 v[48:63], v[172:175], a[188:191], v[48:63]
    s_waitcnt lgkmcnt(4)
    ds_read_b64_tr_b16 a[180:181], v9 offset:31744
    ds_read_b64_tr_b16 a[182:183], v9 offset:32256
    v_mfma_f32_32x32x16_bf16 v[48:63], v[176:179], a[192:195], v[48:63]
    s_waitcnt lgkmcnt(4)
    v_add_u32_e32 v239, 0x10000, v6
    v_mfma_f32_32x32x16_bf16 v[48:63], v[180:183], a[196:199], v[48:63]
    s_waitcnt vmcnt(8) lgkmcnt(0)
    s_barrier
    ds_read_b64_tr_b16 a[184:185], v239 offset:49152
    ds_read_b64_tr_b16 a[186:187], v239 offset:49664
    ds_read_b64_tr_b16 a[188:189], v239 offset:50176
    ds_read_b64_tr_b16 a[190:191], v239 offset:50688
    v_mfma_f32_32x32x16_bf16 v[48:63], v[184:187], a[176:179], v[48:63]
    ds_read_b64_tr_b16 a[192:193], v239 offset:51200
    ds_read_b64_tr_b16 a[194:195], v239 offset:51712
    v_mfma_f32_32x32x16_bf16 v[48:63], v[188:191], a[180:183], v[48:63]
    s_waitcnt lgkmcnt(4)
    ds_read_b64_tr_b16 a[196:197], v239 offset:52224
    ds_read_b64_tr_b16 a[198:199], v239 offset:52736
    v_mfma_f32_32x32x16_bf16 v[32:47], a[184:187], v[64:67], 0
    s_waitcnt lgkmcnt(4)
    s_add_u32 m0, s74, 0x18000
    s_add_u32 s81, s75, 0xe0040
    buffer_load_dwordx4 v10, s[28:31], s81 offen offset:0 lds
    ds_read_b64_tr_b16 a[176:177], v239 offset:53248
    ds_read_b64_tr_b16 a[178:179], v239 offset:53760
    v_mfma_f32_32x32x16_bf16 v[32:47], a[188:191], v[68:71], v[32:47]
    s_waitcnt lgkmcnt(4)
    ds_read_b64_tr_b16 a[180:181], v239 offset:54272
    ds_read_b64_tr_b16 a[182:183], v239 offset:54784
    v_mfma_f32_32x32x16_bf16 v[32:47], a[192:195], v[72:75], v[32:47]
    s_waitcnt lgkmcnt(4)
    buffer_load_dwordx4 v11, s[28:31], s81 offen offset:1024 lds
    ds_read_b64_tr_b16 a[184:185], v239 offset:55296
    ds_read_b64_tr_b16 a[186:187], v239 offset:55808
    v_mfma_f32_32x32x16_bf16 v[32:47], a[196:199], v[76:79], v[32:47]
    s_waitcnt lgkmcnt(4)
    ds_read_b64_tr_b16 a[188:189], v239 offset:56320
    ds_read_b64_tr_b16 a[190:191], v239 offset:56832
    v_mul_f32_e32 v20, v192, v48
    v_mul_f32_e64 v21, v193, v49
    v_add_u32_e32 v9, 0x20000, v6
    v_mfma_f32_32x32x16_bf16 v[32:47], a[176:179], v[80:83], v[32:47]
    s_waitcnt lgkmcnt(4)
    buffer_load_dwordx4 v12, s[28:31], s81 offen offset:2048 lds
    ds_read_b64_tr_b16 a[192:193], v9 offset:16384
    ds_read_b64_tr_b16 a[194:195], v9 offset:16896
    v_cvt_pk_bf16_f32 v20, v20, v21
    v_mfma_f32_32x32x16_bf16 v[32:47], a[180:183], v[84:87], v[32:47]
    s_waitcnt lgkmcnt(4)
    ds_read_b64_tr_b16 a[196:197], v9 offset:17408
    ds_read_b64_tr_b16 a[198:199], v9 offset:17920
    v_accvgpr_write_b32 a40, v20
    v_mul_f32_e64 v22, v194, v50
    v_mul_f32_e32 v23, v195, v51
    v_cvt_pk_bf16_f32 v22, v22, v23
    v_mfma_f32_32x32x16_bf16 v[32:47], a[184:187], v[88:91], v[32:47]
    s_waitcnt lgkmcnt(4)
    buffer_load_dwordx4 v13, s[28:31], s81 offen offset:3072 lds
    ds_read_b64_tr_b16 a[176:177], v9 offset:18432
    ds_read_b64_tr_b16 a[178:179], v9 offset:18944
    v_accvgpr_write_b32 a41, v22
    v_mfma_f32_32x32x16_bf16 v[32:47], a[188:191], v[92:95], v[32:47]
    s_waitcnt lgkmcnt(4)
    ds_read_b64_tr_b16 a[180:181], v9 offset:19456
    ds_read_b64_tr_b16 a[182:183], v9 offset:19968
    v_mul_f32_e32 v20, v196, v52
    v_mul_f32_e64 v21, v197, v53
    v_cvt_pk_bf16_f32 v20, v20, v21
    v_accvgpr_write_b32 a42, v20
    v_mfma_f32_32x32x16_bf16 v[32:47], a[192:195], v[96:99], v[32:47]
    s_waitcnt lgkmcnt(4)
    s_add_u32 m0, s74, 0x20000
    s_add_u32 s81, s75, 0x150040
    buffer_load_dwordx4 v10, s[28:31], s81 offen offset:0 lds
    ds_read_b64_tr_b16 a[184:185], v9 offset:20480
    ds_read_b64_tr_b16 a[186:187], v9 offset:20992
    v_mfma_f32_32x32x16_bf16 v[32:47], a[196:199], v[100:103], v[32:47]
    s_waitcnt lgkmcnt(4)
    ds_read_b64_tr_b16 a[188:189], v9 offset:21504
    ds_read_b64_tr_b16 a[190:191], v9 offset:22016
    v_mul_f32_e32 v22, v198, v54
    v_mul_f32_e32 v23, v199, v55
    v_cvt_pk_bf16_f32 v22, v22, v23
    v_accvgpr_write_b32 a43, v22
    v_mfma_f32_32x32x16_bf16 v[32:47], a[176:179], v[104:107], v[32:47]
    s_waitcnt lgkmcnt(4)
    buffer_load_dwordx4 v11, s[28:31], s81 offen offset:1024 lds
    ds_read_b64_tr_b16 a[192:193], v9 offset:22528
    ds_read_b64_tr_b16 a[194:195], v9 offset:23040
    v_mul_f32_e32 v20, v200, v56
    v_mfma_f32_32x32x16_bf16 v[32:47], a[180:183], v[108:111], v[32:47]
    s_waitcnt lgkmcnt(4)
    ds_read_b64_tr_b16 a[196:197], v9 offset:23552
    ds_read_b64_tr_b16 a[198:199], v9 offset:24064
    v_mul_f32_e32 v21, v201, v57
    v_cvt_pk_bf16_f32 v20, v20, v21
    v_accvgpr_write_b32 a44, v20
    v_mul_f32_e32 v22, v202, v58
    v_mfma_f32_32x32x16_bf16 v[32:47], a[184:187], v[112:115], v[32:47]
    s_waitcnt lgkmcnt(4)
    buffer_load_dwordx4 v12, s[28:31], s81 offen offset:2048 lds
    ds_read_b64_tr_b16 a[176:177], v6 offset:0
    ds_read_b64_tr_b16 a[178:179], v6 offset:512
    v_mul_f32_e32 v23, v203, v59
    v_mfma_f32_32x32x16_bf16 v[32:47], a[188:191], v[116:119], v[32:47]
    s_waitcnt lgkmcnt(4)
    ds_read_b64_tr_b16 a[180:181], v6 offset:1024
    ds_read_b64_tr_b16 a[182:183], v6 offset:1536
    v_cvt_pk_bf16_f32 v22, v22, v23
    v_accvgpr_write_b32 a45, v22
    v_mul_f32_e64 v20, v204, v60
    v_mul_f32_e32 v21, v205, v61
    v_mfma_f32_32x32x16_bf16 v[32:47], a[192:195], v[120:123], v[32:47]
    s_waitcnt lgkmcnt(4)
    buffer_load_dwordx4 v13, s[28:31], s81 offen offset:3072 lds
    ds_read_b64_tr_b16 a[184:185], v6 offset:2048
    ds_read_b64_tr_b16 a[186:187], v6 offset:2560
    v_cvt_pk_bf16_f32 v20, v20, v21
    v_mfma_f32_32x32x16_bf16 v[32:47], a[196:199], v[124:127], v[32:47]
    s_waitcnt lgkmcnt(4)
    ds_read_b64_tr_b16 a[188:189], v6 offset:3072
    ds_read_b64_tr_b16 a[190:191], v6 offset:3584
    v_accvgpr_write_b32 a46, v20
    v_mul_f32_e32 v22, v206, v62
    v_mul_f32_e64 v23, v207, v63
    v_cvt_pk_bf16_f32 v22, v22, v23
    v_mfma_f32_32x32x16_bf16 v[32:47], a[176:179], v[128:131], v[32:47]
    s_waitcnt lgkmcnt(4)
    buffer_load_dword v238, v28, s[36:39], s14 offen
    ds_read_b64_tr_b16 a[192:193], v6 offset:4096
    ds_read_b64_tr_b16 a[194:195], v6 offset:4608
    v_accvgpr_write_b32 a47, v22
    v_mfma_f32_32x32x16_bf16 v[32:47], a[180:183], v[132:135], v[32:47]
    s_waitcnt lgkmcnt(4)
    ds_read_b64_tr_b16 a[196:197], v6 offset:5120
    ds_read_b64_tr_b16 a[198:199], v6 offset:5632
    v_mfma_f32_32x32x16_bf16 v[32:47], a[184:187], v[136:139], v[32:47]
    s_waitcnt lgkmcnt(4)
    ds_read_b64_tr_b16 a[176:177], v6 offset:6144
    ds_read_b64_tr_b16 a[178:179], v6 offset:6656
    v_mfma_f32_32x32x16_bf16 v[32:47], a[188:191], v[140:143], v[32:47]
    s_waitcnt lgkmcnt(4)
    ds_read_b64_tr_b16 a[180:181], v6 offset:7168
    ds_read_b64_tr_b16 a[182:183], v6 offset:7680
    v_mfma_f32_32x32x16_bf16 v[32:47], a[192:195], v[144:147], v[32:47]
    s_waitcnt lgkmcnt(4)
    ds_read_b64_tr_b16 a[184:185], v6 offset:16384
    ds_read_b64_tr_b16 a[186:187], v6 offset:16896
    v_mfma_f32_32x32x16_bf16 v[32:47], a[196:199], v[148:151], v[32:47]
    s_waitcnt lgkmcnt(4)
    ds_read_b64_tr_b16 a[188:189], v6 offset:17408
    ds_read_b64_tr_b16 a[190:191], v6 offset:17920
    v_mfma_f32_32x32x16_bf16 v[32:47], a[176:179], v[152:155], v[32:47]
    s_waitcnt lgkmcnt(4)
    ds_read_b64_tr_b16 a[192:193], v6 offset:18432
    ds_read_b64_tr_b16 a[194:195], v6 offset:18944
    v_mfma_f32_32x32x16_bf16 v[32:47], a[180:183], v[156:159], v[32:47]
    s_waitcnt lgkmcnt(4)
    ds_read_b64_tr_b16 a[196:197], v6 offset:19456
    ds_read_b64_tr_b16 a[198:199], v6 offset:19968
    v_mfma_f32_32x32x16_bf16 v[32:47], a[184:187], v[160:163], v[32:47]
    s_waitcnt lgkmcnt(4)
    ds_read_b64_tr_b16 a[176:177], v6 offset:20480
    ds_read_b64_tr_b16 a[178:179], v6 offset:20992
    s_lshl_b32 s68, s62, 3
    s_add_u32 s68, s68, s60
    s_lshl_b32 s68, s68, 1
    s_add_u32 s68, s68, s57
    v_mfma_f32_32x32x16_bf16 v[32:47], a[188:191], v[164:167], v[32:47]
    s_waitcnt lgkmcnt(4)
    ds_read_b64_tr_b16 a[180:181], v6 offset:21504
    ds_read_b64_tr_b16 a[182:183], v6 offset:22016
    s_mul_i32 s68, s68, 6144
    s_add_u32 s68, s68, 0x100000
    v_mfma_f32_32x32x16_bf16 v[32:47], a[192:195], v[168:171], v[32:47]
    s_waitcnt lgkmcnt(4)
    buffer_store_dwordx4 a[16:19], v29, s[44:47], s68 offen offset:0 sc1
    ds_read_b64_tr_b16 a[184:185], v6 offset:22528
    ds_read_b64_tr_b16 a[186:187], v6 offset:23040
    v_mfma_f32_32x32x16_bf16 v[32:47], a[196:199], v[172:175], v[32:47]
    s_waitcnt lgkmcnt(4)
    ds_read_b64_tr_b16 a[188:189], v6 offset:23552
    ds_read_b64_tr_b16 a[190:191], v6 offset:24064
    v_add_u32_e32 v239, 0x10000, v7
    v_mfma_f32_32x32x16_bf16 v[32:47], a[176:179], v[176:179], v[32:47]
    s_waitcnt lgkmcnt(4)
    buffer_store_dwordx4 a[20:23], v29, s[44:47], s68 offen offset:1024 sc1
    ds_read_b64_tr_b16 a[192:193], v239 offset:49152
    ds_read_b64_tr_b16 a[194:195], v239 offset:49664
    v_mfma_f32_32x32x16_bf16 v[32:47], a[180:183], v[180:183], v[32:47]
    s_waitcnt lgkmcnt(4)
    ds_read_b64_tr_b16 a[196:197], v239 offset:50176
    ds_read_b64_tr_b16 a[198:199], v239 offset:50688
    v_mfma_f32_32x32x16_bf16 v[32:47], a[184:187], v[184:187], v[32:47]
    s_waitcnt lgkmcnt(4)
    buffer_store_dwordx4 a[24:27], v29, s[44:47], s68 offen offset:2048 sc1
    ds_read_b64_tr_b16 a[176:177], v239 offset:51200
    ds_read_b64_tr_b16 a[178:179], v239 offset:51712
    v_mfma_f32_32x32x16_bf16 v[32:47], a[188:191], v[188:191], v[32:47]
    s_waitcnt lgkmcnt(4)
    ds_read_b64_tr_b16 a[180:181], v239 offset:52224
    ds_read_b64_tr_b16 a[182:183], v239 offset:52736
    v_mfma_f32_32x32x16_bf16 v[48:63], a[192:195], v[64:67], 0
    s_waitcnt lgkmcnt(4)
    s_add_u32 m0, s74, 0xc000
    s_add_u32 s81, s76, 0x0
    buffer_load_dwordx4 v14, s[32:35], s81 offen offset:0 lds
    ds_read_b64_tr_b16 a[184:185], v239 offset:53248
    ds_read_b64_tr_b16 a[186:187], v239 offset:53760
    v_mfma_f32_32x32x16_bf16 v[48:63], a[196:199], v[68:71], v[48:63]
    s_waitcnt lgkmcnt(4)
    ds_read_b64_tr_b16 a[188:189], v239 offset:54272
    ds_read_b64_tr_b16 a[190:191], v239 offset:54784
    v_mfma_f32_32x32x16_bf16 v[48:63], a[176:179], v[72:75], v[48:63]
    s_waitcnt lgkmcnt(4)
    buffer_load_dwordx4 v15, s[32:35], s81 offen offset:1024 lds
    ds_read_b64_tr_b16 a[192:193], v239 offset:55296
    ds_read_b64_tr_b16 a[194:195], v239 offset:55808
    v_mfma_f32_32x32x16_bf16 v[48:63], a[180:183], v[76:79], v[48:63]
    s_waitcnt lgkmcnt(4)
    ds_read_b64_tr_b16 a[196:197], v239 offset:56320
    ds_read_b64_tr_b16 a[198:199], v239 offset:56832
    v_mul_f32_e32 v20, v32, v32
    v_mul_f32_e64 v21, v33, v33
    v_fma_f32 v20, v20, v3, v2
    v_fma_f32 v21, v21, v3, v2
    v_add_u32_e32 v9, 0x20000, v7
    v_mfma_f32_32x32x16_bf16 v[48:63], a[184:187], v[80:83], v[48:63]
    s_waitcnt lgkmcnt(4)
    buffer_load_dwordx4 v16, s[32:35], s81 offen offset:2048 lds
    ds_read_b64_tr_b16 a[176:177], v9 offset:16384
    ds_read_b64_tr_b16 a[178:179], v9 offset:16896
    v_mul_f32_e32 v20, v32, v20
    v_mfma_f32_32x32x16_bf16 v[48:63], a[188:191], v[84:87], v[48:63]
    s_waitcnt lgkmcnt(4)
    ds_read_b64_tr_b16 a[180:181], v9 offset:17408
    ds_read_b64_tr_b16 a[182:183], v9 offset:17920
    v_mul_f32_e32 v21, v33, v21
    v_exp_f32_e64 v20, v20
    v_exp_f32_e32 v21, v21
    v_mfma_f32_32x32x16_bf16 v[48:63], a[192:195], v[88:91], v[48:63]
    s_waitcnt lgkmcnt(4)
    buffer_load_dwordx4 v17, s[32:35], s81 offen offset:3072 lds
    ds_read_b64_tr_b16 a[184:185], v9 offset:18432
    ds_read_b64_tr_b16 a[186:187], v9 offset:18944
    v_mul_f32_e32 v22, v32, v40
    v_mfma_f32_32x32x16_bf16 v[48:63], a[196:199], v[92:95], v[48:63]
    s_waitcnt lgkmcnt(4)
    ds_read_b64_tr_b16 a[188:189], v9 offset:19456
    ds_read_b64_tr_b16 a[190:191], v9 offset:19968
    v_mul_f32_e64 v23, v33, v41
    v_fma_f32 v20, v20, v4, v4
    v_fma_f32 v21, v21, v4, v4
    v_mfma_f32_32x32x16_bf16 v[48:63], a[176:179], v[96:99], v[48:63]
    s_waitcnt lgkmcnt(4)
    s_add_u32 m0, s74, 0x14000
    s_add_u32 s81, s76, 0x60000
    buffer_load_dwordx4 v14, s[32:35], s81 offen offset:0 lds
    ds_read_b64_tr_b16 a[192:193], v9 offset:20480
    ds_read_b64_tr_b16 a[194:195], v9 offset:20992
    v_mfma_f32_32x32x16_bf16 v[48:63], a[180:183], v[100:103], v[48:63]
    s_waitcnt lgkmcnt(4)
    ds_read_b64_tr_b16 a[196:197], v9 offset:21504
    ds_read_b64_tr_b16 a[198:199], v9 offset:22016
    v_rcp_f32_e64 v20, v20
    v_rcp_f32_e32 v21, v21
    v_mfma_f32_32x32x16_bf16 v[48:63], a[184:187], v[104:107], v[48:63]
    s_waitcnt lgkmcnt(4)
    buffer_load_dwordx4 v15, s[32:35], s81 offen offset:1024 lds
    ds_read_b64_tr_b16 a[176:177], v9 offset:22528
    ds_read_b64_tr_b16 a[178:179], v9 offset:23040
    v_mul_f32_e32 v22, v22, v20
    v_mfma_f32_32x32x16_bf16 v[48:63], a[188:191], v[108:111], v[48:63]
    s_waitcnt lgkmcnt(4)
    ds_read_b64_tr_b16 a[180:181], v9 offset:23552
    ds_read_b64_tr_b16 a[182:183], v9 offset:24064
    v_mul_f32_e64 v23, v23, v21
    v_cvt_pk_bf16_f32 v24, v22, v23
    v_mul_f32_e64 v20, v34, v34
    v_mul_f32_e32 v21, v35, v35
    v_mfma_f32_32x32x16_bf16 v[48:63], a[192:195], v[112:115], v[48:63]
    s_waitcnt lgkmcnt(4)
    buffer_load_dwordx4 v16, s[32:35], s81 offen offset:2048 lds
    ds_read_b64_tr_b16 a[184:185], v7 offset:0
    ds_read_b64_tr_b16 a[186:187], v7 offset:512
    v_fma_f32 v20, v20, v3, v2
    v_mfma_f32_32x32x16_bf16 v[48:63], a[196:199], v[116:119], v[48:63]
    s_waitcnt lgkmcnt(4)
    ds_read_b64_tr_b16 a[188:189], v7 offset:1024
    ds_read_b64_tr_b16 a[190:191], v7 offset:1536
    v_fma_f32 v21, v21, v3, v2
    v_mul_f32_e32 v20, v34, v20
    v_mul_f32_e32 v21, v35, v21
    v_mfma_f32_32x32x16_bf16 v[48:63], a[176:179], v[120:123], v[48:63]
    s_waitcnt lgkmcnt(4)
    buffer_load_dwordx4 v17, s[32:35], s81 offen offset:3072 lds
    ds_read_b64_tr_b16 a[192:193], v7 offset:2048
    ds_read_b64_tr_b16 a[194:195], v7 offset:2560
    v_exp_f32_e32 v20, v20
    v_mfma_f32_32x32x16_bf16 v[48:63], a[180:183], v[124:127], v[48:63]
    s_waitcnt lgkmcnt(4)
    ds_read_b64_tr_b16 a[196:197], v7 offset:3072
    ds_read_b64_tr_b16 a[198:199], v7 offset:3584
    v_exp_f32_e32 v21, v21
    v_mul_f32_e32 v22, v34, v42
    v_mul_f32_e64 v23, v35, v43
    v_mfma_f32_32x32x16_bf16 v[48:63], a[184:187], v[128:131], v[48:63]
    s_waitcnt lgkmcnt(4)
    buffer_store_dwordx4 a[28:31], v29, s[44:47], s68 offen offset:3072 sc1
    ds_read_b64_tr_b16 a[176:177], v7 offset:4096
    ds_read_b64_tr_b16 a[178:179], v7 offset:4608
    v_mfma_f32_32x32x16_bf16 v[48:63], a[188:191], v[132:135], v[48:63]
    s_waitcnt lgkmcnt(4)
    ds_read_b64_tr_b16 a[180:181], v7 offset:5120
    ds_read_b64_tr_b16 a[182:183], v7 offset:5632
    v_fma_f32 v20, v20, v4, v4
    v_fma_f32 v21, v21, v4, v4
    v_rcp_f32_e32 v20, v20
    v_mfma_f32_32x32x16_bf16 v[48:63], a[192:195], v[136:139], v[48:63]
    s_waitcnt lgkmcnt(4)
    ds_read_b64_tr_b16 a[184:185], v7 offset:6144
    ds_read_b64_tr_b16 a[186:187], v7 offset:6656
    v_rcp_f32_e32 v21, v21
    v_mul_f32_e32 v22, v22, v20
    v_mul_f32_e32 v23, v23, v21
    v_mfma_f32_32x32x16_bf16 v[48:63], a[196:199], v[140:143], v[48:63]
    s_waitcnt lgkmcnt(4)
    ds_read_b64_tr_b16 a[188:189], v7 offset:7168
    ds_read_b64_tr_b16 a[190:191], v7 offset:7680
    v_cvt_pk_bf16_f32 v25, v22, v23
    v_mul_f32_e32 v20, v36, v36
    v_mul_f32_e32 v21, v37, v37
    v_fma_f32 v20, v20, v3, v2
    v_fma_f32 v21, v21, v3, v2
    v_mfma_f32_32x32x16_bf16 v[48:63], a[176:179], v[144:147], v[48:63]
    s_waitcnt lgkmcnt(4)
    ds_read_b64_tr_b16 a[192:193], v7 offset:16384
    ds_read_b64_tr_b16 a[194:195], v7 offset:16896
    v_mul_f32_e32 v20, v36, v20
    v_mul_f32_e64 v21, v37, v21
    v_exp_f32_e32 v20, v20
    v_mfma_f32_32x32x16_bf16 v[48:63], a[180:183], v[148:151], v[48:63]
    s_waitcnt lgkmcnt(4)
    ds_read_b64_tr_b16 a[196:197], v7 offset:17408
    ds_read_b64_tr_b16 a[198:199], v7 offset:17920
    v_exp_f32_e32 v21, v21
    v_mul_f32_e32 v22, v36, v44
    v_mul_f32_e32 v23, v37, v45
    v_mfma_f32_32x32x16_bf16 v[48:63], a[184:187], v[152:155], v[48:63]
    s_waitcnt lgkmcnt(4)
    ds_read_b64_tr_b16 a[176:177], v7 offset:18432
    ds_read_b64_tr_b16 a[178:179], v7 offset:18944
    v_fma_f32 v20, v20, v4, v4
    v_fma_f32 v21, v21, v4, v4
    v_rcp_f32_e32 v20, v20
    v_mfma_f32_32x32x16_bf16 v[48:63], a[188:191], v[156:159], v[48:63]
    s_waitcnt lgkmcnt(4)
    ds_read_b64_tr_b16 a[180:181], v7 offset:19456
    ds_read_b64_tr_b16 a[182:183], v7 offset:19968
    v_rcp_f32_e32 v21, v21
    v_mul_f32_e32 v22, v22, v20
    v_mul_f32_e64 v23, v23, v21
    v_cvt_pk_bf16_f32 v26, v22, v23
    v_mfma_f32_32x32x16_bf16 v[48:63], a[192:195], v[160:163], v[48:63]
    s_waitcnt lgkmcnt(4)
    ds_read_b64_tr_b16 a[184:185], v7 offset:20480
    ds_read_b64_tr_b16 a[186:187], v7 offset:20992
    v_mul_f32_e32 v20, v38, v38
    v_mul_f32_e64 v21, v39, v39
    v_fma_f32 v20, v20, v3, v2
    v_fma_f32 v21, v21, v3, v2
    v_mfma_f32_32x32x16_bf16 v[48:63], a[196:199], v[164:167], v[48:63]
    s_waitcnt lgkmcnt(4)
    ds_read_b64_tr_b16 a[188:189], v7 offset:21504
    ds_read_b64_tr_b16 a[190:191], v7 offset:22016
    v_mul_f32_e32 v20, v38, v20
    v_mul_f32_e64 v21, v39, v21
    v_exp_f32_e32 v20, v20
    v_mfma_f32_32x32x16_bf16 v[48:63], a[176:179], v[168:171], v[48:63]
    s_waitcnt lgkmcnt(4)
    ds_read_b64_tr_b16 a[192:193], v7 offset:22528
    ds_read_b64_tr_b16 a[194:195], v7 offset:23040
    v_exp_f32_e32 v21, v21
    v_mul_f32_e32 v22, v38, v46
    v_mul_f32_e32 v23, v39, v47
    v_mfma_f32_32x32x16_bf16 v[48:63], a[180:183], v[172:175], v[48:63]
    s_waitcnt lgkmcnt(4)
    ds_read_b64_tr_b16 a[196:197], v7 offset:23552
    ds_read_b64_tr_b16 a[198:199], v7 offset:24064
    v_fma_f32 v20, v20, v4, v4
    v_fma_f32 v21, v21, v4, v4
    v_rcp_f32_e64 v20, v20
    v_mfma_f32_32x32x16_bf16 v[48:63], a[184:187], v[176:179], v[48:63]
    s_waitcnt lgkmcnt(4)
    v_rcp_f32_e32 v21, v21
    v_mul_f32_e32 v22, v22, v20
    v_mul_f32_e32 v23, v23, v21
    v_cvt_pk_bf16_f32 v27, v22, v23
    v_mfma_f32_32x32x16_bf16 v[48:63], a[188:191], v[180:183], v[48:63]
    s_waitcnt vmcnt(13) lgkmcnt(0)
    s_barrier
    ds_read_b64_tr_b16 a[176:177], v6 offset:32768
    ds_read_b64_tr_b16 a[178:179], v6 offset:33280
    ds_read_b64_tr_b16 a[180:181], v6 offset:33792
    ds_read_b64_tr_b16 a[182:183], v6 offset:34304
    s_add_u32 s82, s77, 0x0
    s_add_u32 s68, s68, 4096
    v_mfma_f32_32x32x16_bf16 v[48:63], a[192:195], v[184:187], v[48:63]
    s_nop 0
    buffer_store_dwordx4 v[24:27], v1, s[44:47], s82 offen sc1
    ds_read_b64_tr_b16 a[184:185], v6 offset:34816
    ds_read_b64_tr_b16 a[186:187], v6 offset:35328
    v_mfma_f32_32x32x16_bf16 v[48:63], a[196:199], v[188:191], v[48:63]
    s_waitcnt lgkmcnt(4)
    ds_read_b64_tr_b16 a[188:189], v6 offset:35840
    ds_read_b64_tr_b16 a[190:191], v6 offset:36352
    v_mfma_f32_32x32x16_bf16 v[32:47], a[176:179], v[64:67], 0
    s_waitcnt lgkmcnt(4)
    ds_read_b64_tr_b16 a[192:193], v6 offset:36864
    ds_read_b64_tr_b16 a[194:195], v6 offset:37376
    v_mfma_f32_32x32x16_bf16 v[32:47], a[180:183], v[68:71], v[32:47]
    s_waitcnt lgkmcnt(4)
    ds_read_b64_tr_b16 a[196:197], v6 offset:37888
    ds_read_b64_tr_b16 a[198:199], v6 offset:38400
    v_mfma_f32_32x32x16_bf16 v[32:47], a[184:187], v[72:75], v[32:47]
    s_waitcnt lgkmcnt(4)
    s_add_u32 m0, s74, 0x1c000
    s_add_u32 s81, s76, 0xc0000
    buffer_load_dwordx4 v14, s[32:35], s81 offen offset:0 lds
    ds_read_b64_tr_b16 a[176:177], v6 offset:38912
    ds_read_b64_tr_b16 a[178:179], v6 offset:39424
    v_mfma_f32_32x32x16_bf16 v[32:47], a[188:191], v[76:79], v[32:47]
    s_waitcnt lgkmcnt(4)
    ds_read_b64_tr_b16 a[180:181], v6 offset:39936
    ds_read_b64_tr_b16 a[182:183], v6 offset:40448
    v_mul_f32_e32 v20, v48, v48
    v_mul_f32_e64 v21, v49, v49
    v_fma_f32 v20, v20, v3, v2
    v_fma_f32 v21, v21, v3, v2
    v_add_u32_e32 v239, 0x10000, v6
    v_mfma_f32_32x32x16_bf16 v[32:47], a[192:195], v[80:83], v[32:47]
    s_waitcnt lgkmcnt(4)
    buffer_load_dwordx4 v15, s[32:35], s81 offen offset:1024 lds
    ds_read_b64_tr_b16 a[184:185], v239 offset:0
    ds_read_b64_tr_b16 a[186:187], v239 offset:512
    v_mul_f32_e32 v20, v48, v20
    v_mfma_f32_32x32x16_bf16 v[32:47], a[196:199], v[84:87], v[32:47]
    s_waitcnt lgkmcnt(4)
    ds_read_b64_tr_b16 a[188:189], v239 offset:1024
    ds_read_b64_tr_b16 a[190:191], v239 offset:1536
    v_mul_f32_e32 v21, v49, v21
    v_exp_f32_e64 v20, v20
    v_exp_f32_e32 v21, v21
    v_mfma_f32_32x32x16_bf16 v[32:47], a[176:179], v[88:91], v[32:47]
    s_waitcnt lgkmcnt(4)
    buffer_load_dwordx4 v16, s[32:35], s81 offen offset:2048 lds
    ds_read_b64_tr_b16 a[192:193], v239 offset:2048
    ds_read_b64_tr_b16 a[194:195], v239 offset:2560
    v_mul_f32_e64 v22, v48, v56
    v_mul_f32_e32 v23, v49, v57
    v_mfma_f32_32x32x16_bf16 v[32:47], a[180:183], v[92:95], v[32:47]
    s_waitcnt lgkmcnt(4)
    ds_read_b64_tr_b16 a[196:197], v239 offset:3072
    ds_read_b64_tr_b16 a[198:199], v239 offset:3584
    v_fma_f32 v20, v20, v4, v4
    v_fma_f32 v21, v21, v4, v4
    v_rcp_f32_e32 v20, v20
    v_mfma_f32_32x32x16_bf16 v[32:47], a[184:187], v[96:99], v[32:47]
    s_waitcnt lgkmcnt(4)
    buffer_load_dwordx4 v17, s[32:35], s81 offen offset:3072 lds
    ds_read_b64_tr_b16 a[176:177], v239 offset:4096
    ds_read_b64_tr_b16 a[178:179], v239 offset:4608
    v_mfma_f32_32x32x16_bf16 v[32:47], a[188:191], v[100:103], v[32:47]
    s_waitcnt lgkmcnt(4)
    ds_read_b64_tr_b16 a[180:181], v239 offset:5120
    ds_read_b64_tr_b16 a[182:183], v239 offset:5632
    v_rcp_f32_e32 v21, v21
    v_mul_f32_e32 v22, v22, v20
    v_mul_f32_e32 v23, v23, v21
    v_mfma_f32_32x32x16_bf16 v[32:47], a[192:195], v[104:107], v[32:47]
    s_waitcnt lgkmcnt(4)
    s_add_u32 m0, s74, 0x24000
    s_add_u32 s81, s76, 0x120000
    buffer_load_dwordx4 v14, s[32:35], s81 offen offset:0 lds
    ds_read_b64_tr_b16 a[184:185], v239 offset:6144
    ds_read_b64_tr_b16 a[186:187], v239 offset:6656
    v_mfma_f32_32x32x16_bf16 v[32:47], a[196:199], v[108:111], v[32:47]
    s_waitcnt lgkmcnt(4)
    ds_read_b64_tr_b16 a[188:189], v239 offset:7168
    ds_read_b64_tr_b16 a[190:191], v239 offset:7680
    v_cvt_pk_bf16_f32 v24, v22, v23
    v_mul_f32_e32 v20, v50, v50
    v_mul_f32_e32 v21, v51, v51
    v_fma_f32 v20, v20, v3, v2
    v_fma_f32 v21, v21, v3, v2
    v_mfma_f32_32x32x16_bf16 v[32:47], a[176:179], v[112:115], v[32:47]
    s_waitcnt lgkmcnt(4)
    buffer_load_dwordx4 v15, s[32:35], s81 offen offset:1024 lds
    ds_read_b64_tr_b16 a[192:193], v239 offset:32768
    ds_read_b64_tr_b16 a[194:195], v239 offset:33280
    v_mul_f32_e32 v20, v50, v20
    v_mfma_f32_32x32x16_bf16 v[32:47], a[180:183], v[116:119], v[32:47]
    s_waitcnt lgkmcnt(4)
    ds_read_b64_tr_b16 a[196:197], v239 offset:33792
    ds_read_b64_tr_b16 a[198:199], v239 offset:34304
    v_mul_f32_e32 v21, v51, v21
    v_exp_f32_e32 v20, v20
    v_mfma_f32_32x32x16_bf16 v[32:47], a[184:187], v[120:123], v[32:47]
    s_waitcnt lgkmcnt(4)
    buffer_load_dwordx4 v16, s[32:35], s81 offen offset:2048 lds
    ds_read_b64_tr_b16 a[176:177], v239 offset:34816
    ds_read_b64_tr_b16 a[178:179], v239 offset:35328
    v_exp_f32_e32 v21, v21
    v_mfma_f32_32x32x16_bf16 v[32:47], a[188:191], v[124:127], v[32:47]
    s_waitcnt lgkmcnt(4)
    ds_read_b64_tr_b16 a[180:181], v239 offset:35840
    ds_read_b64_tr_b16 a[182:183], v239 offset:36352
    v_mul_f32_e32 v22, v50, v58
    v_mul_f32_e32 v23, v51, v59
    v_fma_f32 v20, v20, v4, v4
    v_fma_f32 v21, v21, v4, v4
    v_mfma_f32_32x32x16_bf16 v[32:47], a[192:195], v[128:131], v[32:47]
    s_waitcnt lgkmcnt(4)
    buffer_load_dwordx4 v17, s[32:35], s81 offen offset:3072 lds
    ds_read_b64_tr_b16 a[184:185], v239 offset:36864
    ds_read_b64_tr_b16 a[186:187], v239 offset:37376
    v_mfma_f32_32x32x16_bf16 v[32:47], a[196:199], v[132:135], v[32:47]
    s_waitcnt lgkmcnt(4)
    ds_read_b64_tr_b16 a[188:189], v239 offset:37888
    ds_read_b64_tr_b16 a[190:191], v239 offset:38400
    v_rcp_f32_e64 v20, v20
    v_rcp_f32_e32 v21, v21
    v_mfma_f32_32x32x16_bf16 v[32:47], a[176:179], v[136:139], v[32:47]
    s_waitcnt lgkmcnt(4)
    buffer_load_dword v238, v30, s[40:43], s15 offen
    ds_read_b64_tr_b16 a[192:193], v239 offset:38912
    ds_read_b64_tr_b16 a[194:195], v239 offset:39424
    v_mul_f32_e32 v22, v22, v20
    v_mfma_f32_32x32x16_bf16 v[32:47], a[180:183], v[140:143], v[32:47]
    s_waitcnt lgkmcnt(4)
    ds_read_b64_tr_b16 a[196:197], v239 offset:39936
    ds_read_b64_tr_b16 a[198:199], v239 offset:40448
    v_mul_f32_e64 v23, v23, v21
    v_cvt_pk_bf16_f32 v25, v22, v23
    v_mul_f32_e32 v20, v52, v52
    v_mul_f32_e32 v21, v53, v53
    v_fma_f32 v20, v20, v3, v2
    v_add_u32_e32 v9, 0x20000, v6
    v_mfma_f32_32x32x16_bf16 v[32:47], a[184:187], v[144:147], v[32:47]
    s_waitcnt lgkmcnt(4)
    ds_read_b64_tr_b16 a[176:177], v9 offset:0
    ds_read_b64_tr_b16 a[178:179], v9 offset:512
    v_fma_f32 v21, v21, v3, v2
    v_mul_f32_e32 v20, v52, v20
    v_mul_f32_e64 v21, v53, v21
    v_exp_f32_e32 v20, v20
    v_mfma_f32_32x32x16_bf16 v[32:47], a[188:191], v[148:151], v[32:47]
    s_waitcnt lgkmcnt(4)
    buffer_store_dwordx2 a[38:39], v1, s[44:47], s68 offen offset:0 sc1
    ds_read_b64_tr_b16 a[180:181], v9 offset:1024
    ds_read_b64_tr_b16 a[182:183], v9 offset:1536
    v_mfma_f32_32x32x16_bf16 v[32:47], a[192:195], v[152:155], v[32:47]
    s_waitcnt lgkmcnt(4)
    ds_read_b64_tr_b16 a[184:185], v9 offset:2048
    ds_read_b64_tr_b16 a[186:187], v9 offset:2560
    v_exp_f32_e32 v21, v21
    v_mul_f32_e64 v22, v52, v60
    v_mul_f32_e32 v23, v53, v61
    v_mfma_f32_32x32x16_bf16 v[32:47], a[196:199], v[156:159], v[32:47]
    s_waitcnt lgkmcnt(4)
    buffer_store_dwordx2 a[46:47], v1, s[44:47], s68 offen offset:1024 sc1
    ds_read_b64_tr_b16 a[188:189], v9 offset:3072
    ds_read_b64_tr_b16 a[190:191], v9 offset:3584
    v_fma_f32 v20, v20, v4, v4
    v_fma_f32 v21, v21, v4, v4
    v_mfma_f32_32x32x16_bf16 v[32:47], a[176:179], v[160:163], v[32:47]
    s_waitcnt lgkmcnt(4)
    ds_read_b64_tr_b16 a[192:193], v9 offset:4096
    ds_read_b64_tr_b16 a[194:195], v9 offset:4608
    v_rcp_f32_e32 v20, v20
    v_rcp_f32_e64 v21, v21
    v_mul_f32_e32 v22, v22, v20
    v_mfma_f32_32x32x16_bf16 v[32:47], a[180:183], v[164:167], v[32:47]
    s_waitcnt lgkmcnt(4)
    ds_read_b64_tr_b16 a[196:197], v9 offset:5120
    ds_read_b64_tr_b16 a[198:199], v9 offset:5632
    v_mul_f32_e64 v23, v23, v21
    v_cvt_pk_bf16_f32 v26, v22, v23
    v_mul_f32_e64 v20, v54, v54
    v_mul_f32_e32 v21, v55, v55
    v_mfma_f32_32x32x16_bf16 v[32:47], a[184:187], v[168:171], v[32:47]
    s_waitcnt lgkmcnt(4)
    ds_read_b64_tr_b16 a[176:177], v9 offset:6144
    ds_read_b64_tr_b16 a[178:179], v9 offset:6656
    v_fma_f32 v20, v20, v3, v2
    v_fma_f32 v21, v21, v3, v2
    v_mul_f32_e64 v20, v54, v20
    v_mul_f32_e32 v21, v55, v21
    v_mfma_f32_32x32x16_bf16 v[32:47], a[188:191], v[172:175], v[32:47]
    s_waitcnt lgkmcnt(4)
    ds_read_b64_tr_b16 a[180:181], v9 offset:7168
    ds_read_b64_tr_b16 a[182:183], v9 offset:7680
    v_exp_f32_e64 v20, v20
    v_exp_f32_e32 v21, v21
    v_mfma_f32_32x32x16_bf16 v[32:47], a[192:195], v[176:179], v[32:47]
    s_waitcnt lgkmcnt(4)
    ds_read_b64_tr_b16 a[184:185], v7 offset:32768
    ds_read_b64_tr_b16 a[186:187], v7 offset:33280
    v_mul_f32_e32 v22, v54, v62
    v_mul_f32_e32 v23, v55, v63
    v_fma_f32 v20, v20, v4, v4
    v_fma_f32 v21, v21, v4, v4
    v_mfma_f32_32x32x16_bf16 v[32:47], a[196:199], v[180:183], v[32:47]
    s_waitcnt lgkmcnt(4)
    ds_read_b64_tr_b16 a[188:189], v7 offset:33792
    ds_read_b64_tr_b16 a[190:191], v7 offset:34304
    v_rcp_f32_e32 v20, v20
    v_rcp_f32_e64 v21, v21
    v_mul_f32_e32 v22, v22, v20
    v_mfma_f32_32x32x16_bf16 v[32:47], a[176:179], v[184:187], v[32:47]
    s_waitcnt lgkmcnt(4)
    ds_read_b64_tr_b16 a[192:193], v7 offset:34816
    ds_read_b64_tr_b16 a[194:195], v7 offset:35328
    v_mul_f32_e32 v23, v23, v21
    v_cvt_pk_bf16_f32 v27, v22, v23
    s_add_u32 s82, s77, 0x400
    v_mfma_f32_32x32x16_bf16 v[32:47], a[180:183], v[188:191], v[32:47]
    s_waitcnt lgkmcnt(4)
    buffer_store_dwordx4 v[24:27], v1, s[44:47], s82 offen sc1
    ds_read_b64_tr_b16 a[196:197], v7 offset:35840
    ds_read_b64_tr_b16 a[198:199], v7 offset:36352
    v_mfma_f32_32x32x16_bf16 v[48:63], a[184:187], v[64:67], 0
    s_waitcnt lgkmcnt(4)
    ds_read_b64_tr_b16 a[176:177], v7 offset:36864
    ds_read_b64_tr_b16 a[178:179], v7 offset:37376
    v_readfirstlane_b32 s67, v253
    s_nop 1
    s_cmp_eq_u32 s67, 0
    s_cbranch_scc1 L_nslow_1
L_nback_2:
    v_mfma_f32_32x32x16_bf16 v[48:63], a[188:191], v[68:71], v[48:63]
    s_waitcnt lgkmcnt(4)
    ds_read_b64_tr_b16 a[180:181], v7 offset:37888
    ds_read_b64_tr_b16 a[182:183], v7 offset:38400
    s_waitcnt vmcnt(1)
    v_mfma_f32_32x32x16_bf16 v[48:63], a[192:195], v[72:75], v[48:63]
    s_waitcnt lgkmcnt(4)
    ds_read_b64_tr_b16 a[184:185], v7 offset:38912
    ds_read_b64_tr_b16 a[186:187], v7 offset:39424
    s_lshl_b32 s69, s60, 1
    s_add_u32 s69, s69, s57
    s_lshl_b32 s90, s62, 8
    s_lshl_b32 s69, s69, 2
    s_add_u32 s90, s90, s69
    s_add_u32 s90, s90, 0x7000
    v_mfma_f32_32x32x16_bf16 v[48:63], a[196:199], v[76:79], v[48:63]
    s_waitcnt lgkmcnt(4)
    s_add_u32 m0, s83, 0x0
    s_add_u32 s81, s84, 0x0
    buffer_load_dwordx4 v252, s[36:39], s81 offen lds
    ds_read_b64_tr_b16 a[188:189], v7 offset:39936
    ds_read_b64_tr_b16 a[190:191], v7 offset:40448
    v_add_u32_e32 v239, 0x10000, v7
    v_mfma_f32_32x32x16_bf16 v[48:63], a[176:179], v[80:83], v[48:63]
    s_waitcnt lgkmcnt(4)
    ds_read_b64_tr_b16 a[192:193], v239 offset:0
    ds_read_b64_tr_b16 a[194:195], v239 offset:512
    v_mul_f32_e32 v20, v32, v32
    v_mul_f32_e64 v21, v33, v33
    v_fma_f32 v20, v20, v3, v2
    v_fma_f32 v21, v21, v3, v2
    v_mfma_f32_32x32x16_bf16 v[48:63], a[180:183], v[84:87], v[48:63]
    s_waitcnt lgkmcnt(4)
    s_add_u32 m0, s83, 0x800
    s_add_u32 s81, s84, 0x4000
    buffer_load_dwordx4 v252, s[36:39], s81 offen lds
    ds_read_b64_tr_b16 a[196:197], v239 offset:1024
    ds_read_b64_tr_b16 a[198:199], v239 offset:1536
    v_mfma_f32_32x32x16_bf16 v[48:63], a[184:187], v[88:91], v[48:63]
    s_waitcnt lgkmcnt(4)
    ds_read_b64_tr_b16 a[176:177], v239 offset:2048
    ds_read_b64_tr_b16 a[178:179], v239 offset:2560
    v_mul_f32_e32 v20, v32, v20
    v_mul_f32_e32 v21, v33, v21
    v_exp_f32_e32 v20, v20
    v_mfma_f32_32x32x16_bf16 v[48:63], a[188:191], v[92:95], v[48:63]
    s_waitcnt lgkmcnt(4)
    s_add_u32 m0, s83, 0x1000
    s_add_u32 s81, s84, 0x8000
    buffer_load_dwordx4 v252, s[36:39], s81 offen lds
    ds_read_b64_tr_b16 a[180:181], v239 offset:3072
    ds_read_b64_tr_b16 a[182:183], v239 offset:3584
    v_mfma_f32_32x32x16_bf16 v[48:63], a[192:195], v[96:99], v[48:63]
    s_waitcnt lgkmcnt(4)
    ds_read_b64_tr_b16 a[184:185], v239 offset:4096
    ds_read_b64_tr_b16 a[186:187], v239 offset:4608
    v_exp_f32_e32 v21, v21
    v_mul_f32_e32 v22, v32, v40
    v_mul_f32_e32 v23, v33, v41
    v_mfma_f32_32x32x16_bf16 v[48:63], a[196:199], v[100:103], v[48:63]
    s_waitcnt lgkmcnt(4)
    s_add_u32 m0, s83, 0x1800
    s_add_u32 s81, s84, 0xc000
    buffer_load_dwordx4 v252, s[36:39], s81 offen lds
    ds_read_b64_tr_b16 a[188:189], v239 offset:5120
    ds_read_b64_tr_b16 a[190:191], v239 offset:5632
    v_mfma_f32_32x32x16_bf16 v[48:63], a[176:179], v[104:107], v[48:63]
    s_waitcnt lgkmcnt(4)
    ds_read_b64_tr_b16 a[192:193], v239 offset:6144
    ds_read_b64_tr_b16 a[194:195], v239 offset:6656
    v_fma_f32 v20, v20, v4, v4
    v_fma_f32 v21, v21, v4, v4
    v_rcp_f32_e32 v20, v20
    v_mfma_f32_32x32x16_bf16 v[48:63], a[180:183], v[108:111], v[48:63]
    s_waitcnt lgkmcnt(4)
    s_add_u32 m0, s83, 0x4000
    s_add_u32 s81, s84, 0x10000
    buffer_load_dwordx4 v252, s[36:39], s81 offen lds
    ds_read_b64_tr_b16 a[196:197], v239 offset:7168
    ds_read_b64_tr_b16 a[198:199], v239 offset:7680
    v_mfma_f32_32x32x16_bf16 v[48:63], a[184:187], v[112:115], v[48:63]
    s_waitcnt lgkmcnt(4)
    ds_read_b64_tr_b16 a[176:177], v239 offset:32768
    ds_read_b64_tr_b16 a[178:179], v239 offset:33280
    v_rcp_f32_e32 v21, v21
    v_mul_f32_e32 v22, v22, v20
    v_mul_f32_e32 v23, v23, v21
    v_mfma_f32_32x32x16_bf16 v[48:63], a[188:191], v[116:119], v[48:63]
    s_waitcnt lgkmcnt(4)
    s_add_u32 m0, s83, 0x4800
    s_add_u32 s81, s84, 0x28000
    buffer_load_dwordx4 v252, s[36:39], s81 offen lds
    ds_read_b64_tr_b16 a[180:181], v239 offset:33792
    ds_read_b64_tr_b16 a[182:183], v239 offset:34304
    v_mfma_f32_32x32x16_bf16 v[48:63], a[192:195], v[120:123], v[48:63]
    s_waitcnt lgkmcnt(4)
    ds_read_b64_tr_b16 a[184:185], v239 offset:34816
    ds_read_b64_tr_b16 a[186:187], v239 offset:35328
    v_cvt_pk_bf16_f32 v24, v22, v23
    v_mul_f32_e32 v20, v34, v34
    v_mul_f32_e32 v21, v35, v35
    v_fma_f32 v20, v20, v3, v2
    v_fma_f32 v21, v21, v3, v2
    v_mfma_f32_32x32x16_bf16 v[48:63], a[196:199], v[124:127], v[48:63]
    s_waitcnt lgkmcnt(4)
    s_add_u32 m0, s83, 0x5000
    s_add_u32 s81, s84, 0x2c000
    buffer_load_dwordx4 v252, s[36:39], s81 offen lds
    ds_read_b64_tr_b16 a[188:189], v239 offset:35840
    ds_read_b64_tr_b16 a[190:191], v239 offset:36352
    v_mfma_f32_32x32x16_bf16 v[48:63], a[176:179], v[128:131], v[48:63]
    s_waitcnt lgkmcnt(4)
    ds_read_b64_tr_b16 a[192:193], v239 offset:36864
    ds_read_b64_tr_b16 a[194:195], v239 offset:37376
    v_mul_f32_e32 v20, v34, v20
    v_mul_f32_e32 v21, v35, v21
    v_exp_f32_e32 v20, v20
    v_mfma_f32_32x32x16_bf16 v[48:63], a[180:183], v[132:135], v[48:63]
    s_waitcnt lgkmcnt(4)
    s_add_u32 m0, s83, 0x5800
    s_add_u32 s81, s84, 0x30000
    buffer_load_dwordx4 v252, s[36:39], s81 offen lds
    ds_read_b64_tr_b16 a[196:197], v239 offset:37888
    ds_read_b64_tr_b16 a[198:199], v239 offset:38400
    v_mfma_f32_32x32x16_bf16 v[48:63], a[184:187], v[136:139], v[48:63]
    s_waitcnt lgkmcnt(4)
    ds_read_b64_tr_b16 a[176:177], v239 offset:38912
    ds_read_b64_tr_b16 a[178:179], v239 offset:39424
    v_exp_f32_e32 v21, v21
    v_mul_f32_e64 v22, v34, v42
    v_mul_f32_e32 v23, v35, v43
    v_mfma_f32_32x32x16_bf16 v[48:63], a[188:191], v[140:143], v[48:63]
    s_waitcnt lgkmcnt(4)
    buffer_store_dword v253, v18, s[44:47], s90 offen sc1
    ds_read_b64_tr_b16 a[180:181], v239 offset:39936
    ds_read_b64_tr_b16 a[182:183], v239 offset:40448
    v_fma_f32 v20, v20, v4, v4
    v_fma_f32 v21, v21, v4, v4
    v_add_u32_e32 v9, 0x20000, v7
    v_mfma_f32_32x32x16_bf16 v[48:63], a[192:195], v[144:147], v[48:63]
    s_waitcnt lgkmcnt(4)
    ds_read_b64_tr_b16 a[184:185], v9 offset:0
    ds_read_b64_tr_b16 a[186:187], v9 offset:512
    v_rcp_f32_e32 v20, v20
    v_rcp_f32_e64 v21, v21
    v_mul_f32_e32 v22, v22, v20
    v_mfma_f32_32x32x16_bf16 v[48:63], a[196:199], v[148:151], v[48:63]
    s_waitcnt lgkmcnt(4)
    ds_read_b64_tr_b16 a[188:189], v9 offset:1024
    ds_read_b64_tr_b16 a[190:191], v9 offset:1536
    v_mul_f32_e64 v23, v23, v21
    v_cvt_pk_bf16_f32 v25, v22, v23
    v_mul_f32_e64 v20, v36, v36
    v_mul_f32_e32 v21, v37, v37
    v_mfma_f32_32x32x16_bf16 v[48:63], a[176:179], v[152:155], v[48:63]
    s_waitcnt lgkmcnt(4)
    ds_read_b64_tr_b16 a[192:193], v9 offset:2048
    ds_read_b64_tr_b16 a[194:195], v9 offset:2560
    v_fma_f32 v20, v20, v3, v2
    v_fma_f32 v21, v21, v3, v2
    v_mul_f32_e64 v20, v36, v20
    v_mul_f32_e32 v21, v37, v21
    v_mfma_f32_32x32x16_bf16 v[48:63], a[180:183], v[156:159], v[48:63]
    s_waitcnt lgkmcnt(4)
    ds_read_b64_tr_b16 a[196:197], v9 offset:3072
    ds_read_b64_tr_b16 a[198:199], v9 offset:3584
    v_exp_f32_e32 v20, v20
    v_exp_f32_e32 v21, v21
    v_mul_f32_e32 v22, v36, v44
    v_mfma_f32_32x32x16_bf16 v[48:63], a[184:187], v[160:163], v[48:63]
    s_waitcnt lgkmcnt(4)
    ds_read_b64_tr_b16 a[176:177], v9 offset:4096
    ds_read_b64_tr_b16 a[178:179], v9 offset:4608
    v_mul_f32_e64 v23, v37, v45
    v_fma_f32 v20, v20, v4, v4
    v_fma_f32 v21, v21, v4, v4
    v_rcp_f32_e32 v20, v20
    v_mfma_f32_32x32x16_bf16 v[48:63], a[188:191], v[164:167], v[48:63]
    s_waitcnt lgkmcnt(4)
    ds_read_b64_tr_b16 a[180:181], v9 offset:5120
    ds_read_b64_tr_b16 a[182:183], v9 offset:5632
    v_rcp_f32_e32 v21, v21
    v_mul_f32_e32 v22, v22, v20
    v_mul_f32_e64 v23, v23, v21
    v_cvt_pk_bf16_f32 v26, v22, v23
    v_mfma_f32_32x32x16_bf16 v[48:63], a[192:195], v[168:171], v[48:63]
    s_waitcnt lgkmcnt(4)
    ds_read_b64_tr_b16 a[184:185], v9 offset:6144
    ds_read_b64_tr_b16 a[186:187], v9 offset:6656
    v_mul_f32_e32 v20, v38, v38
    v_mul_f32_e64 v21, v39, v39
    v_fma_f32 v20, v20, v3, v2
    v_fma_f32 v21, v21, v3, v2
    v_mfma_f32_32x32x16_bf16 v[48:63], a[196:199], v[172:175], v[48:63]
    s_waitcnt lgkmcnt(4)
    ds_read_b64_tr_b16 a[188:189], v9 offset:7168
    ds_read_b64_tr_b16 a[190:191], v9 offset:7680
    v_mul_f32_e32 v20, v38, v20
    v_mul_f32_e32 v21, v39, v21
    v_exp_f32_e32 v20, v20
    v_mfma_f32_32x32x16_bf16 v[48:63], a[176:179], v[176:179], v[48:63]
    s_waitcnt lgkmcnt(4)
    v_exp_f32_e32 v21, v21
    v_mul_f32_e32 v22, v38, v46
    v_mul_f32_e32 v23, v39, v47
    v_fma_f32 v20, v20, v4, v4
    v_mfma_f32_32x32x16_bf16 v[48:63], a[180:183], v[180:183], v[48:63]
    s_waitcnt lgkmcnt(0)
    s_barrier
    ds_read_b64_tr_b16 a[192:193], v8 offset:49152
    ds_read_b64_tr_b16 a[194:195], v8 offset:49664
    ds_read_b64_tr_b16 a[196:197], v8 offset:50176
    ds_read_b64_tr_b16 a[198:199], v8 offset:50688
    v_fma_f32 v21, v21, v4, v4
    v_rcp_f32_e32 v20, v20
    v_rcp_f32_e32 v21, v21
    v_mfma_f32_32x32x16_bf16 v[48:63], a[184:187], v[184:187], v[48:63]
    ds_read_b64_tr_b16 a[176:177], v8 offset:51200
    ds_read_b64_tr_b16 a[178:179], v8 offset:51712
    v_mul_f32_e32 v22, v22, v20
    v_mul_f32_e32 v23, v23, v21
    v_cvt_pk_bf16_f32 v27, v22, v23
    s_add_u32 s82, s77, 0x800
    v_mfma_f32_32x32x16_bf16 v[48:63], a[188:191], v[188:191], v[48:63]
    s_waitcnt lgkmcnt(4)
    buffer_store_dwordx4 v[24:27], v1, s[44:47], s82 offen sc1
    ds_read_b64_tr_b16 a[180:181], v8 offset:52224
    ds_read_b64_tr_b16 a[182:183], v8 offset:52736
    v_mfma_f32_32x32x16_bf16 v[32:47], a[192:195], v[64:67], 0
    s_waitcnt lgkmcnt(4)
    ds_read_b64_tr_b16 a[184:185], v8 offset:53248
    ds_read_b64_tr_b16 a[186:187], v8 offset:53760
    s_cmp_eq_u32 s62, 0
    s_cselect_b32 s69, 0, 1
    s_sub_u32 s8, s62, s69
    v_mfma_f32_32x32x16_bf16 v[32:47], a[196:199], v[68:71], v[32:47]
    s_waitcnt lgkmcnt(4)
    ds_read_b64_tr_b16 a[188:189], v8 offset:54272
    ds_read_b64_tr_b16 a[190:191], v8 offset:54784
    s_lshl_b32 s70, s60, 1
    s_add_u32 s70, s70, s57
    s_lshl_b32 s11, s8, 8
    s_lshl_b32 s70, s70, 2
    s_add_u32 s11, s11, s70
    s_add_u32 s11, s11, 0x7000
    v_mfma_f32_32x32x16_bf16 v[32:47], a[176:179], v[72:75], v[32:47]
    s_waitcnt lgkmcnt(4)
    ds_read_b64_tr_b16 a[192:193], v8 offset:55296
    ds_read_b64_tr_b16 a[194:195], v8 offset:55808
    v_and_b32_e64 v19, 0, v0
    v_lshlrev_b32_e32 v19, 2, v19
    v_mfma_f32_32x32x16_bf16 v[32:47], a[180:183], v[76:79], v[32:47]
    s_waitcnt lgkmcnt(4)
    s_add_u32 m0, s83, 0x8000
    s_add_u32 s81, s84, 0x34000
    buffer_load_dwordx4 v252, s[36:39], s81 offen lds
    ds_read_b64_tr_b16 a[196:197], v8 offset:56320
    ds_read_b64_tr_b16 a[198:199], v8 offset:56832
    v_add_u32_e32 v239, 0x10000, v8
    v_mfma_f32_32x32x16_bf16 v[32:47], a[184:187], v[80:83], v[32:47]
    s_waitcnt lgkmcnt(4)
    ds_read_b64_tr_b16 a[176:177], v239 offset:16384
    ds_read_b64_tr_b16 a[178:179], v239 offset:16896
    v_mul_f32_e32 v20, v48, v48
    v_mul_f32_e64 v21, v49, v49
    v_fma_f32 v20, v20, v3, v2
    v_fma_f32 v21, v21, v3, v2
    v_mfma_f32_32x32x16_bf16 v[32:47], a[188:191], v[84:87], v[32:47]
    s_waitcnt lgkmcnt(4)
    s_add_u32 m0, s83, 0x8800
    s_add_u32 s81, s84, 0x38000
    buffer_load_dwordx4 v252, s[36:39], s81 offen lds
    ds_read_b64_tr_b16 a[180:181], v239 offset:17408
    ds_read_b64_tr_b16 a[182:183], v239 offset:17920
    v_mfma_f32_32x32x16_bf16 v[32:47], a[192:195], v[88:91], v[32:47]
    s_waitcnt lgkmcnt(4)
    ds_read_b64_tr_b16 a[184:185], v239 offset:18432
    ds_read_b64_tr_b16 a[186:187], v239 offset:18944
    v_mul_f32_e32 v20, v48, v20
    v_mul_f32_e32 v21, v49, v21
    v_exp_f32_e32 v20, v20
    v_mfma_f32_32x32x16_bf16 v[32:47], a[196:199], v[92:95], v[32:47]
    s_waitcnt lgkmcnt(4)
    s_add_u32 m0, s83, 0x9000
    s_add_u32 s81, s84, 0x50000
    buffer_load_dwordx4 v252, s[36:39], s81 offen lds
    ds_read_b64_tr_b16 a[188:189], v239 offset:19456
    ds_read_b64_tr_b16 a[190:191], v239 offset:19968
    v_mfma_f32_32x32x16_bf16 v[32:47], a[176:179], v[96:99], v[32:47]
    s_waitcnt lgkmcnt(4)
    ds_read_b64_tr_b16 a[192:193], v239 offset:20480
    ds_read_b64_tr_b16 a[194:195], v239 offset:20992
    v_exp_f32_e32 v21, v21
    v_mul_f32_e32 v22, v48, v56
    v_mul_f32_e32 v23, v49, v57
    v_mfma_f32_32x32x16_bf16 v[32:47], a[180:183], v[100:103], v[32:47]
    s_waitcnt lgkmcnt(4)
    s_add_u32 m0, s83, 0x9800
    s_add_u32 s81, s84, 0x54000
    buffer_load_dwordx4 v252, s[36:39], s81 offen lds
    ds_read_b64_tr_b16 a[196:197], v239 offset:21504
    ds_read_b64_tr_b16 a[198:199], v239 offset:22016
    v_mfma_f32_32x32x16_bf16 v[32:47], a[184:187], v[104:107], v[32:47]
    s_waitcnt lgkmcnt(4)
    ds_read_b64_tr_b16 a[176:177], v239 offset:22528
    ds_read_b64_tr_b16 a[178:179], v239 offset:23040
    v_fma_f32 v20, v20, v4, v4
    v_fma_f32 v21, v21, v4, v4
    v_rcp_f32_e32 v20, v20
    v_mfma_f32_32x32x16_bf16 v[32:47], a[188:191], v[108:111], v[32:47]
    s_waitcnt lgkmcnt(4)
    s_add_u32 m0, s83, 0x10000
    s_add_u32 s81, s84, 0x58000
    buffer_load_dwordx4 v252, s[36:39], s81 offen lds
    ds_read_b64_tr_b16 a[180:181], v239 offset:23552
    ds_read_b64_tr_b16 a[182:183], v239 offset:24064
    v_mfma_f32_32x32x16_bf16 v[32:47], a[192:195], v[112:115], v[32:47]
    s_waitcnt lgkmcnt(4)
    ds_read_b64_tr_b16 a[184:185], v239 offset:49152
    ds_read_b64_tr_b16 a[186:187], v239 offset:49664
    v_rcp_f32_e32 v21, v21
    v_mul_f32_e32 v22, v22, v20
    v_mul_f32_e32 v23, v23, v21
    v_mfma_f32_32x32x16_bf16 v[32:47], a[196:199], v[116:119], v[32:47]
    s_waitcnt lgkmcnt(4)
    s_add_u32 m0, s83, 0x10800
    s_add_u32 s81, s84, 0x5c000
    buffer_load_dwordx4 v252, s[36:39], s81 offen lds
    ds_read_b64_tr_b16 a[188:189], v239 offset:50176
    ds_read_b64_tr_b16 a[190:191], v239 offset:50688
    v_mfma_f32_32x32x16_bf16 v[32:47], a[176:179], v[120:123], v[32:47]
    s_waitcnt lgkmcnt(4)
    ds_read_b64_tr_b16 a[192:193], v239 offset:51200
    ds_read_b64_tr_b16 a[194:195], v239 offset:51712
    v_cvt_pk_bf16_f32 v24, v22, v23
    v_mul_f32_e32 v20, v50, v50
    v_mul_f32_e32 v21, v51, v51
    v_fma_f32 v20, v20, v3, v2
    v_fma_f32 v21, v21, v3, v2
    v_mfma_f32_32x32x16_bf16 v[32:47], a[180:183], v[124:127], v[32:47]
    s_waitcnt lgkmcnt(4)
    s_add_u32 m0, s83, 0x11000
    s_add_u32 s81, s84, 0x60000
    buffer_load_dwordx4 v252, s[36:39], s81 offen lds
    ds_read_b64_tr_b16 a[196:197], v239 offset:52224
    ds_read_b64_tr_b16 a[198:199], v239 offset:52736
    v_mfma_f32_32x32x16_bf16 v[32:47], a[184:187], v[128:131], v[32:47]
    s_waitcnt lgkmcnt(4)
    ds_read_b64_tr_b16 a[176:177], v239 offset:53248
    ds_read_b64_tr_b16 a[178:179], v239 offset:53760
    v_mul_f32_e32 v20, v50, v20
    v_mul_f32_e32 v21, v51, v21
    v_exp_f32_e32 v20, v20
    v_mfma_f32_32x32x16_bf16 v[32:47], a[188:191], v[132:135], v[32:47]
    s_waitcnt lgkmcnt(4)
    s_add_u32 m0, s83, 0x11800
    s_add_u32 s81, s84, 0x78000
    buffer_load_dwordx4 v252, s[36:39], s81 offen lds
    ds_read_b64_tr_b16 a[180:181], v239 offset:54272
    ds_read_b64_tr_b16 a[182:183], v239 offset:54784
    v_mfma_f32_32x32x16_bf16 v[32:47], a[192:195], v[136:139], v[32:47]
    s_waitcnt lgkmcnt(4)
    ds_read_b64_tr_b16 a[184:185], v239 offset:55296
    ds_read_b64_tr_b16 a[186:187], v239 offset:55808
    v_exp_f32_e32 v21, v21
    v_mul_f32_e64 v22, v50, v58
    v_mul_f32_e32 v23, v51, v59
    v_mfma_f32_32x32x16_bf16 v[32:47], a[196:199], v[140:143], v[32:47]
    s_waitcnt lgkmcnt(4)
    buffer_load_dword v19, v19, s[44:47], s11 offen sc1
    ds_read_b64_tr_b16 a[188:189], v239 offset:56320
    ds_read_b64_tr_b16 a[190:191], v239 offset:56832
    v_fma_f32 v20, v20, v4, v4
    v_fma_f32 v21, v21, v4, v4
    v_add_u32_e32 v9, 0x20000, v8
    v_mfma_f32_32x32x16_bf16 v[32:47], a[176:179], v[144:147], v[32:47]
    s_waitcnt lgkmcnt(4)
    ds_read_b64_tr_b16 a[192:193], v9 offset:16384
    ds_read_b64_tr_b16 a[194:195], v9 offset:16896
    v_rcp_f32_e32 v20, v20
    v_rcp_f32_e64 v21, v21
    v_mul_f32_e32 v22, v22, v20
    v_mfma_f32_32x32x16_bf16 v[32:47], a[180:183], v[148:151], v[32:47]
    s_waitcnt lgkmcnt(4)
    ds_read_b64_tr_b16 a[196:197], v9 offset:17408
    ds_read_b64_tr_b16 a[198:199], v9 offset:17920
    v_mul_f32_e64 v23, v23, v21
    v_cvt_pk_bf16_f32 v25, v22, v23
    v_mul_f32_e64 v20, v52, v52
    v_mul_f32_e32 v21, v53, v53
    v_mfma_f32_32x32x16_bf16 v[32:47], a[184:187], v[152:155], v[32:47]
    s_waitcnt lgkmcnt(4)
    ds_read_b64_tr_b16 a[176:177], v9 offset:18432
    ds_read_b64_tr_b16 a[178:179], v9 offset:18944
    v_fma_f32 v20, v20, v3, v2
    v_fma_f32 v21, v21, v3, v2
    v_mul_f32_e64 v20, v52, v20
    v_mul_f32_e32 v21, v53, v21
    v_mfma_f32_32x32x16_bf16 v[32:47], a[188:191], v[156:159], v[32:47]
    s_waitcnt lgkmcnt(4)
    ds_read_b64_tr_b16 a[180:181], v9 offset:19456
    ds_read_b64_tr_b16 a[182:183], v9 offset:19968
    v_exp_f32_e32 v20, v20
    v_exp_f32_e32 v21, v21
    v_mul_f32_e32 v22, v52, v60
    v_mfma_f32_32x32x16_bf16 v[32:47], a[192:195], v[160:163], v[32:47]
    s_waitcnt lgkmcnt(4)
    ds_read_b64_tr_b16 a[184:185], v9 offset:20480
    ds_read_b64_tr_b16 a[186:187], v9 offset:20992
    v_mul_f32_e64 v23, v53, v61
    v_fma_f32 v20, v20, v4, v4
    v_fma_f32 v21, v21, v4, v4
    v_rcp_f32_e32 v20, v20
    v_mfma_f32_32x32x16_bf16 v[32:47], a[196:199], v[164:167], v[32:47]
    s_waitcnt lgkmcnt(4)
    ds_read_b64_tr_b16 a[188:189], v9 offset:21504
    ds_read_b64_tr_b16 a[190:191], v9 offset:22016
    v_rcp_f32_e32 v21, v21
    v_mul_f32_e32 v22, v22, v20
    v_mul_f32_e64 v23, v23, v21
    v_cvt_pk_bf16_f32 v26, v22, v23
    v_mfma_f32_32x32x16_bf16 v[32:47], a[176:179], v[168:171], v[32:47]
    s_waitcnt lgkmcnt(4)
    ds_read_b64_tr_b16 a[192:193], v9 offset:22528
    ds_read_b64_tr_b16 a[194:195], v9 offset:23040
    v_mul_f32_e32 v20, v54, v54
    v_mul_f32_e64 v21, v55, v55
    v_fma_f32 v20, v20, v3, v2
    v_fma_f32 v21, v21, v3, v2
    v_mfma_f32_32x32x16_bf16 v[32:47], a[180:183], v[172:175], v[32:47]
    s_waitcnt lgkmcnt(4)
    ds_read_b64_tr_b16 a[196:197], v9 offset:23552
    ds_read_b64_tr_b16 a[198:199], v9 offset:24064
    v_mul_f32_e32 v20, v54, v20
    v_mul_f32_e64 v21, v55, v21
    v_exp_f32_e32 v20, v20
    v_mfma_f32_32x32x16_bf16 v[32:47], a[184:187], v[176:179], v[32:47]
    s_waitcnt lgkmcnt(4)
    ds_read_b64_tr_b16 a[176:177], v8 offset:57344
    ds_read_b64_tr_b16 a[178:179], v8 offset:57856
    v_exp_f32_e32 v21, v21
    v_mul_f32_e32 v22, v54, v62
    v_mul_f32_e32 v23, v55, v63
    v_fma_f32 v20, v20, v4, v4
    v_mfma_f32_32x32x16_bf16 v[32:47], a[188:191], v[180:183], v[32:47]
    s_waitcnt lgkmcnt(4)
    ds_read_b64_tr_b16 a[180:181], v8 offset:58368
    ds_read_b64_tr_b16 a[182:183], v8 offset:58880
    v_fma_f32 v21, v21, v4, v4
    v_rcp_f32_e64 v20, v20
    v_rcp_f32_e32 v21, v21
    v_mfma_f32_32x32x16_bf16 v[32:47], a[192:195], v[184:187], v[32:47]
    s_waitcnt lgkmcnt(4)
    ds_read_b64_tr_b16 a[184:185], v8 offset:59392
    ds_read_b64_tr_b16 a[186:187], v8 offset:59904
    v_mul_f32_e32 v22, v22, v20
    v_mul_f32_e32 v23, v23, v21
    v_cvt_pk_bf16_f32 v27, v22, v23
    s_add_u32 s82, s77, 0xc00
    v_mfma_f32_32x32x16_bf16 v[32:47], a[196:199], v[188:191], v[32:47]
    s_waitcnt lgkmcnt(4)
    buffer_store_dwordx4 v[24:27], v1, s[44:47], s82 offen sc1
    ds_read_b64_tr_b16 a[188:189], v8 offset:60416
    ds_read_b64_tr_b16 a[190:191], v8 offset:60928
    v_mfma_f32_32x32x16_bf16 v[48:63], a[176:179], v[64:67], 0
    s_waitcnt lgkmcnt(4)
    ds_read_b64_tr_b16 a[192:193], v8 offset:61440
    ds_read_b64_tr_b16 a[194:195], v8 offset:61952
    s_waitcnt vmcnt(1)
    v_mfma_f32_32x32x16_bf16 v[48:63], a[180:183], v[68:71], v[48:63]
    s_waitcnt lgkmcnt(4)
    ds_read_b64_tr_b16 a[196:197], v8 offset:62464
    ds_read_b64_tr_b16 a[198:199], v8 offset:62976
    v_cmp_ne_u32 vcc, s67, v19
    s_nop 1
    s_cmp_lg_u64 vcc, 0
    s_cbranch_scc1 L_slow_4
L_back_5:
    v_mfma_f32_32x32x16_bf16 v[48:63], a[184:187], v[72:75], v[48:63]
    s_waitcnt lgkmcnt(4)
    ds_read_b64_tr_b16 a[176:177], v8 offset:63488
    ds_read_b64_tr_b16 a[178:179], v8 offset:64000
    s_lshl_b32 s11, s64, 8
    s_add_u32 s11, s11, 0x1000
    v_and_b32_e64 v19, 15, v0
    v_lshlrev_b32_e32 v19, 2, v19
    v_mfma_f32_32x32x16_bf16 v[48:63], a[188:191], v[76:79], v[48:63]
    s_waitcnt lgkmcnt(4)
    buffer_load_dword v19, v19, s[44:47], s11 offen sc1
    ds_read_b64_tr_b16 a[180:181], v8 offset:64512
    ds_read_b64_tr_b16 a[182:183], v8 offset:65024
    v_add_u32_e32 v239, 0x10000, v8
    v_mfma_f32_32x32x16_bf16 v[48:63], a[192:195], v[80:83], v[48:63]
    s_waitcnt lgkmcnt(4)
    s_add_u32 m0, s83, 0x18000
    s_add_u32 s81, s84, 0x7c000
    buffer_load_dwordx4 v252, s[36:39], s81 offen lds
    ds_read_b64_tr_b16 a[184:185], v239 offset:24576
    ds_read_b64_tr_b16 a[186:187], v239 offset:25088
    v_mfma_f32_32x32x16_bf16 v[48:63], a[196:199], v[84:87], v[48:63]
    s_waitcnt lgkmcnt(4)
    ds_read_b64_tr_b16 a[188:189], v239 offset:25600
    ds_read_b64_tr_b16 a[190:191], v239 offset:26112
    v_mul_f32_e32 v20, v5, v32
    v_mul_f32_e32 v21, v5, v33
    v_cvt_pk_bf16_f32 v20, v20, v21
    v_accvgpr_write_b32 a48, v20
    v_mfma_f32_32x32x16_bf16 v[48:63], a[176:179], v[88:91], v[48:63]
    s_waitcnt lgkmcnt(4)
    s_add_u32 m0, s83, 0x18800
    s_add_u32 s81, s84, 0x80000
    buffer_load_dwordx4 v252, s[36:39], s81 offen lds
    ds_read_b64_tr_b16 a[192:193], v239 offset:26624
    ds_read_b64_tr_b16 a[194:195], v239 offset:27136
    v_mfma_f32_32x32x16_bf16 v[48:63], a[180:183], v[92:95], v[48:63]
    s_waitcnt lgkmcnt(4)
    ds_read_b64_tr_b16 a[196:197], v239 offset:27648
    ds_read_b64_tr_b16 a[198:199], v239 offset:28160
    s_lshl_b32 s68, s8, 3
    s_add_u32 s68, s68, s60
    s_lshl_b32 s68, s68, 1
    s_add_u32 s68, s68, s57
    v_mfma_f32_32x32x16_bf16 v[48:63], a[184:187], v[96:99], v[48:63]
    s_waitcnt lgkmcnt(4)
    s_add_u32 m0, s83, 0x19000
    s_add_u32 s81, s84, 0x84000
    buffer_load_dwordx4 v252, s[36:39], s81 offen lds
    ds_read_b64_tr_b16 a[176:177], v239 offset:28672
    ds_read_b64_tr_b16 a[178:179], v239 offset:29184
    v_mfma_f32_32x32x16_bf16 v[48:63], a[188:191], v[100:103], v[48:63]
    s_waitcnt lgkmcnt(4)
    ds_read_b64_tr_b16 a[180:181], v239 offset:29696
    ds_read_b64_tr_b16 a[182:183], v239 offset:30208
    v_mul_f32_e32 v22, v5, v34
    v_mul_f32_e32 v23, v5, v35
    v_cvt_pk_bf16_f32 v22, v22, v23
    v_accvgpr_write_b32 a49, v22
    v_mfma_f32_32x32x16_bf16 v[48:63], a[192:195], v[104:107], v[48:63]
    s_waitcnt lgkmcnt(4)
    s_add_u32 m0, s83, 0x19800
    s_add_u32 s81, s84, 0x88000
    buffer_load_dwordx4 v252, s[36:39], s81 offen lds
    ds_read_b64_tr_b16 a[184:185], v239 offset:30720
    ds_read_b64_tr_b16 a[186:187], v239 offset:31232
    v_mfma_f32_32x32x16_bf16 v[48:63], a[196:199], v[108:111], v[48:63]
    s_waitcnt lgkmcnt(4)
    ds_read_b64_tr_b16 a[188:189], v239 offset:31744
    ds_read_b64_tr_b16 a[190:191], v239 offset:32256
    s_mul_i32 s68, s68, 6144
    s_add_u32 s68, s68, 0x100000
    v_mul_f32_e64 v20, v5, v36
    v_mul_f32_e32 v21, v5, v37
    v_mfma_f32_32x32x16_bf16 v[48:63], a[176:179], v[112:115], v[48:63]
    s_waitcnt lgkmcnt(4)
    buffer_load_dwordx4 a[152:155], v29, s[44:47], s68 offen offset:0 sc1
    ds_read_b64_tr_b16 a[192:193], v239 offset:57344
    ds_read_b64_tr_b16 a[194:195], v239 offset:57856
    v_cvt_pk_bf16_f32 v20, v20, v21
    v_mfma_f32_32x32x16_bf16 v[48:63], a[180:183], v[116:119], v[48:63]
    s_waitcnt lgkmcnt(4)
    ds_read_b64_tr_b16 a[196:197], v239 offset:58368
    ds_read_b64_tr_b16 a[198:199], v239 offset:58880
    v_accvgpr_write_b32 a50, v20
    v_mul_f32_e32 v22, v5, v38
    v_mul_f32_e32 v23, v5, v39
    v_cvt_pk_bf16_f32 v22, v22, v23
    v_mfma_f32_32x32x16_bf16 v[48:63], a[184:187], v[120:123], v[48:63]
    s_waitcnt lgkmcnt(4)
    buffer_load_dwordx4 a[156:159], v29, s[44:47], s68 offen offset:1024 sc1
    ds_read_b64_tr_b16 a[176:177], v239 offset:59392
    ds_read_b64_tr_b16 a[178:179], v239 offset:59904
    v_accvgpr_write_b32 a51, v22
    v_mfma_f32_32x32x16_bf16 v[48:63], a[188:191], v[124:127], v[48:63]
    s_waitcnt lgkmcnt(4)
    ds_read_b64_tr_b16 a[180:181], v239 offset:60416
    ds_read_b64_tr_b16 a[182:183], v239 offset:60928
    v_mul_f32_e32 v20, v5, v40
    v_mul_f32_e64 v21, v5, v41
    v_cvt_pk_bf16_f32 v20, v20, v21
    v_accvgpr_write_b32 a52, v20
    v_mfma_f32_32x32x16_bf16 v[48:63], a[192:195], v[128:131], v[48:63]
    s_waitcnt lgkmcnt(4)
    buffer_load_dwordx4 a[160:163], v29, s[44:47], s68 offen offset:2048 sc1
    ds_read_b64_tr_b16 a[184:185], v239 offset:61440
    ds_read_b64_tr_b16 a[186:187], v239 offset:61952
    v_mul_f32_e32 v22, v5, v42
    v_mfma_f32_32x32x16_bf16 v[48:63], a[196:199], v[132:135], v[48:63]
    s_waitcnt lgkmcnt(4)
    ds_read_b64_tr_b16 a[188:189], v239 offset:62464
    ds_read_b64_tr_b16 a[190:191], v239 offset:62976
    v_mul_f32_e32 v23, v5, v43
    v_cvt_pk_bf16_f32 v22, v22, v23
    v_accvgpr_write_b32 a53, v22
    v_mul_f32_e32 v20, v5, v44
    v_mfma_f32_32x32x16_bf16 v[48:63], a[176:179], v[136:139], v[48:63]
    s_waitcnt lgkmcnt(4)
    buffer_load_dwordx4 a[164:167], v29, s[44:47], s68 offen offset:3072 sc1
    ds_read_b64_tr_b16 a[192:193], v239 offset:63488
    ds_read_b64_tr_b16 a[194:195], v239 offset:64000
    s_add_u32 s68, s68, 4096
    v_mfma_f32_32x32x16_bf16 v[48:63], a[180:183], v[140:143], v[48:63]
    s_waitcnt lgkmcnt(4)
    ds_read_b64_tr_b16 a[196:197], v239 offset:64512
    ds_read_b64_tr_b16 a[198:199], v239 offset:65024
    v_mul_f32_e32 v21, v5, v45
    v_cvt_pk_bf16_f32 v20, v20, v21
    v_accvgpr_write_b32 a54, v20
    v_add_u32_e32 v9, 0x20000, v8
    v_mfma_f32_32x32x16_bf16 v[48:63], a[184:187], v[144:147], v[48:63]
    s_waitcnt lgkmcnt(4)
    buffer_load_dwordx2 a[170:171], v1, s[44:47], s68 offen offset:0 sc1
    ds_read_b64_tr_b16 a[176:177], v9 offset:24576
    ds_read_b64_tr_b16 a[178:179], v9 offset:25088
    s_waitcnt vmcnt(10)
    v_mfma_f32_32x32x16_bf16 v[48:63], a[188:191], v[148:151], v[48:63]
    s_waitcnt lgkmcnt(4)
    buffer_load_dwordx2 a[174:175], v1, s[44:47], s68 offen offset:1024 sc1
    ds_read_b64_tr_b16 a[180:181], v9 offset:25600
    ds_read_b64_tr_b16 a[182:183], v9 offset:26112
    s_waitcnt vmcnt(10)
    v_mfma_f32_32x32x16_bf16 v[48:63], a[192:195], v[152:155], v[48:63]
    s_waitcnt lgkmcnt(4)
    s_add_u32 m0, s83, 0x20000
    s_add_u32 s81, s84, 0x14000
    buffer_load_dwordx4 v252, s[36:39], s81 offen lds
    ds_read_b64_tr_b16 a[184:185], v9 offset:26624
    ds_read_b64_tr_b16 a[186:187], v9 offset:27136
    v_mfma_f32_32x32x16_bf16 v[48:63], a[196:199], v[156:159], v[48:63]
    s_waitcnt lgkmcnt(4)
    ds_read_b64_tr_b16 a[188:189], v9 offset:27648
    ds_read_b64_tr_b16 a[190:191], v9 offset:28160
    v_cmp_ne_u32 vcc, s67, v19
    s_nop 1
    s_cmp_lg_u64 vcc, 0
    s_cbranch_scc1 L_slow_7
L_back_8:
    v_mfma_f32_32x32x16_bf16 v[48:63], a[176:179], v[160:163], v[48:63]
    s_waitcnt lgkmcnt(4)
    s_add_u32 s9, s87, 0x0
    buffer_load_dwordx4 a[64:67], v1, s[44:47], s9 offen offset:0 sc1
    ds_read_b64_tr_b16 a[192:193], v9 offset:28672
    ds_read_b64_tr_b16 a[194:195], v9 offset:29184
    v_mfma_f32_32x32x16_bf16 v[48:63], a[180:183], v[164:167], v[48:63]
    s_waitcnt lgkmcnt(4)
    ds_read_b64_tr_b16 a[196:197], v9 offset:29696
    ds_read_b64_tr_b16 a[198:199], v9 offset:30208
    s_lshl_b32 s69, s60, 1
    s_add_u32 s69, s69, s57
    s_add_u32 s69, s69, 16
    s_lshl_b32 s90, s62, 8
    s_lshl_b32 s69, s69, 2
    s_add_u32 s90, s90, s69
    s_add_u32 s90, s90, 0x3000
    v_mfma_f32_32x32x16_bf16 v[48:63], a[184:187], v[168:171], v[48:63]
    s_waitcnt lgkmcnt(4)
    buffer_store_dword v253, v18, s[44:47], s90 offen sc1
    ds_read_b64_tr_b16 a[176:177], v9 offset:30720
    ds_read_b64_tr_b16 a[178:179], v9 offset:31232
    v_mul_f32_e32 v22, v5, v46
    v_mfma_f32_32x32x16_bf16 v[48:63], a[188:191], v[172:175], v[48:63]
    s_waitcnt lgkmcnt(4)
    buffer_load_dwordx4 a[68:71], v1, s[44:47], s9 offen offset:1024 sc1
    ds_read_b64_tr_b16 a[180:181], v9 offset:31744
    ds_read_b64_tr_b16 a[182:183], v9 offset:32256
    v_mul_f32_e32 v23, v5, v47
    v_mfma_f32_32x32x16_bf16 v[48:63], a[192:195], v[176:179], v[48:63]
    s_waitcnt lgkmcnt(4)
    v_cvt_pk_bf16_f32 v22, v22, v23
    v_accvgpr_write_b32 a55, v22
    v_mfma_f32_32x32x16_bf16 v[48:63], a[196:199], v[180:183], v[48:63]
    s_waitcnt lgkmcnt(0)
    s_barrier
    buffer_load_dwordx4 a[72:75], v1, s[44:47], s9 offen offset:2048 sc1
    ds_read_b64_tr_b16 a[128:129], v251 offset:0
    ds_read_b64_tr_b16 a[130:131], v251 offset:512
    ds_read_b64_tr_b16 a[132:133], v248 offset:0
    ds_read_b64_tr_b16 a[134:135], v248 offset:512
    v_mfma_f32_32x32x16_bf16 v[48:63], a[176:179], v[184:187], v[48:63]
    ds_read_b64_tr_b16 a[136:137], v251 offset:2048
    ds_read_b64_tr_b16 a[138:139], v251 offset:2560
    ds_read_b64_tr_b16 a[140:141], v248 offset:2048
    ds_read_b64_tr_b16 a[142:143], v248 offset:2560
    v_mfma_f32_32x32x16_bf16 v[48:63], a[180:183], v[188:191], v[48:63]
    buffer_load_dwordx4 a[76:79], v1, s[44:47], s9 offen offset:3072 sc1
    s_add_u32 s9, s9, 0x1000
    buffer_load_dwordx4 a[80:83], v1, s[44:47], s9 offen offset:0 sc1
    s_add_u32 s9, s87, 0x2800
    buffer_load_dwordx4 a[84:87], v1, s[44:47], s9 offen offset:0 sc1
    buffer_load_dwordx4 a[88:91], v1, s[44:47], s9 offen offset:1024 sc1
    buffer_load_dwordx4 a[92:95], v1, s[44:47], s9 offen offset:2048 sc1
    s_waitcnt vmcnt(8) lgkmcnt(6)
    v_mfma_f32_32x32x16_bf16 v[64:79], a[128:131], a[64:67], 0
    s_waitcnt lgkmcnt(4)
    ds_read_b64_tr_b16 a[144:145], v251 offset:4096
    ds_read_b64_tr_b16 a[146:147], v251 offset:4608
    v_mul_f32_e32 v20, v5, v48
    v_mul_f32_e32 v21, v5, v49
    v_cvt_pk_bf16_f32 v20, v20, v21
    v_accvgpr_write_b32 a56, v20
    v_mul_f32_e32 v22, v5, v50
    v_mul_f32_e32 v23, v5, v51
    v_cvt_pk_bf16_f32 v22, v22, v23
    v_accvgpr_write_b32 a57, v22
    v_mul_f32_e32 v20, v5, v52
    v_mul_f32_e32 v21, v5, v53
    v_cvt_pk_bf16_f32 v20, v20, v21
    v_accvgpr_write_b32 a58, v20
    v_mul_f32_e32 v22, v5, v54
    v_mul_f32_e32 v23, v5, v55
    v_cvt_pk_bf16_f32 v22, v22, v23
    v_accvgpr_write_b32 a59, v22
    v_mfma_f32_32x32x16_bf16 v[80:95], a[132:135], a[64:67], 0
    buffer_load_dwordx4 a[96:99], v1, s[44:47], s9 offen offset:3072 sc1
    s_add_u32 s9, s9, 0x1000
    buffer_load_dwordx4 a[100:103], v1, s[44:47], s9 offen offset:0 sc1
    s_add_u32 m0, s83, 0x20800
    s_add_u32 s81, s84, 0x18000
    buffer_load_dwordx4 v252, s[36:39], s81 offen lds
    ds_read_b64_tr_b16 a[148:149], v248 offset:4096
    ds_read_b64_tr_b16 a[150:151], v248 offset:4608
    v_mul_f32_e32 v20, v5, v56
    v_mul_f32_e32 v21, v5, v57
    v_cvt_pk_bf16_f32 v20, v20, v21
    v_accvgpr_write_b32 a60, v20
    v_mul_f32_e32 v22, v5, v58
    v_mul_f32_e32 v23, v5, v59
    v_cvt_pk_bf16_f32 v22, v22, v23
    v_accvgpr_write_b32 a61, v22
    v_mul_f32_e32 v20, v5, v60
    v_mul_f32_e32 v21, v5, v61
    v_cvt_pk_bf16_f32 v20, v20, v21
    v_accvgpr_write_b32 a62, v20
    v_mul_f32_e32 v22, v5, v62
    v_mul_f32_e32 v23, v5, v63
    v_cvt_pk_bf16_f32 v22, v22, v23
    v_accvgpr_write_b32 a63, v22
    s_waitcnt vmcnt(9) lgkmcnt(6)
    v_mfma_f32_32x32x16_bf16 v[64:79], a[136:139], a[68:71], v[64:79]
    s_waitcnt lgkmcnt(4)
    ds_read_b64_tr_b16 a[128:129], v251 offset:6144
    ds_read_b64_tr_b16 a[130:131], v251 offset:6656
    s_mov_b32 s6, 0x3eb8aa3b
    v_mov_b32_e64 v168, 0
    v_mov_b32_e32 v169, 0
    v_mfma_f32_32x32x16_bf16 v[80:95], a[140:143], a[68:71], v[80:95]
    s_add_u32 s9, s87, 0x5000
    buffer_load_dwordx4 a[104:107], v1, s[44:47], s9 offen offset:0 sc1
    buffer_load_dwordx4 a[108:111], v1, s[44:47], s9 offen offset:1024 sc1
    s_add_u32 m0, s83, 0x21000
    s_add_u32 s81, s84, 0x1c000
    buffer_load_dwordx4 v252, s[36:39], s81 offen lds
    ds_read_b64_tr_b16 a[132:133], v248 offset:6144
    ds_read_b64_tr_b16 a[134:135], v248 offset:6656
    v_mfma_f32_32x32x16_bf16 v[128:143], a[16:19], a[48:51], v[208:223]
    v_mfma_f32_32x32x16_bf16 v[144:159], a[152:155], a[48:51], v[212:227]
    s_waitcnt vmcnt(11) lgkmcnt(6)
    v_mfma_f32_32x32x16_bf16 v[64:79], a[144:147], a[72:75], v[64:79]
    s_waitcnt lgkmcnt(4)
    ds_read_b64_tr_b16 a[136:137], v251 offset:16384
    ds_read_b64_tr_b16 a[138:139], v251 offset:16896
    s_nop 5
    v_max3_f32 v20, v128, v132, v136
    v_max3_f32 v21, v129, v133, v137
    v_max3_f32 v22, v130, v134, v138
    v_max3_f32 v23, v131, v135, v139
    v_max3_f32 v20, v20, v140, v156
    v_max3_f32 v21, v21, v141, v157
    v_max3_f32 v22, v22, v142, v158
    v_max3_f32 v23, v23, v143, v159
    v_max3_f32 v24, v20, v21, v22
    v_max_f32_e64 v24, v24, v23
    v_mfma_f32_32x32x16_bf16 v[80:95], a[148:151], a[72:75], v[80:95]
    buffer_load_dwordx4 a[112:115], v1, s[44:47], s9 offen offset:2048 sc1
    buffer_load_dwordx4 a[116:119], v1, s[44:47], s9 offen offset:3072 sc1
    s_add_u32 m0, s83, 0x21800
    s_add_u32 s81, s84, 0x3c000
    buffer_load_dwordx4 v252, s[36:39], s81 offen lds
    ds_read_b64_tr_b16 a[140:141], v248 offset:16384
    ds_read_b64_tr_b16 a[142:143], v248 offset:16896
    v_mov_b32_e32 v25, v24
    s_nop 1
    v_permlane32_swap_b32 v25, v24
    v_max_f32_e32 v24, v24, v25
    v_mul_f32_e64 v24, s6, v24
    v_fma_f32 v20, v20, s6, -v24
    v_fma_f32 v21, v21, s6, -v24
    v_fma_f32 v22, v22, s6, -v24
    v_fma_f32 v23, v23, s6, -v24
    v_exp_f32_e32 v20, v20
    v_exp_f32_e32 v21, v21
    v_exp_f32_e32 v22, v22
    v_exp_f32_e32 v23, v23
    s_waitcnt vmcnt(13) lgkmcnt(6)
    v_mfma_f32_32x32x16_bf16 v[64:79], a[128:131], a[76:79], v[64:79]
    s_waitcnt lgkmcnt(4)
    ds_read_b64_tr_b16 a[144:145], v251 offset:18432
    ds_read_b64_tr_b16 a[146:147], v251 offset:18944
    v_add_f32_e32 v26, v20, v21
    v_add_f32_e32 v27, v22, v23
    v_add_f32_e32 v26, v26, v27
    v_mov_b32_e32 v27, v26
    s_nop 1
    v_permlane32_swap_b32 v27, v26
    v_add_f32_e32 v26, v26, v27
    v_rcp_f32_e32 v26, v26
    s_nop 0
    v_mul_f32_e32 v20, v20, v26
    v_mul_f32_e32 v21, v21, v26
    v_mul_f32_e32 v22, v22, v26
    v_mul_f32_e64 v23, v23, v26
    v_cvt_pk_bf16_f32 v20, v20, v21
    v_cvt_pk_bf16_f32 v22, v22, v23
    v_and_b32_e32 v160, v20, v228
    v_and_b32_e32 v161, v22, v229
    v_mfma_f32_32x32x16_bf16 v[80:95], a[132:135], a[76:79], v[80:95]
    s_add_u32 s9, s9, 0x1000
    buffer_load_dwordx4 a[120:123], v1, s[44:47], s9 offen offset:0 sc1
    s_add_u32 s9, s87, 0x7800
    buffer_load_dwordx4 a[124:127], v1, s[44:47], s9 offen offset:0 sc1
    s_add_u32 m0, s83, 0xc000
    s_add_u32 s81, s84, 0x40000
    buffer_load_dwordx4 v252, s[36:39], s81 offen lds
    ds_read_b64_tr_b16 a[148:149], v248 offset:18432
    ds_read_b64_tr_b16 a[150:151], v248 offset:18944
    v_and_b32_e32 v162, v20, v230
    v_and_b32_e32 v163, v22, v231
    v_and_b32_e32 v164, v20, v232
    v_and_b32_e32 v165, v22, v233
    v_and_b32_e32 v166, v20, v234
    v_and_b32_e32 v167, v22, v235
    v_and_b32_e64 v170, v20, v236
    v_and_b32_e32 v171, v22, v237
    s_nop 0
    v_mfma_f32_32x32x16_bf16 v[172:187], a[32:35], v[160:163], 0
    v_mfma_f32_32x32x16_bf16 v[172:187], a[36:39], v[164:167], v[172:187]
    v_mfma_f32_32x32x16_bf16 v[172:187], a[168:171], v[168:171], v[172:187]
    s_waitcnt vmcnt(15) lgkmcnt(6)
    v_mfma_f32_32x32x16_bf16 v[64:79], a[136:139], a[80:83], v[64:79]
    s_waitcnt lgkmcnt(4)
    ds_read_b64_tr_b16 a[128:129], v251 offset:20480
    ds_read_b64_tr_b16 a[130:131], v251 offset:20992
    v_mfma_f32_32x32x16_bf16 v[128:143], a[20:23], a[52:55], v[208:223]
    v_mfma_f32_32x32x16_bf16 v[144:159], a[156:159], a[52:55], v[212:227]
    s_nop 4
    v_cvt_pk_bf16_f32 v188, v172, v173
    v_mfma_f32_32x32x16_bf16 v[80:95], a[140:143], a[80:83], v[80:95]
    buffer_load_dwordx4 a[64:67], v1, s[44:47], s9 offen offset:1024 sc1
    buffer_load_dwordx4 a[68:71], v1, s[44:47], s9 offen offset:2048 sc1
    s_add_u32 m0, s83, 0xc800
    s_add_u32 s81, s84, 0x44000
    buffer_load_dwordx4 v252, s[36:39], s81 offen lds
    ds_read_b64_tr_b16 a[132:133], v248 offset:20480
    ds_read_b64_tr_b16 a[134:135], v248 offset:20992
    v_cvt_pk_bf16_f32 v189, v174, v175
    v_cvt_pk_bf16_f32 v190, v176, v177
    v_cvt_pk_bf16_f32 v191, v178, v179
    s_add_u32 s82, s7, 0
    buffer_store_dwordx4 v[188:191], v1, s[44:47], s82 offen sc1
    s_waitcnt vmcnt(18) lgkmcnt(6)
    v_mfma_f32_32x32x16_bf16 v[64:79], a[144:147], a[84:87], v[64:79]
    s_waitcnt lgkmcnt(4)
    ds_read_b64_tr_b16 a[136:137], v251 offset:22528
    ds_read_b64_tr_b16 a[138:139], v251 offset:23040
    v_max3_f32 v20, v128, v132, v136
    v_max3_f32 v21, v129, v133, v137
    v_max3_f32 v22, v130, v134, v138
    v_max3_f32 v23, v131, v135, v139
    v_max3_f32 v20, v20, v140, v156
    v_max3_f32 v21, v21, v141, v157
    v_max3_f32 v22, v22, v142, v158
    v_max3_f32 v23, v23, v143, v159
    v_max3_f32 v24, v20, v21, v22
    v_max_f32_e64 v24, v24, v23
    v_mfma_f32_32x32x16_bf16 v[80:95], a[148:151], a[84:87], v[80:95]
    buffer_load_dwordx4 a[72:75], v1, s[44:47], s9 offen offset:3072 sc1
    s_add_u32 s9, s9, 0x1000
    buffer_load_dwordx4 a[76:79], v1, s[44:47], s9 offen offset:0 sc1
    s_add_u32 m0, s83, 0xd000
    s_add_u32 s81, s84, 0x64000
    buffer_load_dwordx4 v252, s[36:39], s81 offen lds
    ds_read_b64_tr_b16 a[140:141], v248 offset:22528
    ds_read_b64_tr_b16 a[142:143], v248 offset:23040
    v_mov_b32_e32 v25, v24
    s_nop 1
    v_permlane32_swap_b32 v25, v24
    v_max_f32_e32 v24, v24, v25
    v_mul_f32_e64 v24, s6, v24
    v_fma_f32 v20, v20, s6, -v24
    v_fma_f32 v21, v21, s6, -v24
    v_fma_f32 v22, v22, s6, -v24
    v_fma_f32 v23, v23, s6, -v24
    v_exp_f32_e32 v20, v20
    v_exp_f32_e32 v21, v21
    v_exp_f32_e64 v22, v22
    v_exp_f32_e32 v23, v23
    s_waitcnt vmcnt(20) lgkmcnt(6)
    v_mfma_f32_32x32x16_bf16 v[64:79], a[128:131], a[88:91], v[64:79]
    s_waitcnt lgkmcnt(0)
    s_barrier
    ds_read_b64_tr_b16 a[144:145], v251 offset:32768
    ds_read_b64_tr_b16 a[146:147], v251 offset:33280
    v_add_f32_e32 v26, v20, v21
    v_add_f32_e32 v27, v22, v23
    v_add_f32_e32 v26, v26, v27
    v_mov_b32_e32 v27, v26
    s_nop 1
    v_permlane32_swap_b32 v27, v26
    v_add_f32_e32 v26, v26, v27
    v_rcp_f32_e32 v26, v26
    s_nop 0
    v_mul_f32_e32 v20, v20, v26
    v_mul_f32_e32 v21, v21, v26
    v_mul_f32_e32 v22, v22, v26
    v_mul_f32_e64 v23, v23, v26
    v_cvt_pk_bf16_f32 v20, v20, v21
    v_cvt_pk_bf16_f32 v22, v22, v23
    v_and_b32_e32 v160, v20, v228
    v_and_b32_e32 v161, v22, v229
    v_mfma_f32_32x32x16_bf16 v[80:95], a[132:135], a[88:91], v[80:95]
    s_add_u32 m0, s83, 0xd800
    s_add_u32 s81, s84, 0x68000
    buffer_load_dwordx4 v252, s[36:39], s81 offen lds
    ds_read_b64_tr_b16 a[148:149], v248 offset:32768
    ds_read_b64_tr_b16 a[150:151], v248 offset:33280
    v_and_b32_e32 v162, v20, v230
    v_and_b32_e32 v163, v22, v231
    v_and_b32_e32 v164, v20, v232
    v_and_b32_e32 v165, v22, v233
    v_and_b32_e32 v166, v20, v234
    v_and_b32_e32 v167, v22, v235
    v_and_b32_e64 v170, v20, v236
    v_and_b32_e32 v171, v22, v237
    s_nop 0
    v_mfma_f32_32x32x16_bf16 v[172:187], a[32:35], v[160:163], 0
    v_mfma_f32_32x32x16_bf16 v[172:187], a[36:39], v[164:167], v[172:187]
    v_mfma_f32_32x32x16_bf16 v[172:187], a[168:171], v[168:171], v[172:187]
    s_waitcnt vmcnt(20)
    v_mfma_f32_32x32x16_bf16 v[64:79], a[136:139], a[92:95], v[64:79]
    ds_read_b64_tr_b16 a[128:129], v251 offset:34816
    ds_read_b64_tr_b16 a[130:131], v251 offset:35328
    v_mfma_f32_32x32x16_bf16 v[128:143], a[24:27], a[56:59], v[208:223]
    v_mfma_f32_32x32x16_bf16 v[144:159], a[160:163], a[56:59], v[212:227]
    s_nop 5
    v_cvt_pk_bf16_f32 v188, v180, v181
    v_mfma_f32_32x32x16_bf16 v[80:95], a[140:143], a[92:95], v[80:95]
    s_add_u32 m0, s83, 0x14000
    s_add_u32 s81, s84, 0x6c000
    buffer_load_dwordx4 v252, s[36:39], s81 offen lds
    ds_read_b64_tr_b16 a[132:133], v248 offset:34816
    ds_read_b64_tr_b16 a[134:135], v248 offset:35328
    v_cvt_pk_bf16_f32 v189, v182, v183
    v_cvt_pk_bf16_f32 v190, v184, v185
    v_cvt_pk_bf16_f32 v191, v186, v187
    s_add_u32 s82, s7, 1024
    buffer_store_dwordx4 v[188:191], v1, s[44:47], s82 offen sc1
    s_waitcnt vmcnt(21) lgkmcnt(6)
    v_mfma_f32_32x32x16_bf16 v[64:79], a[144:147], a[96:99], v[64:79]
    s_waitcnt lgkmcnt(4)
    ds_read_b64_tr_b16 a[136:137], v251 offset:36864
    ds_read_b64_tr_b16 a[138:139], v251 offset:37376
    v_max3_f32 v20, v128, v132, v136
    v_max3_f32 v21, v129, v133, v137
    v_max3_f32 v22, v130, v134, v138
    v_max3_f32 v23, v131, v135, v139
    v_max3_f32 v20, v20, v140, v156
    v_max3_f32 v21, v21, v141, v157
    v_max3_f32 v22, v22, v142, v158
    v_max3_f32 v23, v23, v143, v159
    v_max3_f32 v24, v20, v21, v22
    v_max_f32_e32 v24, v24, v23
    v_mov_b32_e32 v25, v24
    s_nop 1
    v_permlane32_swap_b32 v25, v24
    v_max_f32_e32 v24, v24, v25
    v_mul_f32_e32 v24, s6, v24
    v_fma_f32 v20, v20, s6, -v24
    v_mfma_f32_32x32x16_bf16 v[80:95], a[148:151], a[96:99], v[80:95]
    s_add_u32 m0, s83, 0x14800
    s_add_u32 s81, s84, 0x8c000
    buffer_load_dwordx4 v252, s[36:39], s81 offen lds
    ds_read_b64_tr_b16 a[140:141], v248 offset:36864
    ds_read_b64_tr_b16 a[142:143], v248 offset:37376
    v_fma_f32 v21, v21, s6, -v24
    v_fma_f32 v22, v22, s6, -v24
    v_fma_f32 v23, v23, s6, -v24
    v_exp_f32_e32 v20, v20
    v_exp_f32_e32 v21, v21
    v_exp_f32_e64 v22, v22
    v_exp_f32_e32 v23, v23
    s_lshl_b32 s11, s64, 8
    s_add_u32 s11, s11, 0x3000
    v_and_b32_e32 v19, 31, v0
    v_lshlrev_b32_e32 v19, 2, v19
    buffer_load_dword v19, v19, s[44:47], s11 offen sc1
    s_waitcnt vmcnt(22) lgkmcnt(6)
    v_mfma_f32_32x32x16_bf16 v[64:79], a[128:131], a[100:103], v[64:79]
    s_waitcnt lgkmcnt(4)
    ds_read_b64_tr_b16 a[144:145], v251 offset:38912
    ds_read_b64_tr_b16 a[146:147], v251 offset:39424
    v_add_f32_e32 v26, v20, v21
    v_add_f32_e32 v27, v22, v23
    v_add_f32_e32 v26, v26, v27
    v_mov_b32_e32 v27, v26
    s_nop 1
    v_permlane32_swap_b32 v27, v26
    v_add_f32_e32 v26, v26, v27
    v_rcp_f32_e32 v26, v26
    s_nop 0
    v_mul_f32_e32 v20, v20, v26
    v_mul_f32_e32 v21, v21, v26
    v_mul_f32_e32 v22, v22, v26
    v_mul_f32_e64 v23, v23, v26
    v_cvt_pk_bf16_f32 v20, v20, v21
    v_cvt_pk_bf16_f32 v22, v22, v23
    v_and_b32_e32 v160, v20, v228
    v_and_b32_e32 v161, v22, v229
    v_mfma_f32_32x32x16_bf16 v[80:95], a[132:135], a[100:103], v[80:95]
    s_add_u32 m0, s83, 0x15000
    s_add_u32 s81, s84, 0x90000
    buffer_load_dwordx4 v252, s[36:39], s81 offen lds
    ds_read_b64_tr_b16 a[148:149], v248 offset:38912
    ds_read_b64_tr_b16 a[150:151], v248 offset:39424
    v_and_b32_e32 v162, v20, v230
    v_and_b32_e32 v163, v22, v231
    v_and_b32_e32 v164, v20, v232
    v_and_b32_e32 v165, v22, v233
    v_and_b32_e32 v166, v20, v234
    v_and_b32_e32 v167, v22, v235
    v_and_b32_e32 v170, v20, v236
    v_and_b32_e32 v171, v22, v237
    s_nop 0
    v_mfma_f32_32x32x16_bf16 v[172:187], a[40:43], v[160:163], 0
    v_mfma_f32_32x32x16_bf16 v[172:187], a[44:47], v[164:167], v[172:187]
    v_mfma_f32_32x32x16_bf16 v[172:187], a[172:175], v[168:171], v[172:187]
    s_waitcnt vmcnt(21) lgkmcnt(6)
    v_mfma_f32_32x32x16_bf16 v[64:79], a[136:139], a[104:107], v[64:79]
    s_waitcnt lgkmcnt(4)
    ds_read_b64_tr_b16 a[128:129], v250 offset:0
    ds_read_b64_tr_b16 a[130:131], v250 offset:512
    v_mfma_f32_32x32x16_bf16 v[128:143], a[28:31], a[60:63], v[208:223]
    v_mfma_f32_32x32x16_bf16 v[144:159], a[164:167], a[60:63], v[212:227]
    s_nop 4
    v_cvt_pk_bf16_f32 v188, v172, v173
    v_mfma_f32_32x32x16_bf16 v[80:95], a[140:143], a[104:107], v[80:95]
    s_add_u32 m0, s83, 0x15800
    s_add_u32 s81, s84, 0x94000
    buffer_load_dwordx4 v252, s[36:39], s81 offen lds
    ds_read_b64_tr_b16 a[132:133], v247 offset:0
    ds_read_b64_tr_b16 a[134:135], v247 offset:512
    v_cvt_pk_bf16_f32 v189, v174, v175
    v_cvt_pk_bf16_f32 v190, v176, v177
    v_cvt_pk_bf16_f32 v191, v178, v179
    s_add_u32 s82, s7, 2048
    buffer_store_dwordx4 v[188:191], v1, s[44:47], s82 offen sc1
    s_waitcnt vmcnt(22) lgkmcnt(6)
    v_mfma_f32_32x32x16_bf16 v[64:79], a[144:147], a[108:111], v[64:79]
    s_waitcnt lgkmcnt(4)
    ds_read_b64_tr_b16 a[136:137], v250 offset:2048
    ds_read_b64_tr_b16 a[138:139], v250 offset:2560
    v_max3_f32 v20, v128, v132, v136
    v_max3_f32 v21, v129, v133, v137
    v_max3_f32 v22, v130, v134, v138
    v_max3_f32 v23, v131, v135, v139
    v_max3_f32 v20, v20, v140, v156
    v_max3_f32 v21, v21, v141, v157
    v_max3_f32 v22, v22, v142, v158
    v_max3_f32 v23, v23, v143, v159
    v_max3_f32 v24, v20, v21, v22
    v_max_f32_e64 v24, v24, v23
    v_mfma_f32_32x32x16_bf16 v[80:95], a[148:151], a[108:111], v[80:95]
    ds_read_b64_tr_b16 a[140:141], v247 offset:2048
    ds_read_b64_tr_b16 a[142:143], v247 offset:2560
    v_mov_b32_e32 v25, v24
    s_nop 1
    v_permlane32_swap_b32 v25, v24
    v_max_f32_e32 v24, v24, v25
    v_mul_f32_e64 v24, s6, v24
    v_fma_f32 v20, v20, s6, -v24
    v_fma_f32 v21, v21, s6, -v24
    v_fma_f32 v22, v22, s6, -v24
    v_fma_f32 v23, v23, s6, -v24
    v_exp_f32_e32 v20, v20
    v_exp_f32_e32 v21, v21
    v_exp_f32_e32 v22, v22
    v_exp_f32_e32 v23, v23
    s_waitcnt vmcnt(20) lgkmcnt(6)
    v_mfma_f32_32x32x16_bf16 v[64:79], a[128:131], a[112:115], v[64:79]
    s_waitcnt lgkmcnt(4)
    ds_read_b64_tr_b16 a[144:145], v250 offset:4096
    ds_read_b64_tr_b16 a[146:147], v250 offset:4608
    v_add_f32_e32 v26, v20, v21
    v_add_f32_e32 v27, v22, v23
    v_add_f32_e32 v26, v26, v27
    v_mov_b32_e32 v27, v26
    s_nop 1
    v_permlane32_swap_b32 v27, v26
    v_add_f32_e32 v26, v26, v27
    v_rcp_f32_e32 v26, v26
    s_nop 0
    v_mul_f32_e32 v20, v20, v26
    v_mul_f32_e32 v21, v21, v26
    v_mul_f32_e32 v22, v22, v26
    v_mul_f32_e64 v23, v23, v26
    v_cvt_pk_bf16_f32 v20, v20, v21
    v_cvt_pk_bf16_f32 v22, v22, v23
    v_and_b32_e32 v160, v20, v228
    v_and_b32_e32 v161, v22, v229
    v_mfma_f32_32x32x16_bf16 v[80:95], a[132:135], a[112:115], v[80:95]
    s_add_u32 m0, s83, 0x1c000
    s_add_u32 s81, s85, 0x140000
    buffer_load_dwordx4 v252, s[36:39], s81 offen lds
    ds_read_b64_tr_b16 a[148:149], v247 offset:4096
    ds_read_b64_tr_b16 a[150:151], v247 offset:4608
    v_and_b32_e32 v162, v20, v230
    v_and_b32_e32 v163, v22, v231
    v_and_b32_e32 v164, v20, v232
    v_and_b32_e32 v165, v22, v233
    v_and_b32_e32 v166, v20, v234
    v_and_b32_e32 v167, v22, v235
    v_and_b32_e32 v170, v20, v236
    v_and_b32_e32 v171, v22, v237
    s_nop 0
    v_mfma_f32_32x32x16_bf16 v[172:187], a[40:43], v[160:163], 0
    v_mfma_f32_32x32x16_bf16 v[172:187], a[44:47], v[164:167], v[172:187]
    v_mfma_f32_32x32x16_bf16 v[172:187], a[172:175], v[168:171], v[172:187]
    s_waitcnt vmcnt(20) lgkmcnt(6)
    v_mfma_f32_32x32x16_bf16 v[64:79], a[136:139], a[116:119], v[64:79]
    s_waitcnt lgkmcnt(4)
    ds_read_b64_tr_b16 a[128:129], v250 offset:6144
    ds_read_b64_tr_b16 a[130:131], v250 offset:6656
    s_nop 6
    v_cvt_pk_bf16_f32 v188, v180, v181
    v_cvt_pk_bf16_f32 v189, v182, v183
    v_cvt_pk_bf16_f32 v190, v184, v185
    v_cvt_pk_bf16_f32 v191, v186, v187
    s_add_u32 s82, s7, 3072
    v_mfma_f32_32x32x16_bf16 v[80:95], a[140:143], a[116:119], v[80:95]
    s_waitcnt vmcnt(4)
    v_cmp_ne_u32 vcc, s67, v19
    s_nop 1
    s_cmp_lg_u64 vcc, 0
    s_cbranch_scc1 L_slow_10
L_back_11:
    s_add_u32 s9, s87, 0x1400
    buffer_load_dwordx4 a[80:83], v1, s[44:47], s9 offen offset:0 sc1
    buffer_load_dwordx4 a[84:87], v1, s[44:47], s9 offen offset:1024 sc1
    s_add_u32 m0, s83, 0x1c800
    s_add_u32 s81, s85, 0x144000
    buffer_load_dwordx4 v252, s[36:39], s81 offen lds
    buffer_store_dwordx4 v[188:191], v1, s[44:47], s82 offen sc1
    ds_read_b64_tr_b16 a[132:133], v247 offset:6144
    ds_read_b64_tr_b16 a[134:135], v247 offset:6656
    s_waitcnt lgkmcnt(6)
    v_mfma_f32_32x32x16_bf16 v[64:79], a[144:147], a[120:123], v[64:79]
    s_waitcnt lgkmcnt(0)
    s_barrier
    ds_read_b64_tr_b16 a[136:137], v250 offset:32768
    ds_read_b64_tr_b16 a[138:139], v250 offset:33280
    v_mfma_f32_32x32x16_bf16 v[80:95], a[148:151], a[120:123], v[80:95]
    buffer_load_dwordx4 a[88:91], v1, s[44:47], s9 offen offset:2048 sc1
    s_add_u32 s9, s87, 0x3c00
    buffer_load_dwordx4 a[92:95], v1, s[44:47], s9 offen offset:0 sc1
    s_add_u32 m0, s83, 0x1d000
    s_add_u32 s81, s85, 0x148000
    buffer_load_dwordx4 v252, s[36:39], s81 offen lds
    ds_read_b64_tr_b16 a[140:141], v247 offset:32768
    ds_read_b64_tr_b16 a[142:143], v247 offset:33280
    v_mfma_f32_32x32x16_bf16 v[64:79], a[128:131], a[124:127], v[64:79]
    ds_read_b64_tr_b16 a[144:145], v250 offset:34816
    ds_read_b64_tr_b16 a[146:147], v250 offset:35328
    v_mfma_f32_32x32x16_bf16 v[80:95], a[132:135], a[124:127], v[80:95]
    buffer_load_dwordx4 a[96:99], v1, s[44:47], s9 offen offset:1024 sc1
    buffer_load_dwordx4 a[100:103], v1, s[44:47], s9 offen offset:2048 sc1
    s_add_u32 m0, s83, 0x1d800
    s_add_u32 s81, s85, 0x14c000
    buffer_load_dwordx4 v252, s[36:39], s81 offen lds
    ds_read_b64_tr_b16 a[148:149], v247 offset:34816
    ds_read_b64_tr_b16 a[150:151], v247 offset:35328
    s_waitcnt lgkmcnt(6)
    v_mfma_f32_32x32x16_bf16 v[64:79], a[136:139], a[64:67], v[64:79]
    s_waitcnt lgkmcnt(4)
    ds_read_b64_tr_b16 a[128:129], v250 offset:36864
    ds_read_b64_tr_b16 a[130:131], v250 offset:37376
    v_mfma_f32_32x32x16_bf16 v[80:95], a[140:143], a[64:67], v[80:95]
    s_add_u32 s9, s87, 0x6400
    buffer_load_dwordx4 a[104:107], v1, s[44:47], s9 offen offset:0 sc1
    buffer_load_dwordx4 a[108:111], v1, s[44:47], s9 offen offset:1024 sc1
    s_add_u32 m0, s83, 0x24000
    s_add_u32 s81, s85, 0x150000
    buffer_load_dwordx4 v252, s[36:39], s81 offen lds
    ds_read_b64_tr_b16 a[132:133], v247 offset:36864
    ds_read_b64_tr_b16 a[134:135], v247 offset:37376
    s_waitcnt lgkmcnt(6)
    v_mfma_f32_32x32x16_bf16 v[64:79], a[144:147], a[68:71], v[64:79]
    s_waitcnt lgkmcnt(4)
    ds_read_b64_tr_b16 a[136:137], v250 offset:38912
    ds_read_b64_tr_b16 a[138:139], v250 offset:39424
    v_mfma_f32_32x32x16_bf16 v[80:95], a[148:151], a[68:71], v[80:95]
    buffer_load_dwordx4 a[112:115], v1, s[44:47], s9 offen offset:2048 sc1
    s_add_u32 s9, s87, 0x8c00
    buffer_load_dwordx4 a[116:119], v1, s[44:47], s9 offen offset:0 sc1
    s_add_u32 m0, s83, 0x24800
    s_add_u32 s81, s85, 0x154000
    buffer_load_dwordx4 v252, s[36:39], s81 offen lds
    ds_read_b64_tr_b16 a[140:141], v247 offset:38912
    ds_read_b64_tr_b16 a[142:143], v247 offset:39424
    s_waitcnt lgkmcnt(6)
    v_mfma_f32_32x32x16_bf16 v[64:79], a[128:131], a[72:75], v[64:79]
    s_waitcnt lgkmcnt(4)
    ds_read_b64_tr_b16 a[144:145], v249 offset:0
    ds_read_b64_tr_b16 a[146:147], v249 offset:512
    v_mfma_f32_32x32x16_bf16 v[80:95], a[132:135], a[72:75], v[80:95]
    buffer_load_dwordx4 a[120:123], v1, s[44:47], s9 offen offset:1024 sc1
    buffer_load_dwordx4 a[124:127], v1, s[44:47], s9 offen offset:2048 sc1
    s_add_u32 m0, s83, 0x25000
    s_add_u32 s81, s85, 0x158000
    buffer_load_dwordx4 v252, s[36:39], s81 offen lds
    ds_read_b64_tr_b16 a[148:149], v246 offset:0
    ds_read_b64_tr_b16 a[150:151], v246 offset:512
    s_waitcnt lgkmcnt(6)
    v_mfma_f32_32x32x16_bf16 v[64:79], a[136:139], a[76:79], v[64:79]
    s_waitcnt lgkmcnt(4)
    ds_read_b64_tr_b16 a[128:129], v249 offset:2048
    ds_read_b64_tr_b16 a[130:131], v249 offset:2560
    v_mfma_f32_32x32x16_bf16 v[80:95], a[140:143], a[76:79], v[80:95]
    s_add_u32 s9, s88, 0x14000
    buffer_load_dwordx4 a[64:67], v1, s[44:47], s9 offen offset:0 sc1
    buffer_load_dwordx4 a[68:71], v1, s[44:47], s9 offen offset:1024 sc1
    s_add_u32 m0, s83, 0x25800
    s_add_u32 s81, s85, 0x15c000
    buffer_load_dwordx4 v252, s[36:39], s81 offen lds
    ds_read_b64_tr_b16 a[132:133], v246 offset:2048
    ds_read_b64_tr_b16 a[134:135], v246 offset:2560
    s_waitcnt vmcnt(21) lgkmcnt(6)
    v_mfma_f32_32x32x16_bf16 v[64:79], a[144:147], a[80:83], v[64:79]
    s_waitcnt lgkmcnt(4)
    ds_read_b64_tr_b16 a[136:137], v249 offset:4096
    ds_read_b64_tr_b16 a[138:139], v249 offset:4608
    s_waitcnt vmcnt(18)
    v_mfma_f32_32x32x16_bf16 v[80:95], a[148:151], a[80:83], v[80:95]
    buffer_load_dwordx4 a[72:75], v1, s[44:47], s9 offen offset:2048 sc1
    s_add_u32 m0, s83, 0x0
    s_add_u32 s81, s85, 0x160000
    buffer_load_dwordx4 v252, s[36:39], s81 offen lds
    ds_read_b64_tr_b16 a[140:141], v246 offset:4096
    ds_read_b64_tr_b16 a[142:143], v246 offset:4608
    s_lshl_b32 s69, s60, 1
    s_add_u32 s69, s69, s57
    s_lshl_b32 s90, s62, 8
    s_lshl_b32 s69, s69, 2
    s_add_u32 s90, s90, s69
    s_add_u32 s90, s90, 0x5000
    buffer_store_dword v253, v18, s[44:47], s90 offen sc1
    s_waitcnt lgkmcnt(6)
    v_mfma_f32_32x32x16_bf16 v[64:79], a[128:131], a[84:87], v[64:79]
    s_waitcnt lgkmcnt(4)
    ds_read_b64_tr_b16 a[144:145], v249 offset:6144
    ds_read_b64_tr_b16 a[146:147], v249 offset:6656
    v_mfma_f32_32x32x16_bf16 v[80:95], a[132:135], a[84:87], v[80:95]
    buffer_load_dwordx4 a[76:79], v1, s[44:47], s9 offen offset:3072 sc1
    ds_read_b64_tr_b16 a[148:149], v246 offset:6144
    ds_read_b64_tr_b16 a[150:151], v246 offset:6656
    s_waitcnt vmcnt(21) lgkmcnt(6)
    v_mfma_f32_32x32x16_bf16 v[64:79], a[136:139], a[88:91], v[64:79]
    s_waitcnt lgkmcnt(0)
    s_barrier
    ds_read_b64_tr_b16 a[128:129], v251 offset:49152
    ds_read_b64_tr_b16 a[130:131], v251 offset:49664
    v_mfma_f32_32x32x16_bf16 v[80:95], a[140:143], a[88:91], v[80:95]
    s_add_u32 s9, s88, 0x15000
    buffer_load_dwordx4 a[80:83], v1, s[44:47], s9 offen offset:0 sc1
    s_add_u32 m0, s83, 0x800
    s_add_u32 s81, s85, 0x164000
    buffer_load_dwordx4 v252, s[36:39], s81 offen lds
    ds_read_b64_tr_b16 a[132:133], v248 offset:49152
    ds_read_b64_tr_b16 a[134:135], v248 offset:49664
    s_waitcnt vmcnt(22)
    v_mfma_f32_32x32x16_bf16 v[64:79], a[144:147], a[92:95], v[64:79]
    s_nop 0
    ds_read_b64_tr_b16 a[136:137], v251 offset:51200
    ds_read_b64_tr_b16 a[138:139], v251 offset:51712
    v_mfma_f32_32x32x16_bf16 v[80:95], a[148:151], a[92:95], v[80:95]
    buffer_load_dwordx4 a[84:87], v1, s[44:47], s9 offen offset:1024 sc1
    s_add_u32 m0, s83, 0x1000
    s_add_u32 s81, s85, 0x168000
    buffer_load_dwordx4 v252, s[36:39], s81 offen lds
    ds_read_b64_tr_b16 a[140:141], v248 offset:51200
    ds_read_b64_tr_b16 a[142:143], v248 offset:51712
    s_waitcnt vmcnt(22) lgkmcnt(6)
    v_mfma_f32_32x32x16_bf16 v[64:79], a[128:131], a[96:99], v[64:79]
    s_waitcnt lgkmcnt(4)
    ds_read_b64_tr_b16 a[144:145], v251 offset:53248
    ds_read_b64_tr_b16 a[146:147], v251 offset:53760
    v_mfma_f32_32x32x16_bf16 v[80:95], a[132:135], a[96:99], v[80:95]
    buffer_load_dwordx4 a[88:91], v1, s[44:47], s9 offen offset:2048 sc1
    s_add_u32 m0, s83, 0x1800
    s_add_u32 s81, s85, 0x16c000
    buffer_load_dwordx4 v252, s[36:39], s81 offen lds
    ds_read_b64_tr_b16 a[148:149], v248 offset:53248
    ds_read_b64_tr_b16 a[150:151], v248 offset:53760
    s_waitcnt vmcnt(23) lgkmcnt(6)
    v_mfma_f32_32x32x16_bf16 v[64:79], a[136:139], a[100:103], v[64:79]
    s_waitcnt lgkmcnt(4)
    ds_read_b64_tr_b16 a[128:129], v251 offset:55296
    ds_read_b64_tr_b16 a[130:131], v251 offset:55808
    v_mfma_f32_32x32x16_bf16 v[80:95], a[140:143], a[100:103], v[80:95]
    buffer_load_dwordx4 a[92:95], v1, s[44:47], s9 offen offset:3072 sc1
    s_add_u32 m0, s83, 0x4000
    s_add_u32 s81, s85, 0x170000
    buffer_load_dwordx4 v252, s[36:39], s81 offen lds
    ds_read_b64_tr_b16 a[132:133], v248 offset:55296
    ds_read_b64_tr_b16 a[134:135], v248 offset:55808
    s_waitcnt vmcnt(23) lgkmcnt(6)
    v_mfma_f32_32x32x16_bf16 v[64:79], a[144:147], a[104:107], v[64:79]
    s_waitcnt lgkmcnt(4)
    ds_read_b64_tr_b16 a[136:137], v250 offset:16384
    ds_read_b64_tr_b16 a[138:139], v250 offset:16896
    v_mfma_f32_32x32x16_bf16 v[80:95], a[148:151], a[104:107], v[80:95]
    s_add_u32 s9, s88, 0x16000
    buffer_load_dwordx4 a[96:99], v1, s[44:47], s9 offen offset:0 sc1
    s_add_u32 m0, s83, 0x4800
    s_add_u32 s81, s85, 0x174000
    buffer_load_dwordx4 v252, s[36:39], s81 offen lds
    ds_read_b64_tr_b16 a[140:141], v247 offset:16384
    ds_read_b64_tr_b16 a[142:143], v247 offset:16896
    s_waitcnt vmcnt(24) lgkmcnt(6)
    v_mfma_f32_32x32x16_bf16 v[64:79], a[128:131], a[108:111], v[64:79]
    s_waitcnt lgkmcnt(4)
    ds_read_b64_tr_b16 a[144:145], v250 offset:18432
    ds_read_b64_tr_b16 a[146:147], v250 offset:18944
    v_mfma_f32_32x32x16_bf16 v[80:95], a[132:135], a[108:111], v[80:95]
    buffer_load_dwordx4 a[100:103], v1, s[44:47], s9 offen offset:1024 sc1
    s_add_u32 m0, s83, 0x5000
    s_add_u32 s81, s85, 0x178000
    buffer_load_dwordx4 v252, s[36:39], s81 offen lds
    ds_read_b64_tr_b16 a[148:149], v247 offset:18432
    ds_read_b64_tr_b16 a[150:151], v247 offset:18944
    s_waitcnt vmcnt(24) lgkmcnt(6)
    v_mfma_f32_32x32x16_bf16 v[64:79], a[136:139], a[112:115], v[64:79]
    s_waitcnt lgkmcnt(4)
    ds_read_b64_tr_b16 a[128:129], v250 offset:20480
    ds_read_b64_tr_b16 a[130:131], v250 offset:20992
    v_mfma_f32_32x32x16_bf16 v[80:95], a[140:143], a[112:115], v[80:95]
    buffer_load_dwordx4 a[104:107], v1, s[44:47], s9 offen offset:2048 sc1
    s_add_u32 m0, s83, 0x5800
    s_add_u32 s81, s85, 0x17c000
    buffer_load_dwordx4 v252, s[36:39], s81 offen lds
    ds_read_b64_tr_b16 a[132:133], v247 offset:20480
    ds_read_b64_tr_b16 a[134:135], v247 offset:20992
    s_waitcnt vmcnt(25) lgkmcnt(6)
    v_mfma_f32_32x32x16_bf16 v[64:79], a[144:147], a[116:119], v[64:79]
    s_waitcnt lgkmcnt(4)
    ds_read_b64_tr_b16 a[136:137], v250 offset:22528
    ds_read_b64_tr_b16 a[138:139], v250 offset:23040
    s_lshl_b32 s11, s64, 8
    s_add_u32 s11, s11, 0x9000
    v_and_b32_e32 v19, 15, v0
    v_lshlrev_b32_e64 v19, 2, v19
    v_mfma_f32_32x32x16_bf16 v[80:95], a[148:151], a[116:119], v[80:95]
    buffer_load_dwordx4 a[108:111], v1, s[44:47], s9 offen offset:3072 sc1
    s_add_u32 m0, s83, 0x8000
    s_add_u32 s81, s84, 0x20000
    buffer_load_dwordx4 v252, s[36:39], s81 offen lds
    buffer_load_dword v19, v19, s[44:47], s11 offen sc1
    ds_read_b64_tr_b16 a[140:141], v247 offset:22528
    ds_read_b64_tr_b16 a[142:143], v247 offset:23040
    s_waitcnt vmcnt(26) lgkmcnt(6)
    v_mfma_f32_32x32x16_bf16 v[64:79], a[128:131], a[120:123], v[64:79]
    s_waitcnt vmcnt(21) lgkmcnt(0)
    s_barrier
    ds_read_b64_tr_b16 a[144:145], v250 offset:49152
    ds_read_b64_tr_b16 a[146:147], v250 offset:49664
    v_lshrrev_b32_e32 v245, 3, v0
    v_lshlrev_b32_e32 v245, 10, v245
    v_and_b32_e32 v20, 7, v0
    v_lshl_add_u32 v245, v20, 4, v245
    s_lshl_b32 s68, s64, 6
    s_lshl_b32 s69, s56, 4
    s_add_u32 s68, s68, s69
    s_lshl_b32 s68, s68, 10
    v_mfma_f32_32x32x16_bf16 v[80:95], a[132:135], a[120:123], v[80:95]
    s_add_u32 s9, s88, 0x17000
    buffer_load_dwordx4 a[112:115], v1, s[44:47], s9 offen offset:0 sc1
    s_add_u32 m0, s83, 0x8800
    s_add_u32 s81, s84, 0x24000
    buffer_load_dwordx4 v252, s[36:39], s81 offen lds
    ds_read_b64_tr_b16 a[148:149], v247 offset:49152
    ds_read_b64_tr_b16 a[150:151], v247 offset:49664
    s_lshl_b32 s69, s65, 7
    s_add_u32 s4, s68, s69
    s_add_u32 s5, s4, 8192
    buffer_load_dwordx4 v[192:195], v245, s[24:27], s4 offen
    buffer_load_dwordx4 v[196:199], v245, s[24:27], s5 offen
    v_mfma_f32_32x32x16_bf16 v[64:79], a[136:139], a[124:127], v[64:79]
    ds_read_b64_tr_b16 a[128:129], v250 offset:51200
    ds_read_b64_tr_b16 a[130:131], v250 offset:51712
    v_mfma_f32_32x32x16_bf16 v[80:95], a[140:143], a[124:127], v[80:95]
    buffer_load_dwordx4 a[116:119], v1, s[44:47], s9 offen offset:1024 sc1
    s_add_u32 m0, s83, 0x9000
    s_add_u32 s81, s84, 0x48000
    buffer_load_dwordx4 v252, s[36:39], s81 offen lds
    ds_read_b64_tr_b16 a[132:133], v247 offset:51200
    ds_read_b64_tr_b16 a[134:135], v247 offset:51712
    s_waitcnt lgkmcnt(6)
    v_mfma_f32_32x32x16_bf16 v[64:79], a[144:147], a[64:67], v[64:79]
    s_waitcnt lgkmcnt(4)
    ds_read_b64_tr_b16 a[136:137], v250 offset:53248
    ds_read_b64_tr_b16 a[138:139], v250 offset:53760
    v_mfma_f32_32x32x16_bf16 v[80:95], a[148:151], a[64:67], v[80:95]
    buffer_load_dwordx4 a[120:123], v1, s[44:47], s9 offen offset:2048 sc1
    ds_read_b64_tr_b16 a[140:141], v247 offset:53248
    ds_read_b64_tr_b16 a[142:143], v247 offset:53760
    s_waitcnt lgkmcnt(6)
    v_mfma_f32_32x32x16_bf16 v[64:79], a[128:131], a[68:71], v[64:79]
    s_waitcnt lgkmcnt(4)
    ds_read_b64_tr_b16 a[144:145], v250 offset:55296
    ds_read_b64_tr_b16 a[146:147], v250 offset:55808
    v_mfma_f32_32x32x16_bf16 v[80:95], a[132:135], a[68:71], v[80:95]
    buffer_load_dwordx4 a[124:127], v1, s[44:47], s9 offen offset:3072 sc1
    s_add_u32 m0, s83, 0x9800
    s_add_u32 s81, s84, 0x4c000
    buffer_load_dwordx4 v252, s[36:39], s81 offen lds
    ds_read_b64_tr_b16 a[148:149], v247 offset:55296
    ds_read_b64_tr_b16 a[150:151], v247 offset:55808
    s_waitcnt vmcnt(29) lgkmcnt(6)
    v_mfma_f32_32x32x16_bf16 v[64:79], a[136:139], a[72:75], v[64:79]
    s_waitcnt lgkmcnt(4)
    ds_read_b64_tr_b16 a[128:129], v249 offset:16384
    ds_read_b64_tr_b16 a[130:131], v249 offset:16896
    v_mfma_f32_32x32x16_bf16 v[80:95], a[140:143], a[72:75], v[80:95]
    s_waitcnt vmcnt(9)
    v_cmp_ne_u32 vcc, s67, v19
    s_nop 1
    s_cmp_lg_u64 vcc, 0
    s_cbranch_scc1 L_slow_13
L_back_14:
    s_add_u32 s9, s87, 0x2000
    buffer_load_dwordx4 a[64:67], v1, s[44:47], s9 offen offset:0 sc1
    s_add_u32 m0, s83, 0x10000
    s_add_u32 s81, s84, 0x70000
    buffer_load_dwordx4 v252, s[36:39], s81 offen lds
    ds_read_b64_tr_b16 a[132:133], v246 offset:16384
    ds_read_b64_tr_b16 a[134:135], v246 offset:16896
    s_waitcnt lgkmcnt(6)
    v_mfma_f32_32x32x16_bf16 v[64:79], a[144:147], a[76:79], v[64:79]
    s_waitcnt lgkmcnt(4)
    ds_read_b64_tr_b16 a[136:137], v249 offset:18432
    ds_read_b64_tr_b16 a[138:139], v249 offset:18944
    v_mfma_f32_32x32x16_bf16 v[80:95], a[148:151], a[76:79], v[80:95]
    s_nop 0
    buffer_load_dwordx4 a[68:71], v1, s[44:47], s9 offen offset:1024 sc1
    s_add_u32 m0, s83, 0x10800
    s_add_u32 s81, s84, 0x74000
    buffer_load_dwordx4 v252, s[36:39], s81 offen lds
    ds_read_b64_tr_b16 a[140:141], v246 offset:18432
    ds_read_b64_tr_b16 a[142:143], v246 offset:18944
    s_waitcnt lgkmcnt(6)
    v_mfma_f32_32x32x16_bf16 v[64:79], a[128:131], a[80:83], v[64:79]
    s_waitcnt lgkmcnt(4)
    ds_read_b64_tr_b16 a[144:145], v249 offset:20480
    ds_read_b64_tr_b16 a[146:147], v249 offset:20992
    v_mfma_f32_32x32x16_bf16 v[80:95], a[132:135], a[80:83], v[80:95]
    s_add_u32 s9, s87, 0x4800
    buffer_load_dwordx4 a[72:75], v1, s[44:47], s9 offen offset:0 sc1
    s_add_u32 m0, s83, 0x11000
    s_add_u32 s81, s84, 0x98000
    buffer_load_dwordx4 v252, s[36:39], s81 offen lds
    ds_read_b64_tr_b16 a[148:149], v246 offset:20480
    ds_read_b64_tr_b16 a[150:151], v246 offset:20992
    s_waitcnt lgkmcnt(6)
    v_mfma_f32_32x32x16_bf16 v[64:79], a[136:139], a[84:87], v[64:79]
    s_waitcnt lgkmcnt(4)
    ds_read_b64_tr_b16 a[128:129], v249 offset:22528
    ds_read_b64_tr_b16 a[130:131], v249 offset:23040
    s_lshl_b32 s11, s64, 8
    s_add_u32 s11, s11, 0x5000
    v_and_b32_e32 v19, 15, v0
    v_lshlrev_b32_e64 v19, 2, v19
    v_mfma_f32_32x32x16_bf16 v[80:95], a[140:143], a[84:87], v[80:95]
    buffer_load_dwordx4 a[76:79], v1, s[44:47], s9 offen offset:1024 sc1
    s_add_u32 m0, s83, 0x11800
    s_add_u32 s81, s84, 0x9c000
    buffer_load_dwordx4 v252, s[36:39], s81 offen lds
    buffer_load_dword v19, v19, s[44:47], s11 offen sc1
    ds_read_b64_tr_b16 a[132:133], v246 offset:22528
    ds_read_b64_tr_b16 a[134:135], v246 offset:23040
    s_waitcnt lgkmcnt(6)
    v_mfma_f32_32x32x16_bf16 v[64:79], a[144:147], a[88:91], v[64:79]
    s_waitcnt lgkmcnt(0)
    s_barrier
    ds_read_b64_tr_b16 a[136:137], v251 offset:0
    ds_read_b64_tr_b16 a[138:139], v251 offset:512
    v_mfma_f32_32x32x16_bf16 v[80:95], a[148:151], a[88:91], v[80:95]
    s_add_u32 s9, s87, 0x7000
    buffer_load_dwordx4 a[80:83], v1, s[44:47], s9 offen offset:0 sc1
    s_add_u32 m0, s83, 0x18000
    s_add_u32 s81, s86, 0x0
    buffer_load_dwordx4 v252, s[40:43], s81 offen lds
    ds_read_b64_tr_b16 a[140:141], v248 offset:0
    ds_read_b64_tr_b16 a[142:143], v248 offset:512
    v_mfma_f32_32x32x16_bf16 v[64:79], a[128:131], a[92:95], v[64:79]
    ds_read_b64_tr_b16 a[144:145], v251 offset:2048
    ds_read_b64_tr_b16 a[146:147], v251 offset:2560
    v_mfma_f32_32x32x16_bf16 v[80:95], a[132:135], a[92:95], v[80:95]
    buffer_load_dwordx4 a[84:87], v1, s[44:47], s9 offen offset:1024 sc1
    s_add_u32 m0, s83, 0x18800
    s_add_u32 s81, s86, 0x4000
    buffer_load_dwordx4 v252, s[40:43], s81 offen lds
    ds_read_b64_tr_b16 a[148:149], v248 offset:2048
    ds_read_b64_tr_b16 a[150:151], v248 offset:2560
    s_waitcnt lgkmcnt(6)
    v_mfma_f32_32x32x16_bf16 v[64:79], a[136:139], a[96:99], v[64:79]
    s_waitcnt lgkmcnt(4)
    ds_read_b64_tr_b16 a[128:129], v251 offset:4096
    ds_read_b64_tr_b16 a[130:131], v251 offset:4608
    v_mfma_f32_32x32x16_bf16 v[80:95], a[140:143], a[96:99], v[80:95]
    s_add_u32 s9, s87, 0x9800
    buffer_load_dwordx4 a[88:91], v1, s[44:47], s9 offen offset:0 sc1
    s_add_u32 m0, s83, 0x19000
    s_add_u32 s81, s86, 0x8000
    buffer_load_dwordx4 v252, s[40:43], s81 offen lds
    ds_read_b64_tr_b16 a[132:133], v248 offset:4096
    ds_read_b64_tr_b16 a[134:135], v248 offset:4608
    s_waitcnt lgkmcnt(6)
    v_mfma_f32_32x32x16_bf16 v[64:79], a[144:147], a[100:103], v[64:79]
    s_waitcnt lgkmcnt(4)
    ds_read_b64_tr_b16 a[136:137], v251 offset:6144
    ds_read_b64_tr_b16 a[138:139], v251 offset:6656
    v_mfma_f32_32x32x16_bf16 v[80:95], a[148:151], a[100:103], v[80:95]
    buffer_load_dwordx4 a[92:95], v1, s[44:47], s9 offen offset:1024 sc1
    s_add_u32 m0, s83, 0x19800
    s_add_u32 s81, s86, 0xc000
    buffer_load_dwordx4 v252, s[40:43], s81 offen lds
    ds_read_b64_tr_b16 a[140:141], v248 offset:6144
    ds_read_b64_tr_b16 a[142:143], v248 offset:6656
    s_waitcnt lgkmcnt(6)
    v_mfma_f32_32x32x16_bf16 v[64:79], a[128:131], a[104:107], v[64:79]
    s_waitcnt lgkmcnt(4)
    ds_read_b64_tr_b16 a[144:145], v251 offset:16384
    ds_read_b64_tr_b16 a[146:147], v251 offset:16896
    v_mfma_f32_32x32x16_bf16 v[80:95], a[132:135], a[104:107], v[80:95]
    s_waitcnt vmcnt(8)
    v_cmp_ne_u32 vcc, s67, v19
    s_nop 1
    s_cmp_lg_u64 vcc, 0
    s_cbranch_scc1 L_slow_16
L_back_17:
    s_add_u32 s9, s89, 0x0
    buffer_load_dwordx4 a[96:99], v1, s[44:47], s9 offen offset:0 sc1
    s_add_u32 m0, s83, 0x20000
    s_add_u32 s81, s86, 0x10000
    buffer_load_dwordx4 v252, s[40:43], s81 offen lds
    ds_read_b64_tr_b16 a[148:149], v248 offset:16384
    ds_read_b64_tr_b16 a[150:151], v248 offset:16896
    s_waitcnt lgkmcnt(6)
    v_mfma_f32_32x32x16_bf16 v[64:79], a[136:139], a[108:111], v[64:79]
    s_waitcnt lgkmcnt(4)
    ds_read_b64_tr_b16 a[128:129], v251 offset:18432
    ds_read_b64_tr_b16 a[130:131], v251 offset:18944
    v_mfma_f32_32x32x16_bf16 v[80:95], a[140:143], a[108:111], v[80:95]
    buffer_load_dwordx4 a[100:103], v1, s[44:47], s9 offen offset:1024 sc1
    ds_read_b64_tr_b16 a[132:133], v248 offset:18432
    ds_read_b64_tr_b16 a[134:135], v248 offset:18944
    s_waitcnt lgkmcnt(6)
    v_mfma_f32_32x32x16_bf16 v[64:79], a[144:147], a[112:115], v[64:79]
    s_waitcnt lgkmcnt(4)
    ds_read_b64_tr_b16 a[136:137], v251 offset:20480
    ds_read_b64_tr_b16 a[138:139], v251 offset:20992
    v_lshlrev_b32_e64 v32, 16, v192
    v_and_b32_e32 v33, 0xffff0000, v192
    v_lshlrev_b32_e64 v34, 16, v193
    v_and_b32_e32 v35, 0xffff0000, v193
    v_lshlrev_b32_e64 v36, 16, v194
    v_and_b32_e32 v37, 0xffff0000, v194
    v_lshlrev_b32_e64 v38, 16, v195
    v_mfma_f32_32x32x16_bf16 v[80:95], a[148:151], a[112:115], v[80:95]
    buffer_load_dwordx4 a[104:107], v1, s[44:47], s9 offen offset:2048 sc1
    s_add_u32 m0, s83, 0x20800
    s_add_u32 s81, s86, 0x14000
    buffer_load_dwordx4 v252, s[40:43], s81 offen lds
    ds_read_b64_tr_b16 a[140:141], v248 offset:20480
    ds_read_b64_tr_b16 a[142:143], v248 offset:20992
    v_and_b32_e32 v39, 0xffff0000, v195
    v_lshlrev_b32_e64 v40, 16, v196
    v_and_b32_e32 v41, 0xffff0000, v196
    v_lshlrev_b32_e64 v42, 16, v197
    v_and_b32_e32 v43, 0xffff0000, v197
    v_lshlrev_b32_e64 v44, 16, v198
    v_and_b32_e32 v45, 0xffff0000, v198
    v_lshlrev_b32_e64 v46, 16, v199
    v_and_b32_e32 v47, 0xffff0000, v199
    s_waitcnt lgkmcnt(6)
    v_mfma_f32_32x32x16_bf16 v[64:79], a[128:131], a[116:119], v[64:79]
    s_waitcnt lgkmcnt(4)
    ds_read_b64_tr_b16 a[144:145], v251 offset:22528
    ds_read_b64_tr_b16 a[146:147], v251 offset:23040
    v_mfma_f32_32x32x16_bf16 v[80:95], a[132:135], a[116:119], v[80:95]
    buffer_load_dwordx4 a[108:111], v1, s[44:47], s9 offen offset:3072 sc1
    s_add_u32 m0, s83, 0x21000
    s_add_u32 s81, s86, 0x18000
    buffer_load_dwordx4 v252, s[40:43], s81 offen lds
    ds_read_b64_tr_b16 a[148:149], v248 offset:22528
    ds_read_b64_tr_b16 a[150:151], v248 offset:23040
    s_waitcnt lgkmcnt(6)
    v_mfma_f32_32x32x16_bf16 v[64:79], a[136:139], a[120:123], v[64:79]
    s_waitcnt lgkmcnt(0)
    s_barrier
    ds_read_b64_tr_b16 a[128:129], v251 offset:32768
    ds_read_b64_tr_b16 a[130:131], v251 offset:33280
    v_mfma_f32_32x32x16_bf16 v[80:95], a[140:143], a[120:123], v[80:95]
    s_nop 0
    s_add_u32 s9, s89, 0x1000
    buffer_load_dwordx4 a[112:115], v1, s[44:47], s9 offen offset:0 sc1
    s_add_u32 m0, s83, 0x21800
    s_add_u32 s81, s86, 0x1c000
    buffer_load_dwordx4 v252, s[40:43], s81 offen lds
    ds_read_b64_tr_b16 a[132:133], v248 offset:32768
    ds_read_b64_tr_b16 a[134:135], v248 offset:33280
    v_mfma_f32_32x32x16_bf16 v[64:79], a[144:147], a[124:127], v[64:79]
    ds_read_b64_tr_b16 a[136:137], v251 offset:34816
    ds_read_b64_tr_b16 a[138:139], v251 offset:35328
    v_mfma_f32_32x32x16_bf16 v[80:95], a[148:151], a[124:127], v[80:95]
    buffer_load_dwordx4 a[116:119], v1, s[44:47], s9 offen offset:1024 sc1
    s_add_u32 m0, s83, 0xc000
    s_add_u32 s81, s86, 0x20000
    buffer_load_dwordx4 v252, s[40:43], s81 offen lds
    ds_read_b64_tr_b16 a[140:141], v248 offset:34816
    ds_read_b64_tr_b16 a[142:143], v248 offset:35328
    s_waitcnt lgkmcnt(6)
    v_mfma_f32_32x32x16_bf16 v[64:79], a[128:131], a[64:67], v[64:79]
    s_waitcnt lgkmcnt(4)
    ds_read_b64_tr_b16 a[144:145], v251 offset:36864
    ds_read_b64_tr_b16 a[146:147], v251 offset:37376
    v_add_u32_e64 v244, s74, v1
    v_add_u32_e32 v244, 0x1c000, v244
    s_xor_b32 s68, s74, 0x2000
    v_add_u32_e64 v243, s68, v1
    v_add_u32_e32 v243, 0x1c000, v243
    v_and_b32_e32 v20, 31, v0
    v_lshlrev_b32_e32 v21, 1, v20
    v_add_u32_e32 v21, s57, v21
    v_lshlrev_b32_e32 v21, 7, v21
    v_lshrrev_b32_e64 v22, 5, v0
    v_lshl_add_u32 v21, v22, 3, v21
    v_and_b32_e32 v20, 7, v20
    s_lshl_b32 s68, s66, 2
    v_xor_b32_e32 v20, s68, v20
    v_xor_b32_e32 v22, 0, v20
    v_lshl_add_u32 v224, v22, 4, v21
    v_xor_b32_e64 v22, 1, v20
    v_lshl_add_u32 v225, v22, 4, v21
    v_mfma_f32_32x32x16_bf16 v[80:95], a[132:135], a[64:67], v[80:95]
    buffer_load_dwordx4 a[120:123], v1, s[44:47], s9 offen offset:2048 sc1
    s_add_u32 m0, s83, 0xc800
    s_add_u32 s81, s86, 0x24000
    buffer_load_dwordx4 v252, s[40:43], s81 offen lds
    ds_read_b64_tr_b16 a[148:149], v248 offset:36864
    ds_read_b64_tr_b16 a[150:151], v248 offset:37376
    v_xor_b32_e64 v22, 2, v20
    v_lshl_add_u32 v226, v22, 4, v21
    v_xor_b32_e64 v22, 3, v20
    v_lshl_add_u32 v227, v22, 4, v21
    v_lshrrev_b32_e32 v20, 3, v0
    s_lshl_b32 s68, s56, 4
    v_add_u32_e32 v20, s68, v20
    v_and_b32_e32 v21, 7, v0
    v_add_u32_e64 v22, 0, v20
    v_bfe_u32 v23, v22, 1, 3
    v_xor_b32_e32 v23, v23, v21
    v_lshlrev_b32_e32 v22, 7, v22
    v_lshl_add_u32 v228, v23, 4, v22
    v_add_u32_e64 v22, 8, v20
    v_bfe_u32 v23, v22, 1, 3
    v_xor_b32_e32 v23, v23, v21
    v_lshlrev_b32_e32 v22, 7, v22
    v_lshl_add_u32 v229, v23, 4, v22
    s_waitcnt lgkmcnt(6)
    v_mfma_f32_32x32x16_bf16 v[64:79], a[136:139], a[68:71], v[64:79]
    s_waitcnt lgkmcnt(4)
    ds_read_b64_tr_b16 a[128:129], v251 offset:38912
    ds_read_b64_tr_b16 a[130:131], v251 offset:39424
    v_mfma_f32_32x32x16_bf16 v[80:95], a[140:143], a[68:71], v[80:95]
    buffer_load_dwordx4 a[124:127], v1, s[44:47], s9 offen offset:3072 sc1
    s_add_u32 m0, s83, 0xd000
    s_add_u32 s81, s86, 0x28000
    buffer_load_dwordx4 v252, s[40:43], s81 offen lds
    ds_read_b64_tr_b16 a[132:133], v248 offset:38912
    ds_read_b64_tr_b16 a[134:135], v248 offset:39424
    s_waitcnt lgkmcnt(6)
    v_mfma_f32_32x32x16_bf16 v[64:79], a[144:147], a[72:75], v[64:79]
    s_waitcnt lgkmcnt(4)
    ds_read_b64_tr_b16 a[136:137], v250 offset:0
    ds_read_b64_tr_b16 a[138:139], v250 offset:512
    v_mfma_f32_32x32x16_bf16 v[80:95], a[148:151], a[72:75], v[80:95]
    s_add_u32 s9, s89, 0x2000
    buffer_load_dwordx4 a[64:67], v1, s[44:47], s9 offen offset:0 sc1
    s_add_u32 m0, s83, 0xd800
    s_add_u32 s81, s86, 0x2c000
    buffer_load_dwordx4 v252, s[40:43], s81 offen lds
    ds_read_b64_tr_b16 a[140:141], v247 offset:0
    ds_read_b64_tr_b16 a[142:143], v247 offset:512
    s_waitcnt lgkmcnt(6)
    v_mfma_f32_32x32x16_bf16 v[64:79], a[128:131], a[76:79], v[64:79]
    s_waitcnt lgkmcnt(4)
    ds_read_b64_tr_b16 a[144:145], v250 offset:2048
    ds_read_b64_tr_b16 a[146:147], v250 offset:2560
    v_mfma_f32_32x32x16_bf16 v[80:95], a[132:135], a[76:79], v[80:95]
    buffer_load_dwordx4 a[68:71], v1, s[44:47], s9 offen offset:1024 sc1
    s_add_u32 m0, s83, 0x14000
    s_add_u32 s81, s86, 0x30000
    buffer_load_dwordx4 v252, s[40:43], s81 offen lds
    ds_read_b64_tr_b16 a[148:149], v247 offset:2048
    ds_read_b64_tr_b16 a[150:151], v247 offset:2560
    s_waitcnt vmcnt(26) lgkmcnt(6)
    v_mfma_f32_32x32x16_bf16 v[64:79], a[136:139], a[80:83], v[64:79]
    s_waitcnt lgkmcnt(4)
    ds_read_b64_tr_b16 a[128:129], v250 offset:4096
    ds_read_b64_tr_b16 a[130:131], v250 offset:4608
    v_mfma_f32_32x32x16_bf16 v[80:95], a[140:143], a[80:83], v[80:95]
    buffer_load_dwordx4 a[72:75], v1, s[44:47], s9 offen offset:2048 sc1
    s_add_u32 m0, s83, 0x14800
    s_add_u32 s81, s86, 0x34000
    buffer_load_dwordx4 v252, s[40:43], s81 offen lds
    ds_read_b64_tr_b16 a[132:133], v247 offset:4096
    ds_read_b64_tr_b16 a[134:135], v247 offset:4608
    s_waitcnt vmcnt(26) lgkmcnt(6)
    v_mfma_f32_32x32x16_bf16 v[64:79], a[144:147], a[84:87], v[64:79]
    s_waitcnt lgkmcnt(4)
    ds_read_b64_tr_b16 a[136:137], v250 offset:6144
    ds_read_b64_tr_b16 a[138:139], v250 offset:6656
    v_mfma_f32_32x32x16_bf16 v[80:95], a[148:151], a[84:87], v[80:95]
    buffer_load_dwordx4 a[76:79], v1, s[44:47], s9 offen offset:3072 sc1
    s_add_u32 m0, s83, 0x15000
    s_add_u32 s81, s86, 0x38000
    buffer_load_dwordx4 v252, s[40:43], s81 offen lds
    ds_read_b64_tr_b16 a[140:141], v247 offset:6144
    ds_read_b64_tr_b16 a[142:143], v247 offset:6656
    s_waitcnt vmcnt(26) lgkmcnt(6)
    v_mfma_f32_32x32x16_bf16 v[64:79], a[128:131], a[88:91], v[64:79]
    s_waitcnt vmcnt(14) lgkmcnt(0)
    s_barrier
    ds_read_b64_tr_b16 a[144:145], v250 offset:32768
    ds_read_b64_tr_b16 a[146:147], v250 offset:33280
    v_mfma_f32_32x32x16_bf16 v[80:95], a[132:135], a[88:91], v[80:95]
    s_nop 0
    s_add_u32 s9, s89, 0x3000
    buffer_load_dwordx4 a[80:83], v1, s[44:47], s9 offen offset:0 sc1
    ds_read_b64_tr_b16 a[148:149], v247 offset:32768
    ds_read_b64_tr_b16 a[150:151], v247 offset:33280
    v_mfma_f32_32x32x16_bf16 v[64:79], a[136:139], a[92:95], v[64:79]
    ds_read_b64_tr_b16 a[128:129], v250 offset:34816
    ds_read_b64_tr_b16 a[130:131], v250 offset:35328
    v_mfma_f32_32x32x16_bf16 v[80:95], a[140:143], a[92:95], v[80:95]
    buffer_load_dwordx4 a[84:87], v1, s[44:47], s9 offen offset:1024 sc1
    s_add_u32 m0, s83, 0x15800
    s_add_u32 s81, s86, 0x3c000
    buffer_load_dwordx4 v252, s[40:43], s81 offen lds
    ds_read_b64_tr_b16 a[132:133], v247 offset:34816
    ds_read_b64_tr_b16 a[134:135], v247 offset:35328
    s_waitcnt lgkmcnt(6)
    v_mfma_f32_32x32x16_bf16 v[96:111], a[144:147], a[96:99], 0
    s_waitcnt lgkmcnt(4)
    ds_read_b64_tr_b16 a[136:137], v250 offset:36864
    ds_read_b64_tr_b16 a[138:139], v250 offset:37376
    v_mfma_f32_32x32x16_bf16 v[112:127], a[148:151], a[96:99], 0
    buffer_load_dwordx4 a[88:91], v1, s[44:47], s9 offen offset:2048 sc1
    ds_read_b64_tr_b16 a[140:141], v247 offset:36864
    ds_read_b64_tr_b16 a[142:143], v247 offset:37376
    s_waitcnt lgkmcnt(6)
    v_mfma_f32_32x32x16_bf16 v[96:111], a[128:131], a[100:103], v[96:111]
    s_waitcnt lgkmcnt(4)
    ds_read_b64_tr_b16 a[144:145], v250 offset:38912
    ds_read_b64_tr_b16 a[146:147], v250 offset:39424
    ds_write_b128 v244, v[80:83] offset:0
    ds_write_b128 v244, v[84:87] offset:1024
    v_mfma_f32_32x32x16_bf16 v[112:127], a[132:135], a[100:103], v[112:127]
    buffer_load_dwordx4 a[92:95], v1, s[44:47], s9 offen offset:3072 sc1
    ds_read_b64_tr_b16 a[148:149], v247 offset:38912
    ds_read_b64_tr_b16 a[150:151], v247 offset:39424
    s_waitcnt lgkmcnt(8)
    v_mfma_f32_32x32x16_bf16 v[96:111], a[136:139], a[104:107], v[96:111]
    s_waitcnt lgkmcnt(6)
    ds_read_b64_tr_b16 a[128:129], v249 offset:0
    ds_read_b64_tr_b16 a[130:131], v249 offset:512
    ds_write_b128 v244, v[88:91] offset:2048
    ds_write_b128 v244, v[92:95] offset:3072
    v_mfma_f32_32x32x16_bf16 v[112:127], a[140:143], a[104:107], v[112:127]
    ds_read_b64_tr_b16 a[132:133], v246 offset:0
    ds_read_b64_tr_b16 a[134:135], v246 offset:512
    s_waitcnt lgkmcnt(10)
    v_mfma_f32_32x32x16_bf16 v[96:111], a[144:147], a[108:111], v[96:111]
    s_waitcnt lgkmcnt(6)
    ds_read_b64_tr_b16 a[136:137], v249 offset:2048
    ds_read_b64_tr_b16 a[138:139], v249 offset:2560
    v_mfma_f32_32x32x16_bf16 v[112:127], a[148:151], a[108:111], v[112:127]
    ds_read_b64_tr_b16 a[140:141], v246 offset:2048
    ds_read_b64_tr_b16 a[142:143], v246 offset:2560
    s_waitcnt lgkmcnt(8)
    v_mfma_f32_32x32x16_bf16 v[96:111], a[128:131], a[112:115], v[96:111]
    s_waitcnt lgkmcnt(4)
    ds_read_b64_tr_b16 a[144:145], v249 offset:4096
    ds_read_b64_tr_b16 a[146:147], v249 offset:4608
    v_mfma_f32_32x32x16_bf16 v[112:127], a[132:135], a[112:115], v[112:127]
    ds_read_b64_tr_b16 a[148:149], v246 offset:4096
    ds_read_b64_tr_b16 a[150:151], v246 offset:4608
    s_waitcnt vmcnt(18) lgkmcnt(6)
    v_mfma_f32_32x32x16_bf16 v[96:111], a[136:139], a[116:119], v[96:111]
    s_waitcnt lgkmcnt(4)
    ds_read_b64_tr_b16 a[128:129], v249 offset:6144
    ds_read_b64_tr_b16 a[130:131], v249 offset:6656
    v_mfma_f32_32x32x16_bf16 v[112:127], a[140:143], a[116:119], v[112:127]
    ds_read_b64_tr_b16 a[132:133], v246 offset:6144
    ds_read_b64_tr_b16 a[134:135], v246 offset:6656
    s_waitcnt vmcnt(16) lgkmcnt(6)
    v_mfma_f32_32x32x16_bf16 v[96:111], a[144:147], a[120:123], v[96:111]
    s_waitcnt vmcnt(2) lgkmcnt(0)
    s_barrier
    ds_read_b64_tr_b16 a[136:137], v251 offset:49152
    ds_read_b64_tr_b16 a[138:139], v251 offset:49664
    ds_read_b128 v[208:211], v243 offset:0
    ds_read_b128 v[212:215], v243 offset:1024
    ds_read_b128 v[216:219], v243 offset:2048
    v_mfma_f32_32x32x16_bf16 v[112:127], a[148:151], a[120:123], v[112:127]
    s_nop 0
    ds_read_b64_tr_b16 a[140:141], v248 offset:49152
    ds_read_b64_tr_b16 a[142:143], v248 offset:49664
    ds_read_b128 v[220:223], v243 offset:3072
    v_mfma_f32_32x32x16_bf16 v[96:111], a[128:131], a[124:127], v[96:111]
    ds_read_b64_tr_b16 a[144:145], v251 offset:51200
    ds_read_b64_tr_b16 a[146:147], v251 offset:51712
    s_waitcnt lgkmcnt(2)
    s_mov_b32 s6, 0xbfb8aa3b
    v_add_f32_e32 v64, v64, v208
    v_add_f32_e32 v65, v65, v209
    v_mul_f32_e32 v20, s6, v64
    v_mul_f32_e32 v21, s6, v65
    v_exp_f32_e32 v20, v20
    v_mfma_f32_32x32x16_bf16 v[112:127], a[132:135], a[124:127], v[112:127]
    ds_read_b64_tr_b16 a[148:149], v248 offset:51200
    ds_read_b64_tr_b16 a[150:151], v248 offset:51712
    v_exp_f32_e32 v21, v21
    s_nop 0
    v_add_f32_e32 v20, 1.0, v20
    v_add_f32_e32 v21, 1.0, v21
    v_rcp_f32_e32 v20, v20
    v_rcp_f32_e32 v21, v21
    s_nop 0
    v_mul_f32_e32 v64, v64, v20
    v_mfma_f32_32x32x16_bf16 v[96:111], a[136:139], a[64:67], v[96:111]
    ds_read_b64_tr_b16 a[128:129], v251 offset:53248
    ds_read_b64_tr_b16 a[130:131], v251 offset:53760
    v_mul_f32_e32 v65, v65, v21
    v_add_f32_e32 v66, v66, v210
    v_add_f32_e32 v67, v67, v211
    v_mul_f32_e32 v20, s6, v66
    v_mul_f32_e32 v21, s6, v67
    v_exp_f32_e32 v20, v20
    v_mfma_f32_32x32x16_bf16 v[112:127], a[140:143], a[64:67], v[112:127]
    ds_read_b64_tr_b16 a[132:133], v248 offset:53248
    ds_read_b64_tr_b16 a[134:135], v248 offset:53760
    v_exp_f32_e32 v21, v21
    s_nop 0
    v_add_f32_e32 v20, 1.0, v20
    v_add_f32_e32 v21, 1.0, v21
    v_rcp_f32_e32 v20, v20
    v_rcp_f32_e32 v21, v21
    s_nop 0
    v_mul_f32_e32 v66, v66, v20
    v_mul_f32_e64 v67, v67, v21
    s_waitcnt lgkmcnt(6)
    v_mfma_f32_32x32x16_bf16 v[96:111], a[144:147], a[68:71], v[96:111]
    s_waitcnt lgkmcnt(4)
    ds_read_b64_tr_b16 a[136:137], v251 offset:55296
    ds_read_b64_tr_b16 a[138:139], v251 offset:55808
    v_add_f32_e32 v68, v68, v212
    v_add_f32_e32 v69, v69, v213
    v_mul_f32_e32 v20, s6, v68
    v_mul_f32_e32 v21, s6, v69
    v_exp_f32_e64 v20, v20
    v_exp_f32_e32 v21, v21
    s_nop 0
    v_mfma_f32_32x32x16_bf16 v[112:127], a[148:151], a[68:71], v[112:127]
    ds_read_b64_tr_b16 a[140:141], v248 offset:55296
    ds_read_b64_tr_b16 a[142:143], v248 offset:55808
    v_add_f32_e32 v20, 1.0, v20
    v_add_f32_e32 v21, 1.0, v21
    v_rcp_f32_e32 v20, v20
    v_rcp_f32_e32 v21, v21
    s_nop 0
    v_mul_f32_e32 v68, v68, v20
    v_mul_f32_e32 v69, v69, v21
    v_add_f32_e32 v70, v70, v214
    s_waitcnt lgkmcnt(6)
    v_mfma_f32_32x32x16_bf16 v[96:111], a[128:131], a[72:75], v[96:111]
    s_waitcnt lgkmcnt(4)
    ds_read_b64_tr_b16 a[144:145], v250 offset:16384
    ds_read_b64_tr_b16 a[146:147], v250 offset:16896
    v_add_f32_e32 v71, v71, v215
    v_mul_f32_e32 v20, s6, v70
    v_mul_f32_e32 v21, s6, v71
    v_exp_f32_e32 v20, v20
    v_exp_f32_e32 v21, v21
    s_nop 0
    v_add_f32_e64 v20, 1.0, v20
    v_mfma_f32_32x32x16_bf16 v[112:127], a[132:135], a[72:75], v[112:127]
    ds_read_b64_tr_b16 a[148:149], v247 offset:16384
    ds_read_b64_tr_b16 a[150:151], v247 offset:16896
    v_add_f32_e32 v21, 1.0, v21
    v_rcp_f32_e32 v20, v20
    v_rcp_f32_e32 v21, v21
    s_nop 0
    v_mul_f32_e32 v70, v70, v20
    v_mul_f32_e32 v71, v71, v21
    v_add_f32_e32 v72, v72, v216
    v_add_f32_e32 v73, v73, v217
    s_waitcnt lgkmcnt(6)
    v_mfma_f32_32x32x16_bf16 v[96:111], a[136:139], a[76:79], v[96:111]
    s_waitcnt lgkmcnt(4)
    ds_read_b64_tr_b16 a[128:129], v250 offset:18432
    ds_read_b64_tr_b16 a[130:131], v250 offset:18944
    v_mul_f32_e32 v20, s6, v72
    v_mul_f32_e32 v21, s6, v73
    v_exp_f32_e32 v20, v20
    v_exp_f32_e32 v21, v21
    s_nop 0
    v_add_f32_e32 v20, 1.0, v20
    v_add_f32_e64 v21, 1.0, v21
    v_mfma_f32_32x32x16_bf16 v[112:127], a[140:143], a[76:79], v[112:127]
    ds_read_b64_tr_b16 a[132:133], v247 offset:18432
    ds_read_b64_tr_b16 a[134:135], v247 offset:18944
    v_rcp_f32_e32 v20, v20
    v_rcp_f32_e32 v21, v21
    s_nop 0
    v_mul_f32_e32 v72, v72, v20
    v_mul_f32_e32 v73, v73, v21
    v_add_f32_e32 v74, v74, v218
    v_add_f32_e32 v75, v75, v219
    v_mul_f32_e32 v20, s6, v74
    s_waitcnt lgkmcnt(6)
    v_mfma_f32_32x32x16_bf16 v[96:111], a[144:147], a[80:83], v[96:111]
    s_waitcnt lgkmcnt(4)
    ds_read_b64_tr_b16 a[136:137], v250 offset:20480
    ds_read_b64_tr_b16 a[138:139], v250 offset:20992
    v_mul_f32_e32 v21, s6, v75
    v_exp_f32_e32 v20, v20
    v_exp_f32_e32 v21, v21
    s_nop 0
    v_add_f32_e32 v20, 1.0, v20
    v_add_f32_e32 v21, 1.0, v21
    v_mfma_f32_32x32x16_bf16 v[112:127], a[148:151], a[80:83], v[112:127]
    ds_read_b64_tr_b16 a[140:141], v247 offset:20480
    ds_read_b64_tr_b16 a[142:143], v247 offset:20992
    v_rcp_f32_e32 v20, v20
    v_rcp_f32_e32 v21, v21
    s_nop 0
    v_mul_f32_e32 v74, v74, v20
    v_mul_f32_e32 v75, v75, v21
    v_add_f32_e32 v76, v76, v220
    v_add_f32_e32 v77, v77, v221
    v_mul_f32_e32 v20, s6, v76
    v_mul_f32_e64 v21, s6, v77
    s_waitcnt lgkmcnt(6)
    v_mfma_f32_32x32x16_bf16 v[96:111], a[128:131], a[84:87], v[96:111]
    s_waitcnt lgkmcnt(4)
    ds_read_b64_tr_b16 a[144:145], v250 offset:22528
    ds_read_b64_tr_b16 a[146:147], v250 offset:23040
    v_exp_f32_e32 v20, v20
    v_exp_f32_e32 v21, v21
    s_nop 0
    v_add_f32_e32 v20, 1.0, v20
    v_add_f32_e32 v21, 1.0, v21
    v_rcp_f32_e32 v20, v20
    v_mfma_f32_32x32x16_bf16 v[112:127], a[132:135], a[84:87], v[112:127]
    ds_read_b64_tr_b16 a[148:149], v247 offset:22528
    ds_read_b64_tr_b16 a[150:151], v247 offset:23040
    v_rcp_f32_e32 v21, v21
    s_nop 0
    v_mul_f32_e32 v76, v76, v20
    v_mul_f32_e32 v77, v77, v21
    v_add_f32_e32 v78, v78, v222
    v_add_f32_e32 v79, v79, v223
    v_mul_f32_e32 v20, s6, v78
    v_mul_f32_e32 v21, s6, v79
    v_exp_f32_e32 v20, v20
    s_waitcnt vmcnt(1) lgkmcnt(6)
    v_mfma_f32_32x32x16_bf16 v[96:111], a[136:139], a[88:91], v[96:111]
    s_waitcnt lgkmcnt(4)
    v_exp_f32_e32 v21, v21
    s_nop 0
    v_add_f32_e32 v20, 1.0, v20
    v_add_f32_e64 v21, 1.0, v21
    v_mfma_f32_32x32x16_bf16 v[112:127], a[140:143], a[88:91], v[112:127]
    v_rcp_f32_e32 v20, v20
    v_rcp_f32_e32 v21, v21
    s_nop 0
    v_mul_f32_e32 v78, v78, v20
    v_mul_f32_e32 v79, v79, v21
    s_waitcnt vmcnt(0) lgkmcnt(0)
    v_mfma_f32_32x32x16_bf16 v[112:127], a[148:151], a[92:95], v[112:127]
    v_mfma_f32_32x32x16_bf16 v[96:111], a[144:147], a[92:95], v[96:111]
    v_add_u32_e32 v244, 0x8000, v244
    v_add_u32_e32 v243, 0x8000, v243
    s_nop 8
    ds_write_b128 v244, v[112:115] offset:0
    ds_write_b128 v244, v[116:119] offset:1024
    ds_write_b128 v244, v[120:123] offset:2048
    ds_write_b128 v244, v[124:127] offset:3072
    s_waitcnt lgkmcnt(0)
    s_barrier
    ds_read_b128 v[208:211], v243 offset:0
    ds_read_b128 v[212:215], v243 offset:1024
    ds_read_b128 v[216:219], v243 offset:2048
    ds_read_b128 v[220:223], v243 offset:3072
    s_waitcnt lgkmcnt(3)
    v_add_f32_e32 v96, v96, v208
    v_add_f32_e32 v97, v97, v209
    v_add_f32_e32 v98, v98, v210
    v_add_f32_e32 v99, v99, v211
    v_mul_f32_e32 v96, v96, v64
    v_mul_f32_e32 v97, v97, v65
    v_mul_f32_e32 v98, v98, v66
    v_mul_f32_e32 v99, v99, v67
    v_cvt_pk_bf16_f32 v200, v96, v97
    v_cvt_pk_bf16_f32 v201, v98, v99
    ds_write_b64 v224, v[200:201] offset:0
    s_waitcnt lgkmcnt(3)
    v_add_f32_e32 v100, v100, v212
    v_add_f32_e32 v101, v101, v213
    v_add_f32_e32 v102, v102, v214
    v_add_f32_e32 v103, v103, v215
    v_mul_f32_e32 v100, v100, v68
    v_mul_f32_e32 v101, v101, v69
    v_mul_f32_e32 v102, v102, v70
    v_mul_f32_e64 v103, v103, v71
    v_cvt_pk_bf16_f32 v202, v100, v101
    v_cvt_pk_bf16_f32 v203, v102, v103
    ds_write_b64 v225, v[202:203] offset:0
    s_waitcnt lgkmcnt(3)
    v_add_f32_e32 v104, v104, v216
    v_add_f32_e32 v105, v105, v217
    v_add_f32_e32 v106, v106, v218
    v_add_f32_e32 v107, v107, v219
    v_mul_f32_e32 v104, v104, v72
    v_mul_f32_e32 v105, v105, v73
    v_mul_f32_e32 v106, v106, v74
    v_mul_f32_e64 v107, v107, v75
    v_cvt_pk_bf16_f32 v204, v104, v105
    v_cvt_pk_bf16_f32 v205, v106, v107
    ds_write_b64 v226, v[204:205] offset:0
    s_waitcnt lgkmcnt(3)
    v_add_f32_e32 v108, v108, v220
    v_add_f32_e32 v109, v109, v221
    v_add_f32_e32 v110, v110, v222
    v_add_f32_e32 v111, v111, v223
    v_mul_f32_e32 v108, v108, v76
    v_mul_f32_e32 v109, v109, v77
    v_mul_f32_e32 v110, v110, v78
    v_mul_f32_e64 v111, v111, v79
    v_cvt_pk_bf16_f32 v206, v108, v109
    v_cvt_pk_bf16_f32 v207, v110, v111
    ds_write_b64 v227, v[206:207] offset:0
    s_waitcnt lgkmcnt(0)
    s_barrier
    ds_read_b128 v[208:211], v228 offset:0
    ds_read_b128 v[212:215], v229 offset:0
    s_waitcnt lgkmcnt(1)
    v_lshlrev_b32_e32 v20, 16, v208
    v_and_b32_e32 v21, 0xffff0000, v208
    v_add_f32_e32 v20, v20, v32
    v_add_f32_e32 v21, v21, v33
    v_cvt_pk_bf16_f32 v192, v20, v21
    v_lshlrev_b32_e64 v22, 16, v209
    v_and_b32_e32 v23, 0xffff0000, v209
    v_add_f32_e32 v22, v22, v34
    v_add_f32_e32 v23, v23, v35
    v_cvt_pk_bf16_f32 v193, v22, v23
    v_lshlrev_b32_e64 v20, 16, v210
    v_and_b32_e32 v21, 0xffff0000, v210
    v_add_f32_e32 v20, v20, v36
    v_add_f32_e32 v21, v21, v37
    v_cvt_pk_bf16_f32 v194, v20, v21
    v_lshlrev_b32_e64 v22, 16, v211
    v_and_b32_e32 v23, 0xffff0000, v211
    v_add_f32_e32 v22, v22, v38
    v_add_f32_e32 v23, v23, v39
    v_cvt_pk_bf16_f32 v195, v22, v23
    buffer_store_dwordx4 v[192:195], v245, s[48:51], s4 offen
    s_waitcnt lgkmcnt(0)
    v_lshlrev_b32_e32 v20, 16, v212
    v_and_b32_e32 v21, 0xffff0000, v212
    v_add_f32_e32 v20, v20, v40
    v_add_f32_e32 v21, v21, v41
    v_cvt_pk_bf16_f32 v196, v20, v21
    v_lshlrev_b32_e64 v22, 16, v213
    v_and_b32_e32 v23, 0xffff0000, v213
    v_add_f32_e32 v22, v22, v42
    v_add_f32_e32 v23, v23, v43
    v_cvt_pk_bf16_f32 v197, v22, v23
    v_lshlrev_b32_e64 v20, 16, v214
    v_and_b32_e32 v21, 0xffff0000, v214
    v_add_f32_e32 v20, v20, v44
    v_add_f32_e32 v21, v21, v45
    v_cvt_pk_bf16_f32 v198, v20, v21
    v_lshlrev_b32_e64 v22, 16, v215
    v_and_b32_e32 v23, 0xffff0000, v215
    v_add_f32_e64 v22, v22, v46
    v_add_f32_e32 v23, v23, v47
    v_cvt_pk_bf16_f32 v199, v22, v23
    buffer_store_dwordx4 v[196:199], v245, s[48:51], s5 offen
    s_endpgm
L_typeB:
    s_waitcnt vmcnt(6)
    s_barrier
    ds_read_b64_tr_b16 a[176:177], v6 offset:0
    ds_read_b64_tr_b16 a[178:179], v6 offset:512
    ds_read_b64_tr_b16 a[180:181], v6 offset:1024
    ds_read_b64_tr_b16 a[182:183], v6 offset:1536
    ds_read_b64_tr_b16 a[184:185], v6 offset:2048
    ds_read_b64_tr_b16 a[186:187], v6 offset:2560
    ds_read_b64_tr_b16 a[188:189], v6 offset:3072
    ds_read_b64_tr_b16 a[190:191], v6 offset:3584
    s_waitcnt lgkmcnt(6)
    v_mfma_f32_32x32x16_bf16 v[32:47], a[176:179], v[64:67], 0
    s_waitcnt lgkmcnt(4)
    s_add_u32 m0, s74, 0x18000
    s_add_u32 s81, s75, 0x40
    buffer_load_dwordx4 v10, s[28:31], s81 offen offset:0 lds
    ds_read_b64_tr_b16 a[192:193], v6 offset:4096
    ds_read_b64_tr_b16 a[194:195], v6 offset:4608
    v_mfma_f32_32x32x16_bf16 v[32:47], a[180:183], v[68:71], v[32:47]
    s_waitcnt lgkmcnt(4)
    ds_read_b64_tr_b16 a[196:197], v6 offset:5120
    ds_read_b64_tr_b16 a[198:199], v6 offset:5632
    s_lshl_b32 s68, s65, 7
    s_lshl_b32 s69, s57, 6
    s_add_u32 s68, s68, s69
    s_mul_i32 s84, s66, 0xa0000
    v_mfma_f32_32x32x16_bf16 v[32:47], a[184:187], v[72:75], v[32:47]
    s_waitcnt lgkmcnt(4)
    buffer_load_dwordx4 v11, s[28:31], s81 offen offset:1024 lds
    ds_read_b64_tr_b16 a[176:177], v6 offset:6144
    ds_read_b64_tr_b16 a[178:179], v6 offset:6656
    s_add_u32 s84, s84, s68
    v_mfma_f32_32x32x16_bf16 v[32:47], a[188:191], v[76:79], v[32:47]
    s_waitcnt lgkmcnt(4)
    ds_read_b64_tr_b16 a[180:181], v6 offset:7168
    ds_read_b64_tr_b16 a[182:183], v6 offset:7680
    s_mul_i32 s85, s66, 0x40000
    s_add_u32 s85, s85, s68
    s_mov_b32 s86, s85
    s_lshl_b32 s83, s66, 13
    v_mfma_f32_32x32x16_bf16 v[32:47], a[192:195], v[80:83], v[32:47]
    s_waitcnt lgkmcnt(4)
    buffer_load_dwordx4 v12, s[28:31], s81 offen offset:2048 lds
    ds_read_b64_tr_b16 a[184:185], v6 offset:16384
    ds_read_b64_tr_b16 a[186:187], v6 offset:16896
    s_lshl_b32 s69, s57, 10
    v_mfma_f32_32x32x16_bf16 v[32:47], a[196:199], v[84:87], v[32:47]
    s_waitcnt lgkmcnt(4)
    ds_read_b64_tr_b16 a[188:189], v6 offset:17408
    ds_read_b64_tr_b16 a[190:191], v6 offset:17920
    s_add_u32 s83, s83, s69
    s_lshl_b32 s68, s64, 1
    s_add_u32 s68, s68, s57
    s_mul_i32 s69, s68, 0x1c000
    v_mfma_f32_32x32x16_bf16 v[32:47], a[176:179], v[88:91], v[32:47]
    s_waitcnt lgkmcnt(4)
    buffer_load_dwordx4 v13, s[28:31], s81 offen offset:3072 lds
    ds_read_b64_tr_b16 a[192:193], v6 offset:18432
    ds_read_b64_tr_b16 a[194:195], v6 offset:18944
    s_add_u32 s69, s69, 0x800000
    v_mfma_f32_32x32x16_bf16 v[32:47], a[180:183], v[92:95], v[32:47]
    s_waitcnt lgkmcnt(4)
    ds_read_b64_tr_b16 a[196:197], v6 offset:19456
    ds_read_b64_tr_b16 a[198:199], v6 offset:19968
    s_mul_i32 s87, s66, 0xa000
    s_add_u32 s87, s87, s69
    s_mul_i32 s88, s66, 0x4000
    s_add_u32 s88, s88, s69
    v_mfma_f32_32x32x16_bf16 v[32:47], a[184:187], v[96:99], v[32:47]
    s_waitcnt lgkmcnt(4)
    s_add_u32 m0, s74, 0x20000
    s_add_u32 s81, s75, 0x70040
    buffer_load_dwordx4 v10, s[28:31], s81 offen offset:0 lds
    ds_read_b64_tr_b16 a[176:177], v6 offset:20480
    ds_read_b64_tr_b16 a[178:179], v6 offset:20992
    v_mfma_f32_32x32x16_bf16 v[32:47], a[188:191], v[100:103], v[32:47]
    s_waitcnt lgkmcnt(4)
    ds_read_b64_tr_b16 a[180:181], v6 offset:21504
    ds_read_b64_tr_b16 a[182:183], v6 offset:22016
    s_lshl_b32 s89, s68, 15
    s_mul_i32 s69, s66, 0x4000
    s_add_u32 s89, s89, s69
    s_add_u32 s89, s89, 0x400000
    v_mfma_f32_32x32x16_bf16 v[32:47], a[192:195], v[104:107], v[32:47]
    s_waitcnt lgkmcnt(4)
    buffer_load_dwordx4 v11, s[28:31], s81 offen offset:1024 lds
    ds_read_b64_tr_b16 a[184:185], v6 offset:22528
    ds_read_b64_tr_b16 a[186:187], v6 offset:23040
    v_lshrrev_b32_e32 v252, 2, v0
    v_mfma_f32_32x32x16_bf16 v[32:47], a[196:199], v[108:111], v[32:47]
    s_waitcnt lgkmcnt(4)
    ds_read_b64_tr_b16 a[188:189], v6 offset:23552
    ds_read_b64_tr_b16 a[190:191], v6 offset:24064
    v_lshlrev_b32_e32 v252, 10, v252
    v_and_b32_e32 v192, 3, v0
    v_lshl_add_u32 v252, v192, 4, v252
    v_lshrrev_b32_e32 v192, 5, v0
    v_mfma_f32_32x32x16_bf16 v[32:47], a[176:179], v[112:115], v[32:47]
    s_waitcnt lgkmcnt(4)
    buffer_load_dwordx4 v12, s[28:31], s81 offen offset:2048 lds
    ds_read_b64_tr_b16 a[192:193], v6 offset:32768
    ds_read_b64_tr_b16 a[194:195], v6 offset:33280
    v_bfe_u32 v193, v0, 2, 2
    v_mfma_f32_32x32x16_bf16 v[32:47], a[180:183], v[116:119], v[32:47]
    s_waitcnt lgkmcnt(4)
    ds_read_b64_tr_b16 a[196:197], v6 offset:33792
    ds_read_b64_tr_b16 a[198:199], v6 offset:34304
    v_lshl_add_u32 v192, v192, 2, v193
    v_lshlrev_b32_e32 v192, 6, v192
    v_bfe_u32 v193, v0, 4, 1
    v_lshl_add_u32 v192, v193, 5, v192
    v_mfma_f32_32x32x16_bf16 v[32:47], a[184:187], v[120:123], v[32:47]
    s_waitcnt lgkmcnt(4)
    buffer_load_dwordx4 v13, s[28:31], s81 offen offset:3072 lds
    ds_read_b64_tr_b16 a[176:177], v6 offset:34816
    ds_read_b64_tr_b16 a[178:179], v6 offset:35328
    v_and_b32_e64 v193, 3, v0
    v_mfma_f32_32x32x16_bf16 v[32:47], a[188:191], v[124:127], v[32:47]
    s_waitcnt lgkmcnt(4)
    ds_read_b64_tr_b16 a[180:181], v6 offset:35840
    ds_read_b64_tr_b16 a[182:183], v6 offset:36352
    v_lshl_add_u32 v192, v193, 3, v192
    s_lshl_b32 s68, s66, 13
    s_lshl_b32 s69, s66, 10
    s_add_u32 s69, s69, s68
    v_mfma_f32_32x32x16_bf16 v[32:47], a[192:195], v[128:131], v[32:47]
    s_waitcnt lgkmcnt(4)
    s_add_u32 m0, s74, 0xc000
    s_add_u32 s81, s75, 0xe0040
    buffer_load_dwordx4 v10, s[28:31], s81 offen offset:0 lds
    ds_read_b64_tr_b16 a[184:185], v6 offset:36864
    ds_read_b64_tr_b16 a[186:187], v6 offset:37376
    v_mfma_f32_32x32x16_bf16 v[32:47], a[196:199], v[132:135], v[32:47]
    s_waitcnt lgkmcnt(4)
    ds_read_b64_tr_b16 a[188:189], v6 offset:37888
    ds_read_b64_tr_b16 a[190:191], v6 offset:38400
    v_add_u32_e32 v251, s69, v192
    v_xor_b32_e32 v248, 0x400, v251
    v_add_u32_e32 v250, 0x10000, v251
    v_add_u32_e32 v247, 0x10000, v248
    v_mfma_f32_32x32x16_bf16 v[32:47], a[176:179], v[136:139], v[32:47]
    s_waitcnt lgkmcnt(4)
    buffer_load_dwordx4 v11, s[28:31], s81 offen offset:1024 lds
    ds_read_b64_tr_b16 a[192:193], v6 offset:38912
    ds_read_b64_tr_b16 a[194:195], v6 offset:39424
    v_add_u32_e32 v249, 0x20000, v251
    v_mfma_f32_32x32x16_bf16 v[32:47], a[180:183], v[140:143], v[32:47]
    s_waitcnt lgkmcnt(4)
    ds_read_b64_tr_b16 a[196:197], v6 offset:39936
    ds_read_b64_tr_b16 a[198:199], v6 offset:40448
    v_add_u32_e32 v246, 0x20000, v248
    v_lshrrev_b32_e64 v192, 2, v0
    v_and_b32_e32 v193, 3, v0
    v_add_u32_e32 v9, 0x10000, v6
    v_mfma_f32_32x32x16_bf16 v[32:47], a[184:187], v[144:147], v[32:47]
    s_waitcnt lgkmcnt(4)
    buffer_load_dwordx4 v12, s[28:31], s81 offen offset:2048 lds
    ds_read_b64_tr_b16 a[176:177], v9 offset:0
    ds_read_b64_tr_b16 a[178:179], v9 offset:512
    v_lshlrev_b32_e32 v28, 10, v192
    v_mfma_f32_32x32x16_bf16 v[32:47], a[188:191], v[148:151], v[32:47]
    s_waitcnt lgkmcnt(4)
    ds_read_b64_tr_b16 a[180:181], v9 offset:1024
    ds_read_b64_tr_b16 a[182:183], v9 offset:1536
    v_lshl_add_u32 v28, v193, 7, v28
    s_and_b32 s68, s2, 1
    s_lshl_b32 s68, s68, 9
    v_add_u32_e32 v28, s68, v28
    v_mfma_f32_32x32x16_bf16 v[32:47], a[192:195], v[152:155], v[32:47]
    s_waitcnt lgkmcnt(4)
    buffer_load_dwordx4 v13, s[28:31], s81 offen offset:3072 lds
    ds_read_b64_tr_b16 a[184:185], v9 offset:2048
    ds_read_b64_tr_b16 a[186:187], v9 offset:2560
    v_mfma_f32_32x32x16_bf16 v[32:47], a[196:199], v[156:159], v[32:47]
    s_waitcnt lgkmcnt(4)
    ds_read_b64_tr_b16 a[188:189], v9 offset:3072
    ds_read_b64_tr_b16 a[190:191], v9 offset:3584
    v_mov_b32_e32 v193, 0x7ffffff0
    v_cmp_gt_u32 vcc, 4, v192
    s_nop 1
    v_cndmask_b32 v30, v193, v28, vcc
    v_mfma_f32_32x32x16_bf16 v[32:47], a[176:179], v[160:163], v[32:47]
    s_waitcnt lgkmcnt(4)
    s_add_u32 m0, s74, 0x14000
    s_add_u32 s81, s75, 0x150040
    buffer_load_dwordx4 v10, s[28:31], s81 offen offset:0 lds
    ds_read_b64_tr_b16 a[192:193], v9 offset:4096
    ds_read_b64_tr_b16 a[194:195], v9 offset:4608
    v_mfma_f32_32x32x16_bf16 v[32:47], a[180:183], v[164:167], v[32:47]
    s_waitcnt lgkmcnt(4)
    ds_read_b64_tr_b16 a[196:197], v9 offset:5120
    ds_read_b64_tr_b16 a[198:199], v9 offset:5632
    v_cmp_gt_u32 vcc, 14, v192
    s_nop 1
    v_cndmask_b32 v28, v193, v28, vcc
    v_mfma_f32_32x32x16_bf16 v[32:47], a[184:187], v[168:171], v[32:47]
    s_waitcnt lgkmcnt(4)
    buffer_load_dwordx4 v11, s[28:31], s81 offen offset:1024 lds
    ds_read_b64_tr_b16 a[176:177], v9 offset:6144
    ds_read_b64_tr_b16 a[178:179], v9 offset:6656
    s_lshr_b32 s68, s2, 3
    v_mfma_f32_32x32x16_bf16 v[32:47], a[188:191], v[172:175], v[32:47]
    s_waitcnt lgkmcnt(4)
    ds_read_b64_tr_b16 a[180:181], v9 offset:7168
    ds_read_b64_tr_b16 a[182:183], v9 offset:7680
    s_lshl_b32 s68, s68, 2
    s_add_u32 s68, s68, s56
    s_mul_i32 s14, s68, 14336
    s_lshl_b32 s15, s68, 12
    v_mfma_f32_32x32x16_bf16 v[32:47], a[192:195], v[176:179], v[32:47]
    s_waitcnt lgkmcnt(4)
    buffer_load_dwordx4 v12, s[28:31], s81 offen offset:2048 lds
    ds_read_b64_tr_b16 a[184:185], v7 offset:0
    ds_read_b64_tr_b16 a[186:187], v7 offset:512
    v_mfma_f32_32x32x16_bf16 v[32:47], a[196:199], v[180:183], v[32:47]
    s_waitcnt lgkmcnt(4)
    ds_read_b64_tr_b16 a[188:189], v7 offset:1024
    ds_read_b64_tr_b16 a[190:191], v7 offset:1536
    v_mfma_f32_32x32x16_bf16 v[32:47], a[176:179], v[184:187], v[32:47]
    s_waitcnt lgkmcnt(4)
    buffer_load_dwordx4 v13, s[28:31], s81 offen offset:3072 lds
    ds_read_b64_tr_b16 a[192:193], v7 offset:2048
    ds_read_b64_tr_b16 a[194:195], v7 offset:2560
    v_mfma_f32_32x32x16_bf16 v[32:47], a[180:183], v[188:191], v[32:47]
    s_waitcnt lgkmcnt(4)
    ds_read_b64_tr_b16 a[196:197], v7 offset:3072
    ds_read_b64_tr_b16 a[198:199], v7 offset:3584
    v_mfma_f32_32x32x16_bf16 v[48:63], a[184:187], v[64:67], 0
    s_waitcnt lgkmcnt(4)
    s_add_u32 m0, s74, 0x1c000
    s_add_u32 s81, s75, 0x80
    buffer_load_dwordx4 v10, s[28:31], s81 offen offset:0 lds
    ds_read_b64_tr_b16 a[176:177], v7 offset:4096
    ds_read_b64_tr_b16 a[178:179], v7 offset:4608
    v_mfma_f32_32x32x16_bf16 v[48:63], a[188:191], v[68:71], v[48:63]
    s_waitcnt lgkmcnt(4)
    ds_read_b64_tr_b16 a[180:181], v7 offset:5120
    ds_read_b64_tr_b16 a[182:183], v7 offset:5632
    v_mfma_f32_32x32x16_bf16 v[48:63], a[192:195], v[72:75], v[48:63]
    s_waitcnt lgkmcnt(4)
    buffer_load_dwordx4 v11, s[28:31], s81 offen offset:1024 lds
    ds_read_b64_tr_b16 a[184:185], v7 offset:6144
    ds_read_b64_tr_b16 a[186:187], v7 offset:6656
    v_mfma_f32_32x32x16_bf16 v[48:63], a[196:199], v[76:79], v[48:63]
    s_waitcnt lgkmcnt(4)
    ds_read_b64_tr_b16 a[188:189], v7 offset:7168
    ds_read_b64_tr_b16 a[190:191], v7 offset:7680
    v_mul_f32_e32 v20, v32, v32
    v_mul_f32_e64 v21, v33, v33
    v_fma_f32 v20, v20, v3, v2
    v_fma_f32 v21, v21, v3, v2
    v_mfma_f32_32x32x16_bf16 v[48:63], a[176:179], v[80:83], v[48:63]
    s_waitcnt lgkmcnt(4)
    buffer_load_dwordx4 v12, s[28:31], s81 offen offset:2048 lds
    ds_read_b64_tr_b16 a[192:193], v7 offset:16384
    ds_read_b64_tr_b16 a[194:195], v7 offset:16896
    v_mul_f32_e32 v20, v32, v20
    v_mfma_f32_32x32x16_bf16 v[48:63], a[180:183], v[84:87], v[48:63]
    s_waitcnt lgkmcnt(4)
    ds_read_b64_tr_b16 a[196:197], v7 offset:17408
    ds_read_b64_tr_b16 a[198:199], v7 offset:17920
    v_mul_f32_e32 v21, v33, v21
    v_exp_f32_e32 v20, v20
    v_mfma_f32_32x32x16_bf16 v[48:63], a[184:187], v[88:91], v[48:63]
    s_waitcnt lgkmcnt(4)
    buffer_load_dwordx4 v13, s[28:31], s81 offen offset:3072 lds
    ds_read_b64_tr_b16 a[176:177], v7 offset:18432
    ds_read_b64_tr_b16 a[178:179], v7 offset:18944
    v_mfma_f32_32x32x16_bf16 v[48:63], a[188:191], v[92:95], v[48:63]
    s_waitcnt lgkmcnt(4)
    ds_read_b64_tr_b16 a[180:181], v7 offset:19456
    ds_read_b64_tr_b16 a[182:183], v7 offset:19968
    v_exp_f32_e32 v21, v21
    v_mul_f32_e32 v22, v32, v40
    v_mul_f32_e32 v23, v33, v41
    v_mfma_f32_32x32x16_bf16 v[48:63], a[192:195], v[96:99], v[48:63]
    s_waitcnt lgkmcnt(4)
    s_add_u32 m0, s74, 0x24000
    s_add_u32 s81, s75, 0x70080
    buffer_load_dwordx4 v10, s[28:31], s81 offen offset:0 lds
    ds_read_b64_tr_b16 a[184:185], v7 offset:20480
    ds_read_b64_tr_b16 a[186:187], v7 offset:20992
    v_mfma_f32_32x32x16_bf16 v[48:63], a[196:199], v[100:103], v[48:63]
    s_waitcnt lgkmcnt(4)
    ds_read_b64_tr_b16 a[188:189], v7 offset:21504
    ds_read_b64_tr_b16 a[190:191], v7 offset:22016
    v_fma_f32 v20, v20, v4, v4
    v_fma_f32 v21, v21, v4, v4
    v_rcp_f32_e32 v20, v20
    v_mfma_f32_32x32x16_bf16 v[48:63], a[176:179], v[104:107], v[48:63]
    s_waitcnt lgkmcnt(4)
    buffer_load_dwordx4 v11, s[28:31], s81 offen offset:1024 lds
    ds_read_b64_tr_b16 a[192:193], v7 offset:22528
    ds_read_b64_tr_b16 a[194:195], v7 offset:23040
    v_mfma_f32_32x32x16_bf16 v[48:63], a[180:183], v[108:111], v[48:63]
    s_waitcnt lgkmcnt(4)
    ds_read_b64_tr_b16 a[196:197], v7 offset:23552
    ds_read_b64_tr_b16 a[198:199], v7 offset:24064
    v_rcp_f32_e32 v21, v21
    v_mul_f32_e64 v22, v22, v20
    v_mul_f32_e32 v23, v23, v21
    v_mfma_f32_32x32x16_bf16 v[48:63], a[184:187], v[112:115], v[48:63]
    s_waitcnt lgkmcnt(4)
    buffer_load_dwordx4 v12, s[28:31], s81 offen offset:2048 lds
    ds_read_b64_tr_b16 a[176:177], v7 offset:32768
    ds_read_b64_tr_b16 a[178:179], v7 offset:33280
    v_cvt_pk_bf16_f32 v24, v22, v23
    v_mfma_f32_32x32x16_bf16 v[48:63], a[188:191], v[116:119], v[48:63]
    s_waitcnt lgkmcnt(4)
    ds_read_b64_tr_b16 a[180:181], v7 offset:33792
    ds_read_b64_tr_b16 a[182:183], v7 offset:34304
    v_mul_f32_e32 v20, v34, v34
    v_mul_f32_e64 v21, v35, v35
    v_fma_f32 v20, v20, v3, v2
    v_fma_f32 v21, v21, v3, v2
    v_mfma_f32_32x32x16_bf16 v[48:63], a[192:195], v[120:123], v[48:63]
    s_waitcnt lgkmcnt(4)
    buffer_load_dwordx4 v13, s[28:31], s81 offen offset:3072 lds
    ds_read_b64_tr_b16 a[184:185], v7 offset:34816
    ds_read_b64_tr_b16 a[186:187], v7 offset:35328
    v_mul_f32_e32 v20, v34, v20
    v_mfma_f32_32x32x16_bf16 v[48:63], a[196:199], v[124:127], v[48:63]
    s_waitcnt lgkmcnt(4)
    ds_read_b64_tr_b16 a[188:189], v7 offset:35840
    ds_read_b64_tr_b16 a[190:191], v7 offset:36352
    v_mul_f32_e32 v21, v35, v21
    v_exp_f32_e32 v20, v20
    v_mfma_f32_32x32x16_bf16 v[48:63], a[176:179], v[128:131], v[48:63]
    s_waitcnt lgkmcnt(4)
    ds_read_b64_tr_b16 a[192:193], v7 offset:36864
    ds_read_b64_tr_b16 a[194:195], v7 offset:37376
    v_exp_f32_e32 v21, v21
    v_mul_f32_e32 v22, v34, v42
    v_mul_f32_e32 v23, v35, v43
    v_mfma_f32_32x32x16_bf16 v[48:63], a[180:183], v[132:135], v[48:63]
    s_waitcnt lgkmcnt(4)
    ds_read_b64_tr_b16 a[196:197], v7 offset:37888
    ds_read_b64_tr_b16 a[198:199], v7 offset:38400
    v_fma_f32 v20, v20, v4, v4
    v_fma_f32 v21, v21, v4, v4
    v_rcp_f32_e32 v20, v20
    v_mfma_f32_32x32x16_bf16 v[48:63], a[184:187], v[136:139], v[48:63]
    s_waitcnt lgkmcnt(4)
    ds_read_b64_tr_b16 a[176:177], v7 offset:38912
    ds_read_b64_tr_b16 a[178:179], v7 offset:39424
    v_rcp_f32_e32 v21, v21
    v_mul_f32_e32 v22, v22, v20
    v_mul_f32_e32 v23, v23, v21
    v_mfma_f32_32x32x16_bf16 v[48:63], a[188:191], v[140:143], v[48:63]
    s_waitcnt lgkmcnt(4)
    ds_read_b64_tr_b16 a[180:181], v7 offset:39936
    ds_read_b64_tr_b16 a[182:183], v7 offset:40448
    v_cvt_pk_bf16_f32 v25, v22, v23
    v_mul_f32_e32 v20, v36, v36
    v_mul_f32_e32 v21, v37, v37
    v_fma_f32 v20, v20, v3, v2
    v_add_u32_e32 v239, 0x10000, v7
    v_mfma_f32_32x32x16_bf16 v[48:63], a[192:195], v[144:147], v[48:63]
    s_waitcnt lgkmcnt(4)
    ds_read_b64_tr_b16 a[184:185], v239 offset:0
    ds_read_b64_tr_b16 a[186:187], v239 offset:512
    v_fma_f32 v21, v21, v3, v2
    v_mul_f32_e32 v20, v36, v20
    v_mul_f32_e32 v21, v37, v21
    v_mfma_f32_32x32x16_bf16 v[48:63], a[196:199], v[148:151], v[48:63]
    s_waitcnt lgkmcnt(4)
    ds_read_b64_tr_b16 a[188:189], v239 offset:1024
    ds_read_b64_tr_b16 a[190:191], v239 offset:1536
    v_exp_f32_e64 v20, v20
    v_exp_f32_e32 v21, v21
    v_mfma_f32_32x32x16_bf16 v[48:63], a[176:179], v[152:155], v[48:63]
    s_waitcnt lgkmcnt(4)
    ds_read_b64_tr_b16 a[192:193], v239 offset:2048
    ds_read_b64_tr_b16 a[194:195], v239 offset:2560
    v_mul_f32_e32 v22, v36, v44
    v_mul_f32_e32 v23, v37, v45
    v_fma_f32 v20, v20, v4, v4
    v_fma_f32 v21, v21, v4, v4
    v_mfma_f32_32x32x16_bf16 v[48:63], a[180:183], v[156:159], v[48:63]
    s_waitcnt lgkmcnt(4)
    ds_read_b64_tr_b16 a[196:197], v239 offset:3072
    ds_read_b64_tr_b16 a[198:199], v239 offset:3584
    v_rcp_f32_e32 v20, v20
    v_rcp_f32_e32 v21, v21
    v_mfma_f32_32x32x16_bf16 v[48:63], a[184:187], v[160:163], v[48:63]
    s_waitcnt lgkmcnt(4)
    ds_read_b64_tr_b16 a[176:177], v239 offset:4096
    ds_read_b64_tr_b16 a[178:179], v239 offset:4608
    v_mul_f32_e32 v22, v22, v20
    v_mul_f32_e32 v23, v23, v21
    v_cvt_pk_bf16_f32 v26, v22, v23
    v_mul_f32_e32 v20, v38, v38
    v_mfma_f32_32x32x16_bf16 v[48:63], a[188:191], v[164:167], v[48:63]
    s_waitcnt lgkmcnt(4)
    ds_read_b64_tr_b16 a[180:181], v239 offset:5120
    ds_read_b64_tr_b16 a[182:183], v239 offset:5632
    v_mul_f32_e64 v21, v39, v39
    v_fma_f32 v20, v20, v3, v2
    v_fma_f32 v21, v21, v3, v2
    v_mul_f32_e32 v20, v38, v20
    v_mfma_f32_32x32x16_bf16 v[48:63], a[192:195], v[168:171], v[48:63]
    s_waitcnt lgkmcnt(4)
    ds_read_b64_tr_b16 a[184:185], v239 offset:6144
    ds_read_b64_tr_b16 a[186:187], v239 offset:6656
    v_mul_f32_e64 v21, v39, v21
    v_exp_f32_e32 v20, v20
    v_mfma_f32_32x32x16_bf16 v[48:63], a[196:199], v[172:175], v[48:63]
    s_waitcnt lgkmcnt(4)
    ds_read_b64_tr_b16 a[188:189], v239 offset:7168
    ds_read_b64_tr_b16 a[190:191], v239 offset:7680
    v_exp_f32_e32 v21, v21
    v_mul_f32_e32 v22, v38, v46
    v_mul_f32_e32 v23, v39, v47
    v_mfma_f32_32x32x16_bf16 v[48:63], a[176:179], v[176:179], v[48:63]
    s_waitcnt lgkmcnt(4)
    v_fma_f32 v20, v20, v4, v4
    v_fma_f32 v21, v21, v4, v4
    v_rcp_f32_e64 v20, v20
    v_add_u32_e32 v9, 0x10000, v6
    v_mfma_f32_32x32x16_bf16 v[48:63], a[180:183], v[180:183], v[48:63]
    s_waitcnt vmcnt(8) lgkmcnt(0)
    s_barrier
    ds_read_b64_tr_b16 a[192:193], v9 offset:32768
    ds_read_b64_tr_b16 a[194:195], v9 offset:33280
    ds_read_b64_tr_b16 a[196:197], v9 offset:33792
    ds_read_b64_tr_b16 a[198:199], v9 offset:34304
    v_rcp_f32_e64 v21, v21
    v_mfma_f32_32x32x16_bf16 v[48:63], a[184:187], v[184:187], v[48:63]
    ds_read_b64_tr_b16 a[176:177], v9 offset:34816
    ds_read_b64_tr_b16 a[178:179], v9 offset:35328
    v_mul_f32_e64 v22, v22, v20
    v_mul_f32_e32 v23, v23, v21
    v_cvt_pk_bf16_f32 v27, v22, v23
    s_add_u32 s82, s77, 0x0
    v_mfma_f32_32x32x16_bf16 v[48:63], a[188:191], v[188:191], v[48:63]
    s_waitcnt lgkmcnt(4)
    buffer_store_dwordx4 v[24:27], v1, s[44:47], s82 offen sc1
    ds_read_b64_tr_b16 a[180:181], v9 offset:35840
    ds_read_b64_tr_b16 a[182:183], v9 offset:36352
    v_mfma_f32_32x32x16_bf16 v[32:47], a[192:195], v[64:67], 0
    s_waitcnt lgkmcnt(4)
    ds_read_b64_tr_b16 a[184:185], v9 offset:36864
    ds_read_b64_tr_b16 a[186:187], v9 offset:37376
    v_mfma_f32_32x32x16_bf16 v[32:47], a[196:199], v[68:71], v[32:47]
    s_waitcnt lgkmcnt(4)
    ds_read_b64_tr_b16 a[188:189], v9 offset:37888
    ds_read_b64_tr_b16 a[190:191], v9 offset:38400
    v_mfma_f32_32x32x16_bf16 v[32:47], a[176:179], v[72:75], v[32:47]
    s_waitcnt lgkmcnt(4)
    ds_read_b64_tr_b16 a[192:193], v9 offset:38912
    ds_read_b64_tr_b16 a[194:195], v9 offset:39424
    v_mfma_f32_32x32x16_bf16 v[32:47], a[180:183], v[76:79], v[32:47]
    s_waitcnt lgkmcnt(4)
    s_add_u32 m0, s74, 0x0
    s_add_u32 s81, s75, 0xe0080
    buffer_load_dwordx4 v10, s[28:31], s81 offen offset:0 lds
    ds_read_b64_tr_b16 a[196:197], v9 offset:39936
    ds_read_b64_tr_b16 a[198:199], v9 offset:40448
    v_add_u32_e32 v239, 0x20000, v6
    v_mfma_f32_32x32x16_bf16 v[32:47], a[184:187], v[80:83], v[32:47]
    s_waitcnt lgkmcnt(4)
    ds_read_b64_tr_b16 a[176:177], v239 offset:0
    ds_read_b64_tr_b16 a[178:179], v239 offset:512
    v_mul_f32_e32 v20, v48, v48
    v_mul_f32_e64 v21, v49, v49
    v_fma_f32 v20, v20, v3, v2
    v_fma_f32 v21, v21, v3, v2
    v_mfma_f32_32x32x16_bf16 v[32:47], a[188:191], v[84:87], v[32:47]
    s_waitcnt lgkmcnt(4)
    buffer_load_dwordx4 v11, s[28:31], s81 offen offset:1024 lds
    ds_read_b64_tr_b16 a[180:181], v239 offset:1024
    ds_read_b64_tr_b16 a[182:183], v239 offset:1536
    v_mul_f32_e32 v20, v48, v20
    v_mul_f32_e32 v21, v49, v21
    v_mfma_f32_32x32x16_bf16 v[32:47], a[192:195], v[88:91], v[32:47]
    s_waitcnt lgkmcnt(4)
    ds_read_b64_tr_b16 a[184:185], v239 offset:2048
    ds_read_b64_tr_b16 a[186:187], v239 offset:2560
    v_exp_f32_e64 v20, v20
    v_exp_f32_e32 v21, v21
    v_mfma_f32_32x32x16_bf16 v[32:47], a[196:199], v[92:95], v[32:47]
    s_waitcnt lgkmcnt(4)
    buffer_load_dwordx4 v12, s[28:31], s81 offen offset:2048 lds
    ds_read_b64_tr_b16 a[188:189], v239 offset:3072
    ds_read_b64_tr_b16 a[190:191], v239 offset:3584
    v_mul_f32_e32 v22, v48, v56
    v_mfma_f32_32x32x16_bf16 v[32:47], a[176:179], v[96:99], v[32:47]
    s_waitcnt lgkmcnt(4)
    ds_read_b64_tr_b16 a[192:193], v239 offset:4096
    ds_read_b64_tr_b16 a[194:195], v239 offset:4608
    v_mul_f32_e64 v23, v49, v57
    v_fma_f32 v20, v20, v4, v4
    v_fma_f32 v21, v21, v4, v4
    v_mfma_f32_32x32x16_bf16 v[32:47], a[180:183], v[100:103], v[32:47]
    s_waitcnt lgkmcnt(4)
    buffer_load_dwordx4 v13, s[28:31], s81 offen offset:3072 lds
    ds_read_b64_tr_b16 a[196:197], v239 offset:5120
    ds_read_b64_tr_b16 a[198:199], v239 offset:5632
    v_mfma_f32_32x32x16_bf16 v[32:47], a[184:187], v[104:107], v[32:47]
    s_waitcnt lgkmcnt(4)
    ds_read_b64_tr_b16 a[176:177], v239 offset:6144
    ds_read_b64_tr_b16 a[178:179], v239 offset:6656
    v_rcp_f32_e32 v20, v20
    v_rcp_f32_e32 v21, v21
    v_mul_f32_e32 v22, v22, v20
    v_mfma_f32_32x32x16_bf16 v[32:47], a[188:191], v[108:111], v[32:47]
    s_waitcnt lgkmcnt(4)
    s_add_u32 m0, s74, 0x4000
    s_add_u32 s81, s75, 0x150080
    buffer_load_dwordx4 v10, s[28:31], s81 offen offset:0 lds
    ds_read_b64_tr_b16 a[180:181], v239 offset:7168
    ds_read_b64_tr_b16 a[182:183], v239 offset:7680
    v_mfma_f32_32x32x16_bf16 v[32:47], a[192:195], v[112:115], v[32:47]
    s_waitcnt lgkmcnt(4)
    ds_read_b64_tr_b16 a[184:185], v6 offset:49152
    ds_read_b64_tr_b16 a[186:187], v6 offset:49664
    v_mul_f32_e32 v23, v23, v21
    v_cvt_pk_bf16_f32 v24, v22, v23
    v_mul_f32_e64 v20, v50, v50
    v_mul_f32_e32 v21, v51, v51
    v_mfma_f32_32x32x16_bf16 v[32:47], a[196:199], v[116:119], v[32:47]
    s_waitcnt lgkmcnt(4)
    buffer_load_dwordx4 v11, s[28:31], s81 offen offset:1024 lds
    ds_read_b64_tr_b16 a[188:189], v6 offset:50176
    ds_read_b64_tr_b16 a[190:191], v6 offset:50688
    v_fma_f32 v20, v20, v3, v2
    v_mfma_f32_32x32x16_bf16 v[32:47], a[176:179], v[120:123], v[32:47]
    s_waitcnt lgkmcnt(4)
    ds_read_b64_tr_b16 a[192:193], v6 offset:51200
    ds_read_b64_tr_b16 a[194:195], v6 offset:51712
    v_fma_f32 v21, v21, v3, v2
    v_mul_f32_e32 v20, v50, v20
    v_mul_f32_e64 v21, v51, v21
    v_exp_f32_e32 v20, v20
    v_mfma_f32_32x32x16_bf16 v[32:47], a[180:183], v[124:127], v[32:47]
    s_waitcnt lgkmcnt(4)
    buffer_load_dwordx4 v12, s[28:31], s81 offen offset:2048 lds
    ds_read_b64_tr_b16 a[196:197], v6 offset:52224
    ds_read_b64_tr_b16 a[198:199], v6 offset:52736
    v_exp_f32_e32 v21, v21
    v_mfma_f32_32x32x16_bf16 v[32:47], a[184:187], v[128:131], v[32:47]
    s_waitcnt lgkmcnt(4)
    ds_read_b64_tr_b16 a[176:177], v6 offset:53248
    ds_read_b64_tr_b16 a[178:179], v6 offset:53760
    v_mul_f32_e32 v22, v50, v58
    v_mul_f32_e32 v23, v51, v59
    v_fma_f32 v20, v20, v4, v4
    v_fma_f32 v21, v21, v4, v4
    v_mfma_f32_32x32x16_bf16 v[32:47], a[188:191], v[132:135], v[32:47]
    s_waitcnt lgkmcnt(4)
    buffer_load_dwordx4 v13, s[28:31], s81 offen offset:3072 lds
    ds_read_b64_tr_b16 a[180:181], v6 offset:54272
    ds_read_b64_tr_b16 a[182:183], v6 offset:54784
    v_mfma_f32_32x32x16_bf16 v[32:47], a[192:195], v[136:139], v[32:47]
    s_waitcnt lgkmcnt(4)
    ds_read_b64_tr_b16 a[184:185], v6 offset:55296
    ds_read_b64_tr_b16 a[186:187], v6 offset:55808
    v_rcp_f32_e64 v20, v20
    v_rcp_f32_e32 v21, v21
    v_mfma_f32_32x32x16_bf16 v[32:47], a[196:199], v[140:143], v[32:47]
    s_waitcnt lgkmcnt(4)
    ds_read_b64_tr_b16 a[188:189], v6 offset:56320
    ds_read_b64_tr_b16 a[190:191], v6 offset:56832
    v_mul_f32_e32 v22, v22, v20
    v_mul_f32_e32 v23, v23, v21
    v_cvt_pk_bf16_f32 v25, v22, v23
    v_mul_f32_e64 v20, v52, v52
    v_mul_f32_e32 v21, v53, v53
    v_add_u32_e32 v9, 0x10000, v6
    v_mfma_f32_32x32x16_bf16 v[32:47], a[176:179], v[144:147], v[32:47]
    s_waitcnt lgkmcnt(4)
    ds_read_b64_tr_b16 a[192:193], v9 offset:16384
    ds_read_b64_tr_b16 a[194:195], v9 offset:16896
    v_fma_f32 v20, v20, v3, v2
    v_fma_f32 v21, v21, v3, v2
    v_mul_f32_e64 v20, v52, v20
    v_mul_f32_e32 v21, v53, v21
    v_mfma_f32_32x32x16_bf16 v[32:47], a[180:183], v[148:151], v[32:47]
    s_waitcnt lgkmcnt(4)
    ds_read_b64_tr_b16 a[196:197], v9 offset:17408
    ds_read_b64_tr_b16 a[198:199], v9 offset:17920
    v_exp_f32_e64 v20, v20
    v_exp_f32_e32 v21, v21
    v_mfma_f32_32x32x16_bf16 v[32:47], a[184:187], v[152:155], v[32:47]
    s_waitcnt lgkmcnt(4)
    ds_read_b64_tr_b16 a[176:177], v9 offset:18432
    ds_read_b64_tr_b16 a[178:179], v9 offset:18944
    v_mul_f32_e32 v22, v52, v60
    v_mul_f32_e32 v23, v53, v61
    v_fma_f32 v20, v20, v4, v4
    v_fma_f32 v21, v21, v4, v4
    v_mfma_f32_32x32x16_bf16 v[32:47], a[188:191], v[156:159], v[32:47]
    s_waitcnt lgkmcnt(4)
    ds_read_b64_tr_b16 a[180:181], v9 offset:19456
    ds_read_b64_tr_b16 a[182:183], v9 offset:19968
    v_rcp_f32_e32 v20, v20
    v_rcp_f32_e64 v21, v21
    v_mul_f32_e32 v22, v22, v20
    v_mfma_f32_32x32x16_bf16 v[32:47], a[192:195], v[160:163], v[32:47]
    s_waitcnt lgkmcnt(4)
    ds_read_b64_tr_b16 a[184:185], v9 offset:20480
    ds_read_b64_tr_b16 a[186:187], v9 offset:20992
    v_mul_f32_e64 v23, v23, v21
    v_cvt_pk_bf16_f32 v26, v22, v23
    v_mul_f32_e64 v20, v54, v54
    v_mul_f32_e32 v21, v55, v55
    v_fma_f32 v20, v20, v3, v2
    v_mfma_f32_32x32x16_bf16 v[32:47], a[196:199], v[164:167], v[32:47]
    s_waitcnt lgkmcnt(4)
    ds_read_b64_tr_b16 a[188:189], v9 offset:21504
    ds_read_b64_tr_b16 a[190:191], v9 offset:22016
    v_fma_f32 v21, v21, v3, v2
    v_mul_f32_e64 v20, v54, v20
    v_mul_f32_e32 v21, v55, v21
    v_mfma_f32_32x32x16_bf16 v[32:47], a[176:179], v[168:171], v[32:47]
    s_waitcnt lgkmcnt(4)
    ds_read_b64_tr_b16 a[192:193], v9 offset:22528
    ds_read_b64_tr_b16 a[194:195], v9 offset:23040
    v_exp_f32_e64 v20, v20
    v_exp_f32_e32 v21, v21
    v_mfma_f32_32x32x16_bf16 v[32:47], a[180:183], v[172:175], v[32:47]
    s_waitcnt lgkmcnt(4)
    ds_read_b64_tr_b16 a[196:197], v9 offset:23552
    ds_read_b64_tr_b16 a[198:199], v9 offset:24064
    v_mul_f32_e32 v22, v54, v62
    v_mul_f32_e32 v23, v55, v63
    v_fma_f32 v20, v20, v4, v4
    v_fma_f32 v21, v21, v4, v4
    v_add_u32_e32 v239, 0x10000, v7
    v_mfma_f32_32x32x16_bf16 v[32:47], a[184:187], v[176:179], v[32:47]
    s_waitcnt lgkmcnt(4)
    ds_read_b64_tr_b16 a[176:177], v239 offset:32768
    ds_read_b64_tr_b16 a[178:179], v239 offset:33280
    v_rcp_f32_e32 v20, v20
    v_rcp_f32_e64 v21, v21
    v_mul_f32_e32 v22, v22, v20
    v_mfma_f32_32x32x16_bf16 v[32:47], a[188:191], v[180:183], v[32:47]
    s_waitcnt lgkmcnt(4)
    ds_read_b64_tr_b16 a[180:181], v239 offset:33792
    ds_read_b64_tr_b16 a[182:183], v239 offset:34304
    v_mul_f32_e64 v23, v23, v21
    v_cvt_pk_bf16_f32 v27, v22, v23
    s_add_u32 s82, s77, 0x400
    v_mfma_f32_32x32x16_bf16 v[32:47], a[192:195], v[184:187], v[32:47]
    s_waitcnt lgkmcnt(4)
    buffer_store_dwordx4 v[24:27], v1, s[44:47], s82 offen sc1
    ds_read_b64_tr_b16 a[184:185], v239 offset:34816
    ds_read_b64_tr_b16 a[186:187], v239 offset:35328
    v_mfma_f32_32x32x16_bf16 v[32:47], a[196:199], v[188:191], v[32:47]
    s_waitcnt lgkmcnt(4)
    ds_read_b64_tr_b16 a[188:189], v239 offset:35840
    ds_read_b64_tr_b16 a[190:191], v239 offset:36352
    v_mfma_f32_32x32x16_bf16 v[48:63], a[176:179], v[64:67], 0
    s_waitcnt lgkmcnt(4)
    ds_read_b64_tr_b16 a[192:193], v239 offset:36864
    ds_read_b64_tr_b16 a[194:195], v239 offset:37376
    v_mfma_f32_32x32x16_bf16 v[48:63], a[180:183], v[68:71], v[48:63]
    s_waitcnt lgkmcnt(4)
    ds_read_b64_tr_b16 a[196:197], v239 offset:37888
    ds_read_b64_tr_b16 a[198:199], v239 offset:38400
    v_mfma_f32_32x32x16_bf16 v[48:63], a[184:187], v[72:75], v[48:63]
    s_waitcnt lgkmcnt(4)
    s_add_u32 m0, s74, 0x8000
    s_add_u32 s81, s75, 0xc0
    buffer_load_dwordx4 v10, s[28:31], s81 offen offset:0 lds
    ds_read_b64_tr_b16 a[176:177], v239 offset:38912
    ds_read_b64_tr_b16 a[178:179], v239 offset:39424
    v_mfma_f32_32x32x16_bf16 v[48:63], a[188:191], v[76:79], v[48:63]
    s_waitcnt lgkmcnt(4)
    ds_read_b64_tr_b16 a[180:181], v239 offset:39936
    ds_read_b64_tr_b16 a[182:183], v239 offset:40448
    v_mul_f32_e32 v20, v32, v32
    v_mul_f32_e32 v21, v33, v33
    v_fma_f32 v20, v20, v3, v2
    v_fma_f32 v21, v21, v3, v2
    v_add_u32_e32 v9, 0x20000, v7
    v_mfma_f32_32x32x16_bf16 v[48:63], a[192:195], v[80:83], v[48:63]
    s_waitcnt lgkmcnt(4)
    buffer_load_dwordx4 v11, s[28:31], s81 offen offset:1024 lds
    ds_read_b64_tr_b16 a[184:185], v9 offset:0
    ds_read_b64_tr_b16 a[186:187], v9 offset:512
    v_mul_f32_e32 v20, v32, v20
    v_mfma_f32_32x32x16_bf16 v[48:63], a[196:199], v[84:87], v[48:63]
    s_waitcnt lgkmcnt(4)
    ds_read_b64_tr_b16 a[188:189], v9 offset:1024
    ds_read_b64_tr_b16 a[190:191], v9 offset:1536
    v_mul_f32_e32 v21, v33, v21
    v_exp_f32_e64 v20, v20
    v_exp_f32_e32 v21, v21
    v_mfma_f32_32x32x16_bf16 v[48:63], a[176:179], v[88:91], v[48:63]
    s_waitcnt lgkmcnt(4)
    buffer_load_dwordx4 v12, s[28:31], s81 offen offset:2048 lds
    ds_read_b64_tr_b16 a[192:193], v9 offset:2048
    ds_read_b64_tr_b16 a[194:195], v9 offset:2560
    v_mul_f32_e32 v22, v32, v40
    v_mfma_f32_32x32x16_bf16 v[48:63], a[180:183], v[92:95], v[48:63]
    s_waitcnt lgkmcnt(4)
    ds_read_b64_tr_b16 a[196:197], v9 offset:3072
    ds_read_b64_tr_b16 a[198:199], v9 offset:3584
    v_mul_f32_e64 v23, v33, v41
    v_fma_f32 v20, v20, v4, v4
    v_fma_f32 v21, v21, v4, v4
    v_mfma_f32_32x32x16_bf16 v[48:63], a[184:187], v[96:99], v[48:63]
    s_waitcnt lgkmcnt(4)
    buffer_load_dwordx4 v13, s[28:31], s81 offen offset:3072 lds
    ds_read_b64_tr_b16 a[176:177], v9 offset:4096
    ds_read_b64_tr_b16 a[178:179], v9 offset:4608
    v_mfma_f32_32x32x16_bf16 v[48:63], a[188:191], v[100:103], v[48:63]
    s_waitcnt lgkmcnt(4)
    ds_read_b64_tr_b16 a[180:181], v9 offset:5120
    ds_read_b64_tr_b16 a[182:183], v9 offset:5632
    v_rcp_f32_e64 v20, v20
    v_rcp_f32_e32 v21, v21
    v_mfma_f32_32x32x16_bf16 v[48:63], a[192:195], v[104:107], v[48:63]
    s_waitcnt lgkmcnt(4)
    s_add_u32 m0, s74, 0x10000
    s_add_u32 s81, s75, 0x700c0
    buffer_load_dwordx4 v10, s[28:31], s81 offen offset:0 lds
    ds_read_b64_tr_b16 a[184:185], v9 offset:6144
    ds_read_b64_tr_b16 a[186:187], v9 offset:6656
    v_mfma_f32_32x32x16_bf16 v[48:63], a[196:199], v[108:111], v[48:63]
    s_waitcnt lgkmcnt(4)
    ds_read_b64_tr_b16 a[188:189], v9 offset:7168
    ds_read_b64_tr_b16 a[190:191], v9 offset:7680
    v_mul_f32_e32 v22, v22, v20
    v_mul_f32_e64 v23, v23, v21
    v_cvt_pk_bf16_f32 v24, v22, v23
    v_mul_f32_e32 v20, v34, v34
    v_mfma_f32_32x32x16_bf16 v[48:63], a[176:179], v[112:115], v[48:63]
    s_waitcnt lgkmcnt(4)
    buffer_load_dwordx4 v11, s[28:31], s81 offen offset:1024 lds
    ds_read_b64_tr_b16 a[192:193], v7 offset:49152
    ds_read_b64_tr_b16 a[194:195], v7 offset:49664
    v_mul_f32_e32 v21, v35, v35
    v_mfma_f32_32x32x16_bf16 v[48:63], a[180:183], v[116:119], v[48:63]
    s_waitcnt lgkmcnt(4)
    ds_read_b64_tr_b16 a[196:197], v7 offset:50176
    ds_read_b64_tr_b16 a[198:199], v7 offset:50688
    v_fma_f32 v20, v20, v3, v2
    v_fma_f32 v21, v21, v3, v2
    v_mul_f32_e64 v20, v34, v20
    v_mul_f32_e32 v21, v35, v21
    v_mfma_f32_32x32x16_bf16 v[48:63], a[184:187], v[120:123], v[48:63]
    s_waitcnt lgkmcnt(4)
    buffer_load_dwordx4 v12, s[28:31], s81 offen offset:2048 lds
    ds_read_b64_tr_b16 a[176:177], v7 offset:51200
    ds_read_b64_tr_b16 a[178:179], v7 offset:51712
    v_exp_f32_e32 v20, v20
    v_mfma_f32_32x32x16_bf16 v[48:63], a[188:191], v[124:127], v[48:63]
    s_waitcnt lgkmcnt(4)
    ds_read_b64_tr_b16 a[180:181], v7 offset:52224
    ds_read_b64_tr_b16 a[182:183], v7 offset:52736
    v_exp_f32_e32 v21, v21
    v_mul_f32_e32 v22, v34, v42
    v_mul_f32_e32 v23, v35, v43
    v_mfma_f32_32x32x16_bf16 v[48:63], a[192:195], v[128:131], v[48:63]
    s_waitcnt lgkmcnt(4)
    buffer_load_dwordx4 v13, s[28:31], s81 offen offset:3072 lds
    ds_read_b64_tr_b16 a[184:185], v7 offset:53248
    ds_read_b64_tr_b16 a[186:187], v7 offset:53760
    v_fma_f32 v20, v20, v4, v4
    v_mfma_f32_32x32x16_bf16 v[48:63], a[196:199], v[132:135], v[48:63]
    s_waitcnt lgkmcnt(4)
    ds_read_b64_tr_b16 a[188:189], v7 offset:54272
    ds_read_b64_tr_b16 a[190:191], v7 offset:54784
    v_fma_f32 v21, v21, v4, v4
    v_rcp_f32_e32 v20, v20
    v_mfma_f32_32x32x16_bf16 v[48:63], a[176:179], v[136:139], v[48:63]
    s_waitcnt lgkmcnt(4)
    ds_read_b64_tr_b16 a[192:193], v7 offset:55296
    ds_read_b64_tr_b16 a[194:195], v7 offset:55808
    v_rcp_f32_e32 v21, v21
    v_mul_f32_e64 v22, v22, v20
    v_mul_f32_e32 v23, v23, v21
    v_mfma_f32_32x32x16_bf16 v[48:63], a[180:183], v[140:143], v[48:63]
    s_waitcnt lgkmcnt(4)
    ds_read_b64_tr_b16 a[196:197], v7 offset:56320
    ds_read_b64_tr_b16 a[198:199], v7 offset:56832
    v_cvt_pk_bf16_f32 v25, v22, v23
    v_mul_f32_e32 v20, v36, v36
    v_mul_f32_e32 v21, v37, v37
    v_fma_f32 v20, v20, v3, v2
    v_add_u32_e32 v239, 0x10000, v7
    v_mfma_f32_32x32x16_bf16 v[48:63], a[184:187], v[144:147], v[48:63]
    s_waitcnt lgkmcnt(4)
    ds_read_b64_tr_b16 a[176:177], v239 offset:16384
    ds_read_b64_tr_b16 a[178:179], v239 offset:16896
    v_fma_f32 v21, v21, v3, v2
    v_mul_f32_e32 v20, v36, v20
    v_mul_f32_e32 v21, v37, v21
    v_mfma_f32_32x32x16_bf16 v[48:63], a[188:191], v[148:151], v[48:63]
    s_waitcnt lgkmcnt(4)
    ds_read_b64_tr_b16 a[180:181], v239 offset:17408
    ds_read_b64_tr_b16 a[182:183], v239 offset:17920
    v_exp_f32_e64 v20, v20
    v_exp_f32_e32 v21, v21
    v_mfma_f32_32x32x16_bf16 v[48:63], a[192:195], v[152:155], v[48:63]
    s_waitcnt lgkmcnt(4)
    ds_read_b64_tr_b16 a[184:185], v239 offset:18432
    ds_read_b64_tr_b16 a[186:187], v239 offset:18944
    v_mul_f32_e32 v22, v36, v44
    v_mul_f32_e32 v23, v37, v45
    v_fma_f32 v20, v20, v4, v4
    v_fma_f32 v21, v21, v4, v4
    v_mfma_f32_32x32x16_bf16 v[48:63], a[196:199], v[156:159], v[48:63]
    s_waitcnt lgkmcnt(4)
    ds_read_b64_tr_b16 a[188:189], v239 offset:19456
    ds_read_b64_tr_b16 a[190:191], v239 offset:19968
    v_rcp_f32_e32 v20, v20
    v_rcp_f32_e64 v21, v21
    v_mul_f32_e32 v22, v22, v20
    v_mfma_f32_32x32x16_bf16 v[48:63], a[176:179], v[160:163], v[48:63]
    s_waitcnt lgkmcnt(4)
    ds_read_b64_tr_b16 a[192:193], v239 offset:20480
    ds_read_b64_tr_b16 a[194:195], v239 offset:20992
    v_mul_f32_e64 v23, v23, v21
    v_cvt_pk_bf16_f32 v26, v22, v23
    v_mul_f32_e64 v20, v38, v38
    v_mul_f32_e32 v21, v39, v39
    v_mfma_f32_32x32x16_bf16 v[48:63], a[180:183], v[164:167], v[48:63]
    s_waitcnt lgkmcnt(4)
    ds_read_b64_tr_b16 a[196:197], v239 offset:21504
    ds_read_b64_tr_b16 a[198:199], v239 offset:22016
    v_fma_f32 v20, v20, v3, v2
    v_fma_f32 v21, v21, v3, v2
    v_mul_f32_e64 v20, v38, v20
    v_mul_f32_e32 v21, v39, v21
    v_mfma_f32_32x32x16_bf16 v[48:63], a[184:187], v[168:171], v[48:63]
    s_waitcnt lgkmcnt(4)
    ds_read_b64_tr_b16 a[176:177], v239 offset:22528
    ds_read_b64_tr_b16 a[178:179], v239 offset:23040
    v_exp_f32_e64 v20, v20
    v_exp_f32_e32 v21, v21
    v_mfma_f32_32x32x16_bf16 v[48:63], a[188:191], v[172:175], v[48:63]
    s_waitcnt lgkmcnt(4)
    ds_read_b64_tr_b16 a[180:181], v239 offset:23552
    ds_read_b64_tr_b16 a[182:183], v239 offset:24064
    v_mul_f32_e32 v22, v38, v46
    v_mul_f32_e32 v23, v39, v47
    v_fma_f32 v20, v20, v4, v4
    v_fma_f32 v21, v21, v4, v4
    v_mfma_f32_32x32x16_bf16 v[48:63], a[192:195], v[176:179], v[48:63]
    s_waitcnt lgkmcnt(4)
    v_rcp_f32_e32 v20, v20
    v_rcp_f32_e32 v21, v21
    v_mul_f32_e32 v22, v22, v20
    v_add_u32_e32 v9, 0x10000, v6
    v_mfma_f32_32x32x16_bf16 v[48:63], a[196:199], v[180:183], v[48:63]
    s_waitcnt vmcnt(9) lgkmcnt(0)
    s_barrier
    ds_read_b64_tr_b16 a[184:185], v9 offset:49152
    ds_read_b64_tr_b16 a[186:187], v9 offset:49664
    ds_read_b64_tr_b16 a[188:189], v9 offset:50176
    ds_read_b64_tr_b16 a[190:191], v9 offset:50688
    v_mul_f32_e64 v23, v23, v21
    v_cvt_pk_bf16_f32 v27, v22, v23
    s_add_u32 s82, s77, 0x800
    v_mfma_f32_32x32x16_bf16 v[48:63], a[176:179], v[184:187], v[48:63]
    buffer_store_dwordx4 v[24:27], v1, s[44:47], s82 offen sc1
    ds_read_b64_tr_b16 a[192:193], v9 offset:51200
    ds_read_b64_tr_b16 a[194:195], v9 offset:51712
    v_mfma_f32_32x32x16_bf16 v[48:63], a[180:183], v[188:191], v[48:63]
    s_waitcnt lgkmcnt(4)
    ds_read_b64_tr_b16 a[196:197], v9 offset:52224
    ds_read_b64_tr_b16 a[198:199], v9 offset:52736
    v_mfma_f32_32x32x16_bf16 v[32:47], a[184:187], v[64:67], 0
    s_waitcnt lgkmcnt(4)
    ds_read_b64_tr_b16 a[176:177], v9 offset:53248
    ds_read_b64_tr_b16 a[178:179], v9 offset:53760
    v_mfma_f32_32x32x16_bf16 v[32:47], a[188:191], v[68:71], v[32:47]
    s_waitcnt lgkmcnt(4)
    ds_read_b64_tr_b16 a[180:181], v9 offset:54272
    ds_read_b64_tr_b16 a[182:183], v9 offset:54784
    v_mfma_f32_32x32x16_bf16 v[32:47], a[192:195], v[72:75], v[32:47]
    s_waitcnt lgkmcnt(4)
    s_add_u32 m0, s74, 0x18000
    s_add_u32 s81, s75, 0xe00c0
    buffer_load_dwordx4 v10, s[28:31], s81 offen offset:0 lds
    ds_read_b64_tr_b16 a[184:185], v9 offset:55296
    ds_read_b64_tr_b16 a[186:187], v9 offset:55808
    v_mfma_f32_32x32x16_bf16 v[32:47], a[196:199], v[76:79], v[32:47]
    s_waitcnt lgkmcnt(4)
    ds_read_b64_tr_b16 a[188:189], v9 offset:56320
    ds_read_b64_tr_b16 a[190:191], v9 offset:56832
    v_mul_f32_e32 v20, v48, v48
    v_mul_f32_e64 v21, v49, v49
    v_fma_f32 v20, v20, v3, v2
    v_fma_f32 v21, v21, v3, v2
    v_add_u32_e32 v239, 0x20000, v6
    v_mfma_f32_32x32x16_bf16 v[32:47], a[176:179], v[80:83], v[32:47]
    s_waitcnt lgkmcnt(4)
    buffer_load_dwordx4 v11, s[28:31], s81 offen offset:1024 lds
    ds_read_b64_tr_b16 a[192:193], v239 offset:16384
    ds_read_b64_tr_b16 a[194:195], v239 offset:16896
    v_mul_f32_e32 v20, v48, v20
    v_mfma_f32_32x32x16_bf16 v[32:47], a[180:183], v[84:87], v[32:47]
    s_waitcnt lgkmcnt(4)
    ds_read_b64_tr_b16 a[196:197], v239 offset:17408
    ds_read_b64_tr_b16 a[198:199], v239 offset:17920
    v_mul_f32_e32 v21, v49, v21
    v_exp_f32_e64 v20, v20
    v_exp_f32_e32 v21, v21
    v_mfma_f32_32x32x16_bf16 v[32:47], a[184:187], v[88:91], v[32:47]
    s_waitcnt lgkmcnt(4)
    buffer_load_dwordx4 v12, s[28:31], s81 offen offset:2048 lds
    ds_read_b64_tr_b16 a[176:177], v239 offset:18432
    ds_read_b64_tr_b16 a[178:179], v239 offset:18944
    v_mul_f32_e32 v22, v48, v56
    v_mfma_f32_32x32x16_bf16 v[32:47], a[188:191], v[92:95], v[32:47]
    s_waitcnt lgkmcnt(4)
    ds_read_b64_tr_b16 a[180:181], v239 offset:19456
    ds_read_b64_tr_b16 a[182:183], v239 offset:19968
    v_mul_f32_e64 v23, v49, v57
    v_fma_f32 v20, v20, v4, v4
    v_fma_f32 v21, v21, v4, v4
    v_mfma_f32_32x32x16_bf16 v[32:47], a[192:195], v[96:99], v[32:47]
    s_waitcnt lgkmcnt(4)
    buffer_load_dwordx4 v13, s[28:31], s81 offen offset:3072 lds
    ds_read_b64_tr_b16 a[184:185], v239 offset:20480
    ds_read_b64_tr_b16 a[186:187], v239 offset:20992
    v_mfma_f32_32x32x16_bf16 v[32:47], a[196:199], v[100:103], v[32:47]
    s_waitcnt lgkmcnt(4)
    ds_read_b64_tr_b16 a[188:189], v239 offset:21504
    ds_read_b64_tr_b16 a[190:191], v239 offset:22016
    v_rcp_f32_e64 v20, v20
    v_rcp_f32_e32 v21, v21
    v_mfma_f32_32x32x16_bf16 v[32:47], a[176:179], v[104:107], v[32:47]
    s_waitcnt lgkmcnt(4)
    s_add_u32 m0, s74, 0x20000
    s_add_u32 s81, s75, 0x1500c0
    buffer_load_dwordx4 v10, s[28:31], s81 offen offset:0 lds
    ds_read_b64_tr_b16 a[192:193], v239 offset:22528
    ds_read_b64_tr_b16 a[194:195], v239 offset:23040
    v_mfma_f32_32x32x16_bf16 v[32:47], a[180:183], v[108:111], v[32:47]
    s_waitcnt lgkmcnt(4)
    ds_read_b64_tr_b16 a[196:197], v239 offset:23552
    ds_read_b64_tr_b16 a[198:199], v239 offset:24064
    v_mul_f32_e32 v22, v22, v20
    v_mul_f32_e64 v23, v23, v21
    v_cvt_pk_bf16_f32 v24, v22, v23
    v_mul_f32_e32 v20, v50, v50
    v_mfma_f32_32x32x16_bf16 v[32:47], a[184:187], v[112:115], v[32:47]
    s_waitcnt lgkmcnt(4)
    buffer_load_dwordx4 v11, s[28:31], s81 offen offset:1024 lds
    ds_read_b64_tr_b16 a[176:177], v6 offset:0
    ds_read_b64_tr_b16 a[178:179], v6 offset:512
    v_mul_f32_e32 v21, v51, v51
    v_mfma_f32_32x32x16_bf16 v[32:47], a[188:191], v[116:119], v[32:47]
    s_waitcnt lgkmcnt(4)
    ds_read_b64_tr_b16 a[180:181], v6 offset:1024
    ds_read_b64_tr_b16 a[182:183], v6 offset:1536
    v_fma_f32 v20, v20, v3, v2
    v_fma_f32 v21, v21, v3, v2
    v_mul_f32_e64 v20, v50, v20
    v_mul_f32_e32 v21, v51, v21
    v_mfma_f32_32x32x16_bf16 v[32:47], a[192:195], v[120:123], v[32:47]
    s_waitcnt lgkmcnt(4)
    buffer_load_dwordx4 v12, s[28:31], s81 offen offset:2048 lds
    ds_read_b64_tr_b16 a[184:185], v6 offset:2048
    ds_read_b64_tr_b16 a[186:187], v6 offset:2560
    v_exp_f32_e32 v20, v20
    v_mfma_f32_32x32x16_bf16 v[32:47], a[196:199], v[124:127], v[32:47]
    s_waitcnt lgkmcnt(4)
    ds_read_b64_tr_b16 a[188:189], v6 offset:3072
    ds_read_b64_tr_b16 a[190:191], v6 offset:3584
    v_exp_f32_e32 v21, v21
    v_mul_f32_e32 v22, v50, v58
    v_mul_f32_e32 v23, v51, v59
    v_mfma_f32_32x32x16_bf16 v[32:47], a[176:179], v[128:131], v[32:47]
    s_waitcnt lgkmcnt(4)
    buffer_load_dwordx4 v13, s[28:31], s81 offen offset:3072 lds
    ds_read_b64_tr_b16 a[192:193], v6 offset:4096
    ds_read_b64_tr_b16 a[194:195], v6 offset:4608
    v_fma_f32 v20, v20, v4, v4
    v_mfma_f32_32x32x16_bf16 v[32:47], a[180:183], v[132:135], v[32:47]
    s_waitcnt lgkmcnt(4)
    ds_read_b64_tr_b16 a[196:197], v6 offset:5120
    ds_read_b64_tr_b16 a[198:199], v6 offset:5632
    v_fma_f32 v21, v21, v4, v4
    v_rcp_f32_e32 v20, v20
    v_mfma_f32_32x32x16_bf16 v[32:47], a[184:187], v[136:139], v[32:47]
    s_waitcnt lgkmcnt(4)
    buffer_load_dword v238, v28, s[36:39], s14 offen
    ds_read_b64_tr_b16 a[176:177], v6 offset:6144
    ds_read_b64_tr_b16 a[178:179], v6 offset:6656
    v_mfma_f32_32x32x16_bf16 v[32:47], a[188:191], v[140:143], v[32:47]
    s_waitcnt lgkmcnt(4)
    ds_read_b64_tr_b16 a[180:181], v6 offset:7168
    ds_read_b64_tr_b16 a[182:183], v6 offset:7680
    v_rcp_f32_e32 v21, v21
    v_mul_f32_e32 v22, v22, v20
    v_mul_f32_e64 v23, v23, v21
    v_cvt_pk_bf16_f32 v25, v22, v23
    v_mfma_f32_32x32x16_bf16 v[32:47], a[192:195], v[144:147], v[32:47]
    s_waitcnt lgkmcnt(4)
    ds_read_b64_tr_b16 a[184:185], v6 offset:16384
    ds_read_b64_tr_b16 a[186:187], v6 offset:16896
    v_mul_f32_e32 v20, v52, v52
    v_mul_f32_e64 v21, v53, v53
    v_fma_f32 v20, v20, v3, v2
    v_fma_f32 v21, v21, v3, v2
    v_mfma_f32_32x32x16_bf16 v[32:47], a[196:199], v[148:151], v[32:47]
    s_waitcnt lgkmcnt(4)
    ds_read_b64_tr_b16 a[188:189], v6 offset:17408
    ds_read_b64_tr_b16 a[190:191], v6 offset:17920
    v_mul_f32_e32 v20, v52, v20
    v_mul_f32_e64 v21, v53, v21
    v_exp_f32_e32 v20, v20
    v_mfma_f32_32x32x16_bf16 v[32:47], a[176:179], v[152:155], v[32:47]
    s_waitcnt lgkmcnt(4)
    ds_read_b64_tr_b16 a[192:193], v6 offset:18432
    ds_read_b64_tr_b16 a[194:195], v6 offset:18944
    v_exp_f32_e32 v21, v21
    v_mul_f32_e32 v22, v52, v60
    v_mul_f32_e32 v23, v53, v61
    v_mfma_f32_32x32x16_bf16 v[32:47], a[180:183], v[156:159], v[32:47]
    s_waitcnt lgkmcnt(4)
    ds_read_b64_tr_b16 a[196:197], v6 offset:19456
    ds_read_b64_tr_b16 a[198:199], v6 offset:19968
    v_fma_f32 v20, v20, v4, v4
    v_fma_f32 v21, v21, v4, v4
    v_rcp_f32_e32 v20, v20
    v_mfma_f32_32x32x16_bf16 v[32:47], a[184:187], v[160:163], v[32:47]
    s_waitcnt lgkmcnt(4)
    ds_read_b64_tr_b16 a[176:177], v6 offset:20480
    ds_read_b64_tr_b16 a[178:179], v6 offset:20992
    v_rcp_f32_e32 v21, v21
    v_mul_f32_e32 v22, v22, v20
    v_mul_f32_e32 v23, v23, v21
    v_mfma_f32_32x32x16_bf16 v[32:47], a[188:191], v[164:167], v[32:47]
    s_waitcnt lgkmcnt(4)
    ds_read_b64_tr_b16 a[180:181], v6 offset:21504
    ds_read_b64_tr_b16 a[182:183], v6 offset:22016
    v_cvt_pk_bf16_f32 v26, v22, v23
    v_mul_f32_e64 v20, v54, v54
    v_mul_f32_e32 v21, v55, v55
    v_fma_f32 v20, v20, v3, v2
    v_mfma_f32_32x32x16_bf16 v[32:47], a[192:195], v[168:171], v[32:47]
    s_waitcnt lgkmcnt(4)
    ds_read_b64_tr_b16 a[184:185], v6 offset:22528
    ds_read_b64_tr_b16 a[186:187], v6 offset:23040
    v_fma_f32 v21, v21, v3, v2
    v_mul_f32_e64 v20, v54, v20
    v_mul_f32_e32 v21, v55, v21
    v_mfma_f32_32x32x16_bf16 v[32:47], a[196:199], v[172:175], v[32:47]
    s_waitcnt lgkmcnt(4)
    ds_read_b64_tr_b16 a[188:189], v6 offset:23552
    ds_read_b64_tr_b16 a[190:191], v6 offset:24064
    v_exp_f32_e32 v20, v20
    v_exp_f32_e32 v21, v21
    v_add_u32_e32 v9, 0x10000, v7
    v_mfma_f32_32x32x16_bf16 v[32:47], a[176:179], v[176:179], v[32:47]
    s_waitcnt lgkmcnt(4)
    ds_read_b64_tr_b16 a[192:193], v9 offset:49152
    ds_read_b64_tr_b16 a[194:195], v9 offset:49664
    v_mul_f32_e32 v22, v54, v62
    v_mul_f32_e64 v23, v55, v63
    v_fma_f32 v20, v20, v4, v4
    v_fma_f32 v21, v21, v4, v4
    v_mfma_f32_32x32x16_bf16 v[32:47], a[180:183], v[180:183], v[32:47]
    s_waitcnt lgkmcnt(4)
    ds_read_b64_tr_b16 a[196:197], v9 offset:50176
    ds_read_b64_tr_b16 a[198:199], v9 offset:50688
    v_rcp_f32_e32 v20, v20
    v_rcp_f32_e32 v21, v21
    v_mfma_f32_32x32x16_bf16 v[32:47], a[184:187], v[184:187], v[32:47]
    s_waitcnt lgkmcnt(4)
    ds_read_b64_tr_b16 a[176:177], v9 offset:51200
    ds_read_b64_tr_b16 a[178:179], v9 offset:51712
    v_mul_f32_e64 v22, v22, v20
    v_mul_f32_e32 v23, v23, v21
    v_cvt_pk_bf16_f32 v27, v22, v23
    s_add_u32 s82, s77, 0xc00
    v_mfma_f32_32x32x16_bf16 v[32:47], a[188:191], v[188:191], v[32:47]
    s_waitcnt lgkmcnt(4)
    buffer_store_dwordx4 v[24:27], v1, s[44:47], s82 offen sc1
    ds_read_b64_tr_b16 a[180:181], v9 offset:52224
    ds_read_b64_tr_b16 a[182:183], v9 offset:52736
    v_mfma_f32_32x32x16_bf16 v[48:63], a[192:195], v[64:67], 0
    s_waitcnt lgkmcnt(4)
    ds_read_b64_tr_b16 a[184:185], v9 offset:53248
    ds_read_b64_tr_b16 a[186:187], v9 offset:53760
    v_mfma_f32_32x32x16_bf16 v[48:63], a[196:199], v[68:71], v[48:63]
    s_waitcnt lgkmcnt(4)
    ds_read_b64_tr_b16 a[188:189], v9 offset:54272
    ds_read_b64_tr_b16 a[190:191], v9 offset:54784
    v_mfma_f32_32x32x16_bf16 v[48:63], a[176:179], v[72:75], v[48:63]
    s_waitcnt lgkmcnt(4)
    ds_read_b64_tr_b16 a[192:193], v9 offset:55296
    ds_read_b64_tr_b16 a[194:195], v9 offset:55808
    v_mfma_f32_32x32x16_bf16 v[48:63], a[180:183], v[76:79], v[48:63]
    s_waitcnt lgkmcnt(4)
    s_add_u32 m0, s74, 0xc000
    s_add_u32 s81, s75, 0x100
    buffer_load_dwordx4 v10, s[28:31], s81 offen offset:0 lds
    ds_read_b64_tr_b16 a[196:197], v9 offset:56320
    ds_read_b64_tr_b16 a[198:199], v9 offset:56832
    v_add_u32_e32 v239, 0x20000, v7
    v_mfma_f32_32x32x16_bf16 v[48:63], a[184:187], v[80:83], v[48:63]
    s_waitcnt lgkmcnt(4)
    ds_read_b64_tr_b16 a[176:177], v239 offset:16384
    ds_read_b64_tr_b16 a[178:179], v239 offset:16896
    v_mul_f32_e32 v20, v32, v32
    v_mul_f32_e64 v21, v33, v33
    v_fma_f32 v20, v20, v3, v2
    v_fma_f32 v21, v21, v3, v2
    v_mfma_f32_32x32x16_bf16 v[48:63], a[188:191], v[84:87], v[48:63]
    s_waitcnt lgkmcnt(4)
    buffer_load_dwordx4 v11, s[28:31], s81 offen offset:1024 lds
    ds_read_b64_tr_b16 a[180:181], v239 offset:17408
    ds_read_b64_tr_b16 a[182:183], v239 offset:17920
    v_mul_f32_e32 v20, v32, v20
    v_mul_f32_e32 v21, v33, v21
    v_mfma_f32_32x32x16_bf16 v[48:63], a[192:195], v[88:91], v[48:63]
    s_waitcnt lgkmcnt(4)
    ds_read_b64_tr_b16 a[184:185], v239 offset:18432
    ds_read_b64_tr_b16 a[186:187], v239 offset:18944
    v_exp_f32_e64 v20, v20
    v_exp_f32_e32 v21, v21
    v_mfma_f32_32x32x16_bf16 v[48:63], a[196:199], v[92:95], v[48:63]
    s_waitcnt lgkmcnt(4)
    buffer_load_dwordx4 v12, s[28:31], s81 offen offset:2048 lds
    ds_read_b64_tr_b16 a[188:189], v239 offset:19456
    ds_read_b64_tr_b16 a[190:191], v239 offset:19968
    v_mul_f32_e32 v22, v32, v40
    v_mfma_f32_32x32x16_bf16 v[48:63], a[176:179], v[96:99], v[48:63]
    s_waitcnt lgkmcnt(4)
    ds_read_b64_tr_b16 a[192:193], v239 offset:20480
    ds_read_b64_tr_b16 a[194:195], v239 offset:20992
    v_mul_f32_e64 v23, v33, v41
    v_fma_f32 v20, v20, v4, v4
    v_fma_f32 v21, v21, v4, v4
    v_mfma_f32_32x32x16_bf16 v[48:63], a[180:183], v[100:103], v[48:63]
    s_waitcnt lgkmcnt(4)
    buffer_load_dwordx4 v13, s[28:31], s81 offen offset:3072 lds
    ds_read_b64_tr_b16 a[196:197], v239 offset:21504
    ds_read_b64_tr_b16 a[198:199], v239 offset:22016
    v_mfma_f32_32x32x16_bf16 v[48:63], a[184:187], v[104:107], v[48:63]
    s_waitcnt lgkmcnt(4)
    ds_read_b64_tr_b16 a[176:177], v239 offset:22528
    ds_read_b64_tr_b16 a[178:179], v239 offset:23040
    v_rcp_f32_e32 v20, v20
    v_rcp_f32_e32 v21, v21
    v_mul_f32_e32 v22, v22, v20
    v_mfma_f32_32x32x16_bf16 v[48:63], a[188:191], v[108:111], v[48:63]
    s_waitcnt lgkmcnt(4)
    s_add_u32 m0, s74, 0x14000
    s_add_u32 s81, s75, 0x70100
    buffer_load_dwordx4 v10, s[28:31], s81 offen offset:0 lds
    ds_read_b64_tr_b16 a[180:181], v239 offset:23552
    ds_read_b64_tr_b16 a[182:183], v239 offset:24064
    v_mfma_f32_32x32x16_bf16 v[48:63], a[192:195], v[112:115], v[48:63]
    s_waitcnt lgkmcnt(4)
    ds_read_b64_tr_b16 a[184:185], v7 offset:0
    ds_read_b64_tr_b16 a[186:187], v7 offset:512
    v_mul_f32_e32 v23, v23, v21
    v_cvt_pk_bf16_f32 v24, v22, v23
    v_mul_f32_e64 v20, v34, v34
    v_mul_f32_e32 v21, v35, v35
    v_mfma_f32_32x32x16_bf16 v[48:63], a[196:199], v[116:119], v[48:63]
    s_waitcnt lgkmcnt(4)
    buffer_load_dwordx4 v11, s[28:31], s81 offen offset:1024 lds
    ds_read_b64_tr_b16 a[188:189], v7 offset:1024
    ds_read_b64_tr_b16 a[190:191], v7 offset:1536
    v_fma_f32 v20, v20, v3, v2
    v_mfma_f32_32x32x16_bf16 v[48:63], a[176:179], v[120:123], v[48:63]
    s_waitcnt lgkmcnt(4)
    ds_read_b64_tr_b16 a[192:193], v7 offset:2048
    ds_read_b64_tr_b16 a[194:195], v7 offset:2560
    v_fma_f32 v21, v21, v3, v2
    v_mul_f32_e32 v20, v34, v20
    v_mul_f32_e64 v21, v35, v21
    v_exp_f32_e32 v20, v20
    v_mfma_f32_32x32x16_bf16 v[48:63], a[180:183], v[124:127], v[48:63]
    s_waitcnt lgkmcnt(4)
    buffer_load_dwordx4 v12, s[28:31], s81 offen offset:2048 lds
    ds_read_b64_tr_b16 a[196:197], v7 offset:3072
    ds_read_b64_tr_b16 a[198:199], v7 offset:3584
    v_exp_f32_e32 v21, v21
    v_mfma_f32_32x32x16_bf16 v[48:63], a[184:187], v[128:131], v[48:63]
    s_waitcnt lgkmcnt(4)
    ds_read_b64_tr_b16 a[176:177], v7 offset:4096
    ds_read_b64_tr_b16 a[178:179], v7 offset:4608
    v_mul_f32_e32 v22, v34, v42
    v_mul_f32_e32 v23, v35, v43
    v_fma_f32 v20, v20, v4, v4
    v_fma_f32 v21, v21, v4, v4
    v_mfma_f32_32x32x16_bf16 v[48:63], a[188:191], v[132:135], v[48:63]
    s_waitcnt lgkmcnt(4)
    buffer_load_dwordx4 v13, s[28:31], s81 offen offset:3072 lds
    ds_read_b64_tr_b16 a[180:181], v7 offset:5120
    ds_read_b64_tr_b16 a[182:183], v7 offset:5632
    v_mfma_f32_32x32x16_bf16 v[48:63], a[192:195], v[136:139], v[48:63]
    s_waitcnt lgkmcnt(4)
    ds_read_b64_tr_b16 a[184:185], v7 offset:6144
    ds_read_b64_tr_b16 a[186:187], v7 offset:6656
    v_rcp_f32_e64 v20, v20
    v_rcp_f32_e32 v21, v21
    v_mfma_f32_32x32x16_bf16 v[48:63], a[196:199], v[140:143], v[48:63]
    s_waitcnt lgkmcnt(4)
    ds_read_b64_tr_b16 a[188:189], v7 offset:7168
    ds_read_b64_tr_b16 a[190:191], v7 offset:7680
    v_mul_f32_e32 v22, v22, v20
    v_mul_f32_e32 v23, v23, v21
    v_cvt_pk_bf16_f32 v25, v22, v23
    v_mul_f32_e64 v20, v36, v36
    v_mul_f32_e32 v21, v37, v37
    v_mfma_f32_32x32x16_bf16 v[48:63], a[176:179], v[144:147], v[48:63]
    s_waitcnt lgkmcnt(4)
    ds_read_b64_tr_b16 a[192:193], v7 offset:16384
    ds_read_b64_tr_b16 a[194:195], v7 offset:16896
    v_fma_f32 v20, v20, v3, v2
    v_fma_f32 v21, v21, v3, v2
    v_mul_f32_e64 v20, v36, v20
    v_mul_f32_e32 v21, v37, v21
    v_mfma_f32_32x32x16_bf16 v[48:63], a[180:183], v[148:151], v[48:63]
    s_waitcnt lgkmcnt(4)
    ds_read_b64_tr_b16 a[196:197], v7 offset:17408
    ds_read_b64_tr_b16 a[198:199], v7 offset:17920
    v_exp_f32_e64 v20, v20
    v_exp_f32_e32 v21, v21
    v_mfma_f32_32x32x16_bf16 v[48:63], a[184:187], v[152:155], v[48:63]
    s_waitcnt lgkmcnt(4)
    ds_read_b64_tr_b16 a[176:177], v7 offset:18432
    ds_read_b64_tr_b16 a[178:179], v7 offset:18944
    v_mul_f32_e32 v22, v36, v44
    v_mul_f32_e32 v23, v37, v45
    v_fma_f32 v20, v20, v4, v4
    v_fma_f32 v21, v21, v4, v4
    v_mfma_f32_32x32x16_bf16 v[48:63], a[188:191], v[156:159], v[48:63]
    s_waitcnt lgkmcnt(4)
    ds_read_b64_tr_b16 a[180:181], v7 offset:19456
    ds_read_b64_tr_b16 a[182:183], v7 offset:19968
    v_rcp_f32_e32 v20, v20
    v_rcp_f32_e64 v21, v21
    v_mul_f32_e32 v22, v22, v20
    v_mfma_f32_32x32x16_bf16 v[48:63], a[192:195], v[160:163], v[48:63]
    s_waitcnt lgkmcnt(4)
    ds_read_b64_tr_b16 a[184:185], v7 offset:20480
    ds_read_b64_tr_b16 a[186:187], v7 offset:20992
    v_mul_f32_e64 v23, v23, v21
    v_cvt_pk_bf16_f32 v26, v22, v23
    v_mul_f32_e64 v20, v38, v38
    v_mul_f32_e32 v21, v39, v39
    v_fma_f32 v20, v20, v3, v2
    v_mfma_f32_32x32x16_bf16 v[48:63], a[196:199], v[164:167], v[48:63]
    s_waitcnt lgkmcnt(4)
    ds_read_b64_tr_b16 a[188:189], v7 offset:21504
    ds_read_b64_tr_b16 a[190:191], v7 offset:22016
    v_fma_f32 v21, v21, v3, v2
    v_mul_f32_e64 v20, v38, v20
    v_mul_f32_e32 v21, v39, v21
    v_mfma_f32_32x32x16_bf16 v[48:63], a[176:179], v[168:171], v[48:63]
    s_waitcnt lgkmcnt(4)
    ds_read_b64_tr_b16 a[192:193], v7 offset:22528
    ds_read_b64_tr_b16 a[194:195], v7 offset:23040
    v_exp_f32_e64 v20, v20
    v_exp_f32_e32 v21, v21
    v_mfma_f32_32x32x16_bf16 v[48:63], a[180:183], v[172:175], v[48:63]
    s_waitcnt lgkmcnt(4)
    ds_read_b64_tr_b16 a[196:197], v7 offset:23552
    ds_read_b64_tr_b16 a[198:199], v7 offset:24064
    v_mul_f32_e32 v22, v38, v46
    v_mul_f32_e32 v23, v39, v47
    v_fma_f32 v20, v20, v4, v4
    v_fma_f32 v21, v21, v4, v4
    v_mfma_f32_32x32x16_bf16 v[48:63], a[184:187], v[176:179], v[48:63]
    s_waitcnt lgkmcnt(4)
    v_rcp_f32_e32 v20, v20
    v_rcp_f32_e32 v21, v21
    v_mul_f32_e32 v22, v22, v20
    v_mfma_f32_32x32x16_bf16 v[48:63], a[188:191], v[180:183], v[48:63]
    s_waitcnt vmcnt(10) lgkmcnt(0)
    s_barrier
    ds_read_b64_tr_b16 a[176:177], v6 offset:32768
    ds_read_b64_tr_b16 a[178:179], v6 offset:33280
    ds_read_b64_tr_b16 a[180:181], v6 offset:33792
    ds_read_b64_tr_b16 a[182:183], v6 offset:34304
    v_mul_f32_e64 v23, v23, v21
    v_cvt_pk_bf16_f32 v27, v22, v23
    s_add_u32 s82, s77, 0x1000
    v_mfma_f32_32x32x16_bf16 v[48:63], a[192:195], v[184:187], v[48:63]
    buffer_store_dwordx4 v[24:27], v1, s[44:47], s82 offen sc1
    ds_read_b64_tr_b16 a[184:185], v6 offset:34816
    ds_read_b64_tr_b16 a[186:187], v6 offset:35328
    v_mfma_f32_32x32x16_bf16 v[48:63], a[196:199], v[188:191], v[48:63]
    s_waitcnt lgkmcnt(4)
    ds_read_b64_tr_b16 a[188:189], v6 offset:35840
    ds_read_b64_tr_b16 a[190:191], v6 offset:36352
    v_mfma_f32_32x32x16_bf16 v[32:47], a[176:179], v[64:67], 0
    s_waitcnt lgkmcnt(4)
    ds_read_b64_tr_b16 a[192:193], v6 offset:36864
    ds_read_b64_tr_b16 a[194:195], v6 offset:37376
    v_mfma_f32_32x32x16_bf16 v[32:47], a[180:183], v[68:71], v[32:47]
    s_waitcnt lgkmcnt(4)
    ds_read_b64_tr_b16 a[196:197], v6 offset:37888
    ds_read_b64_tr_b16 a[198:199], v6 offset:38400
    v_readfirstlane_b32 s67, v253
    s_nop 1
    s_cmp_eq_u32 s67, 0
    s_cbranch_scc1 L_nslow_19
L_nback_20:
    v_mfma_f32_32x32x16_bf16 v[32:47], a[184:187], v[72:75], v[32:47]
    s_waitcnt lgkmcnt(4)
    s_add_u32 m0, s74, 0x1c000
    s_add_u32 s81, s75, 0xe0100
    buffer_load_dwordx4 v10, s[28:31], s81 offen offset:0 lds
    ds_read_b64_tr_b16 a[176:177], v6 offset:38912
    ds_read_b64_tr_b16 a[178:179], v6 offset:39424
    v_mfma_f32_32x32x16_bf16 v[32:47], a[188:191], v[76:79], v[32:47]
    s_waitcnt lgkmcnt(4)
    ds_read_b64_tr_b16 a[180:181], v6 offset:39936
    ds_read_b64_tr_b16 a[182:183], v6 offset:40448
    v_mul_f32_e32 v20, v48, v48
    v_mul_f32_e64 v21, v49, v49
    v_fma_f32 v20, v20, v3, v2
    v_fma_f32 v21, v21, v3, v2
    v_add_u32_e32 v9, 0x10000, v6
    v_mfma_f32_32x32x16_bf16 v[32:47], a[192:195], v[80:83], v[32:47]
    s_waitcnt lgkmcnt(4)
    buffer_load_dwordx4 v11, s[28:31], s81 offen offset:1024 lds
    ds_read_b64_tr_b16 a[184:185], v9 offset:0
    ds_read_b64_tr_b16 a[186:187], v9 offset:512
    v_mul_f32_e32 v20, v48, v20
    v_mfma_f32_32x32x16_bf16 v[32:47], a[196:199], v[84:87], v[32:47]
    s_waitcnt lgkmcnt(4)
    ds_read_b64_tr_b16 a[188:189], v9 offset:1024
    ds_read_b64_tr_b16 a[190:191], v9 offset:1536
    v_mul_f32_e32 v21, v49, v21
    v_exp_f32_e64 v20, v20
    v_exp_f32_e32 v21, v21
    v_mfma_f32_32x32x16_bf16 v[32:47], a[176:179], v[88:91], v[32:47]
    s_waitcnt lgkmcnt(4)
    buffer_load_dwordx4 v12, s[28:31], s81 offen offset:2048 lds
    ds_read_b64_tr_b16 a[192:193], v9 offset:2048
    ds_read_b64_tr_b16 a[194:195], v9 offset:2560
    v_mul_f32_e32 v22, v48, v56
    v_mfma_f32_32x32x16_bf16 v[32:47], a[180:183], v[92:95], v[32:47]
    s_waitcnt lgkmcnt(4)
    ds_read_b64_tr_b16 a[196:197], v9 offset:3072
    ds_read_b64_tr_b16 a[198:199], v9 offset:3584
    v_mul_f32_e64 v23, v49, v57
    v_fma_f32 v20, v20, v4, v4
    v_fma_f32 v21, v21, v4, v4
    v_mfma_f32_32x32x16_bf16 v[32:47], a[184:187], v[96:99], v[32:47]
    s_waitcnt lgkmcnt(4)
    buffer_load_dwordx4 v13, s[28:31], s81 offen offset:3072 lds
    ds_read_b64_tr_b16 a[176:177], v9 offset:4096
    ds_read_b64_tr_b16 a[178:179], v9 offset:4608
    v_mfma_f32_32x32x16_bf16 v[32:47], a[188:191], v[100:103], v[32:47]
    s_waitcnt lgkmcnt(4)
    ds_read_b64_tr_b16 a[180:181], v9 offset:5120
    ds_read_b64_tr_b16 a[182:183], v9 offset:5632
    v_rcp_f32_e64 v20, v20
    v_rcp_f32_e32 v21, v21
    v_mfma_f32_32x32x16_bf16 v[32:47], a[192:195], v[104:107], v[32:47]
    s_waitcnt lgkmcnt(4)
    s_add_u32 m0, s74, 0x24000
    s_add_u32 s81, s75, 0x150100
    buffer_load_dwordx4 v10, s[28:31], s81 offen offset:0 lds
    ds_read_b64_tr_b16 a[184:185], v9 offset:6144
    ds_read_b64_tr_b16 a[186:187], v9 offset:6656
    v_mfma_f32_32x32x16_bf16 v[32:47], a[196:199], v[108:111], v[32:47]
    s_waitcnt lgkmcnt(4)
    ds_read_b64_tr_b16 a[188:189], v9 offset:7168
    ds_read_b64_tr_b16 a[190:191], v9 offset:7680
    v_mul_f32_e32 v22, v22, v20
    v_mul_f32_e64 v23, v23, v21
    v_cvt_pk_bf16_f32 v24, v22, v23
    v_mul_f32_e32 v20, v50, v50
    v_mfma_f32_32x32x16_bf16 v[32:47], a[176:179], v[112:115], v[32:47]
    s_waitcnt lgkmcnt(4)
    buffer_load_dwordx4 v11, s[28:31], s81 offen offset:1024 lds
    ds_read_b64_tr_b16 a[192:193], v9 offset:32768
    ds_read_b64_tr_b16 a[194:195], v9 offset:33280
    v_mul_f32_e32 v21, v51, v51
    v_mfma_f32_32x32x16_bf16 v[32:47], a[180:183], v[116:119], v[32:47]
    s_waitcnt lgkmcnt(4)
    ds_read_b64_tr_b16 a[196:197], v9 offset:33792
    ds_read_b64_tr_b16 a[198:199], v9 offset:34304
    v_fma_f32 v20, v20, v3, v2
    v_fma_f32 v21, v21, v3, v2
    v_mul_f32_e64 v20, v50, v20
    v_mul_f32_e32 v21, v51, v21
    v_mfma_f32_32x32x16_bf16 v[32:47], a[184:187], v[120:123], v[32:47]
    s_waitcnt lgkmcnt(4)
    buffer_load_dwordx4 v12, s[28:31], s81 offen offset:2048 lds
    ds_read_b64_tr_b16 a[176:177], v9 offset:34816
    ds_read_b64_tr_b16 a[178:179], v9 offset:35328
    v_exp_f32_e32 v20, v20
    v_mfma_f32_32x32x16_bf16 v[32:47], a[188:191], v[124:127], v[32:47]
    s_waitcnt lgkmcnt(4)
    ds_read_b64_tr_b16 a[180:181], v9 offset:35840
    ds_read_b64_tr_b16 a[182:183], v9 offset:36352
    v_exp_f32_e32 v21, v21
    v_mul_f32_e32 v22, v50, v58
    v_mul_f32_e32 v23, v51, v59
    v_mfma_f32_32x32x16_bf16 v[32:47], a[192:195], v[128:131], v[32:47]
    s_waitcnt lgkmcnt(4)
    buffer_load_dwordx4 v13, s[28:31], s81 offen offset:3072 lds
    ds_read_b64_tr_b16 a[184:185], v9 offset:36864
    ds_read_b64_tr_b16 a[186:187], v9 offset:37376
    v_fma_f32 v20, v20, v4, v4
    v_mfma_f32_32x32x16_bf16 v[32:47], a[196:199], v[132:135], v[32:47]
    s_waitcnt lgkmcnt(4)
    ds_read_b64_tr_b16 a[188:189], v9 offset:37888
    ds_read_b64_tr_b16 a[190:191], v9 offset:38400
    v_fma_f32 v21, v21, v4, v4
    v_rcp_f32_e32 v20, v20
    s_waitcnt vmcnt(8)
    v_mfma_f32_32x32x16_bf16 v[32:47], a[176:179], v[136:139], v[32:47]
    s_waitcnt lgkmcnt(4)
    buffer_load_dword v238, v30, s[40:43], s15 offen
    ds_read_b64_tr_b16 a[192:193], v9 offset:38912
    ds_read_b64_tr_b16 a[194:195], v9 offset:39424
    v_mfma_f32_32x32x16_bf16 v[32:47], a[180:183], v[140:143], v[32:47]
    s_waitcnt lgkmcnt(4)
    ds_read_b64_tr_b16 a[196:197], v9 offset:39936
    ds_read_b64_tr_b16 a[198:199], v9 offset:40448
    v_rcp_f32_e32 v21, v21
    v_mul_f32_e32 v22, v22, v20
    v_mul_f32_e32 v23, v23, v21
    v_cvt_pk_bf16_f32 v25, v22, v23
    v_add_u32_e32 v239, 0x20000, v6
    v_mfma_f32_32x32x16_bf16 v[32:47], a[184:187], v[144:147], v[32:47]
    s_waitcnt lgkmcnt(4)
    ds_read_b64_tr_b16 a[176:177], v239 offset:0
    ds_read_b64_tr_b16 a[178:179], v239 offset:512
    v_mul_f32_e32 v20, v52, v52
    v_mul_f32_e64 v21, v53, v53
    v_fma_f32 v20, v20, v3, v2
    v_fma_f32 v21, v21, v3, v2
    v_mfma_f32_32x32x16_bf16 v[32:47], a[188:191], v[148:151], v[32:47]
    s_waitcnt lgkmcnt(4)
    ds_read_b64_tr_b16 a[180:181], v239 offset:1024
    ds_read_b64_tr_b16 a[182:183], v239 offset:1536
    v_mul_f32_e32 v20, v52, v20
    v_mul_f32_e64 v21, v53, v21
    v_exp_f32_e32 v20, v20
    v_mfma_f32_32x32x16_bf16 v[32:47], a[192:195], v[152:155], v[32:47]
    s_waitcnt lgkmcnt(4)
    ds_read_b64_tr_b16 a[184:185], v239 offset:2048
    ds_read_b64_tr_b16 a[186:187], v239 offset:2560
    v_exp_f32_e32 v21, v21
    v_mul_f32_e32 v22, v52, v60
    v_mul_f32_e32 v23, v53, v61
    v_mfma_f32_32x32x16_bf16 v[32:47], a[196:199], v[156:159], v[32:47]
    s_waitcnt lgkmcnt(4)
    ds_read_b64_tr_b16 a[188:189], v239 offset:3072
    ds_read_b64_tr_b16 a[190:191], v239 offset:3584
    v_fma_f32 v20, v20, v4, v4
    v_fma_f32 v21, v21, v4, v4
    v_rcp_f32_e32 v20, v20
    v_mfma_f32_32x32x16_bf16 v[32:47], a[176:179], v[160:163], v[32:47]
    s_waitcnt lgkmcnt(4)
    ds_read_b64_tr_b16 a[192:193], v239 offset:4096
    ds_read_b64_tr_b16 a[194:195], v239 offset:4608
    v_rcp_f32_e32 v21, v21
    v_mul_f32_e32 v22, v22, v20
    v_mul_f32_e32 v23, v23, v21
    v_mfma_f32_32x32x16_bf16 v[32:47], a[180:183], v[164:167], v[32:47]
    s_waitcnt lgkmcnt(4)
    ds_read_b64_tr_b16 a[196:197], v239 offset:5120
    ds_read_b64_tr_b16 a[198:199], v239 offset:5632
    v_cvt_pk_bf16_f32 v26, v22, v23
    v_mul_f32_e64 v20, v54, v54
    v_mul_f32_e32 v21, v55, v55
    v_fma_f32 v20, v20, v3, v2
    v_mfma_f32_32x32x16_bf16 v[32:47], a[184:187], v[168:171], v[32:47]
    s_waitcnt lgkmcnt(4)
    ds_read_b64_tr_b16 a[176:177], v239 offset:6144
    ds_read_b64_tr_b16 a[178:179], v239 offset:6656
    v_fma_f32 v21, v21, v3, v2
    v_mul_f32_e64 v20, v54, v20
    v_mul_f32_e32 v21, v55, v21
    v_mfma_f32_32x32x16_bf16 v[32:47], a[188:191], v[172:175], v[32:47]
    s_waitcnt lgkmcnt(4)
    ds_read_b64_tr_b16 a[180:181], v239 offset:7168
    ds_read_b64_tr_b16 a[182:183], v239 offset:7680
    v_exp_f32_e64 v20, v20
    v_exp_f32_e32 v21, v21
    v_mfma_f32_32x32x16_bf16 v[32:47], a[192:195], v[176:179], v[32:47]
    s_waitcnt lgkmcnt(4)
    ds_read_b64_tr_b16 a[184:185], v7 offset:32768
    ds_read_b64_tr_b16 a[186:187], v7 offset:33280
    v_mul_f32_e32 v22, v54, v62
    v_mul_f32_e32 v23, v55, v63
    v_fma_f32 v20, v20, v4, v4
    v_fma_f32 v21, v21, v4, v4
    v_mfma_f32_32x32x16_bf16 v[32:47], a[196:199], v[180:183], v[32:47]
    s_waitcnt lgkmcnt(4)
    ds_read_b64_tr_b16 a[188:189], v7 offset:33792
    ds_read_b64_tr_b16 a[190:191], v7 offset:34304
    v_rcp_f32_e32 v20, v20
    v_rcp_f32_e32 v21, v21
    v_mfma_f32_32x32x16_bf16 v[32:47], a[176:179], v[184:187], v[32:47]
    s_waitcnt lgkmcnt(4)
    ds_read_b64_tr_b16 a[192:193], v7 offset:34816
    ds_read_b64_tr_b16 a[194:195], v7 offset:35328
    v_mul_f32_e32 v22, v22, v20
    v_mul_f32_e32 v23, v23, v21
    v_cvt_pk_bf16_f32 v27, v22, v23
    s_add_u32 s82, s77, 0x1400
    v_mfma_f32_32x32x16_bf16 v[32:47], a[180:183], v[188:191], v[32:47]
    s_waitcnt lgkmcnt(4)
    buffer_store_dwordx4 v[24:27], v1, s[44:47], s82 offen sc1
    ds_read_b64_tr_b16 a[196:197], v7 offset:35840
    ds_read_b64_tr_b16 a[198:199], v7 offset:36352
    v_mfma_f32_32x32x16_bf16 v[48:63], a[184:187], v[64:67], 0
    s_waitcnt lgkmcnt(4)
    ds_read_b64_tr_b16 a[176:177], v7 offset:36864
    ds_read_b64_tr_b16 a[178:179], v7 offset:37376
    s_lshl_b32 s69, s60, 1
    s_add_u32 s69, s69, s57
    s_lshl_b32 s90, s62, 8
    s_lshl_b32 s69, s69, 2
    s_add_u32 s90, s90, s69
    s_add_u32 s90, s90, 0x1000
    v_mfma_f32_32x32x16_bf16 v[48:63], a[188:191], v[68:71], v[48:63]
    s_waitcnt lgkmcnt(4)
    ds_read_b64_tr_b16 a[180:181], v7 offset:37888
    ds_read_b64_tr_b16 a[182:183], v7 offset:38400
    v_mfma_f32_32x32x16_bf16 v[48:63], a[192:195], v[72:75], v[48:63]
    s_waitcnt lgkmcnt(4)
    ds_read_b64_tr_b16 a[184:185], v7 offset:38912
    ds_read_b64_tr_b16 a[186:187], v7 offset:39424
    v_mfma_f32_32x32x16_bf16 v[48:63], a[196:199], v[76:79], v[48:63]
    s_waitcnt lgkmcnt(4)
    buffer_store_dword v253, v18, s[44:47], s90 offen sc1
    ds_read_b64_tr_b16 a[188:189], v7 offset:39936
    ds_read_b64_tr_b16 a[190:191], v7 offset:40448
    v_mul_f32_e64 v20, v32, v32
    v_add_u32_e32 v9, 0x10000, v7
    v_mfma_f32_32x32x16_bf16 v[48:63], a[176:179], v[80:83], v[48:63]
    s_waitcnt lgkmcnt(4)
    s_add_u32 m0, s83, 0x0
    s_add_u32 s81, s84, 0x0
    buffer_load_dwordx4 v252, s[36:39], s81 offen lds
    ds_read_b64_tr_b16 a[192:193], v9 offset:0
    ds_read_b64_tr_b16 a[194:195], v9 offset:512
    v_mfma_f32_32x32x16_bf16 v[48:63], a[180:183], v[84:87], v[48:63]
    s_waitcnt lgkmcnt(4)
    ds_read_b64_tr_b16 a[196:197], v9 offset:1024
    ds_read_b64_tr_b16 a[198:199], v9 offset:1536
    v_mul_f32_e64 v21, v33, v33
    v_fma_f32 v20, v20, v3, v2
    v_fma_f32 v21, v21, v3, v2
    v_mul_f32_e64 v20, v32, v20
    v_mul_f32_e32 v21, v33, v21
    v_mfma_f32_32x32x16_bf16 v[48:63], a[184:187], v[88:91], v[48:63]
    s_waitcnt lgkmcnt(4)
    s_add_u32 m0, s83, 0x800
    s_add_u32 s81, s84, 0x4000
    buffer_load_dwordx4 v252, s[36:39], s81 offen lds
    ds_read_b64_tr_b16 a[176:177], v9 offset:2048
    ds_read_b64_tr_b16 a[178:179], v9 offset:2560
    v_mfma_f32_32x32x16_bf16 v[48:63], a[188:191], v[92:95], v[48:63]
    s_waitcnt lgkmcnt(4)
    ds_read_b64_tr_b16 a[180:181], v9 offset:3072
    ds_read_b64_tr_b16 a[182:183], v9 offset:3584
    v_exp_f32_e32 v20, v20
    v_exp_f32_e64 v21, v21
    v_mul_f32_e32 v22, v32, v40
    v_mfma_f32_32x32x16_bf16 v[48:63], a[192:195], v[96:99], v[48:63]
    s_waitcnt lgkmcnt(4)
    s_add_u32 m0, s83, 0x1000
    s_add_u32 s81, s84, 0x8000
    buffer_load_dwordx4 v252, s[36:39], s81 offen lds
    ds_read_b64_tr_b16 a[184:185], v9 offset:4096
    ds_read_b64_tr_b16 a[186:187], v9 offset:4608
    v_mfma_f32_32x32x16_bf16 v[48:63], a[196:199], v[100:103], v[48:63]
    s_waitcnt lgkmcnt(4)
    ds_read_b64_tr_b16 a[188:189], v9 offset:5120
    ds_read_b64_tr_b16 a[190:191], v9 offset:5632
    v_mul_f32_e32 v23, v33, v41
    v_fma_f32 v20, v20, v4, v4
    v_fma_f32 v21, v21, v4, v4
    v_mfma_f32_32x32x16_bf16 v[48:63], a[176:179], v[104:107], v[48:63]
    s_waitcnt lgkmcnt(4)
    s_add_u32 m0, s83, 0x1800
    s_add_u32 s81, s84, 0xc000
    buffer_load_dwordx4 v252, s[36:39], s81 offen lds
    ds_read_b64_tr_b16 a[192:193], v9 offset:6144
    ds_read_b64_tr_b16 a[194:195], v9 offset:6656
    v_mfma_f32_32x32x16_bf16 v[48:63], a[180:183], v[108:111], v[48:63]
    s_waitcnt lgkmcnt(4)
    ds_read_b64_tr_b16 a[196:197], v9 offset:7168
    ds_read_b64_tr_b16 a[198:199], v9 offset:7680
    v_rcp_f32_e32 v20, v20
    v_rcp_f32_e32 v21, v21
    v_mul_f32_e32 v22, v22, v20
    v_mfma_f32_32x32x16_bf16 v[48:63], a[184:187], v[112:115], v[48:63]
    s_waitcnt lgkmcnt(4)
    s_add_u32 m0, s83, 0x4000
    s_add_u32 s81, s84, 0x10000
    buffer_load_dwordx4 v252, s[36:39], s81 offen lds
    ds_read_b64_tr_b16 a[176:177], v9 offset:32768
    ds_read_b64_tr_b16 a[178:179], v9 offset:33280
    v_mfma_f32_32x32x16_bf16 v[48:63], a[188:191], v[116:119], v[48:63]
    s_waitcnt lgkmcnt(4)
    ds_read_b64_tr_b16 a[180:181], v9 offset:33792
    ds_read_b64_tr_b16 a[182:183], v9 offset:34304
    v_mul_f32_e32 v23, v23, v21
    v_cvt_pk_bf16_f32 v24, v22, v23
    v_mul_f32_e32 v20, v34, v34
    v_mul_f32_e32 v21, v35, v35
    v_mfma_f32_32x32x16_bf16 v[48:63], a[192:195], v[120:123], v[48:63]
    s_waitcnt lgkmcnt(4)
    s_add_u32 m0, s83, 0x4800
    s_add_u32 s81, s84, 0x28000
    buffer_load_dwordx4 v252, s[36:39], s81 offen lds
    ds_read_b64_tr_b16 a[184:185], v9 offset:34816
    ds_read_b64_tr_b16 a[186:187], v9 offset:35328
    v_mfma_f32_32x32x16_bf16 v[48:63], a[196:199], v[124:127], v[48:63]
    s_waitcnt lgkmcnt(4)
    ds_read_b64_tr_b16 a[188:189], v9 offset:35840
    ds_read_b64_tr_b16 a[190:191], v9 offset:36352
    v_fma_f32 v20, v20, v3, v2
    v_fma_f32 v21, v21, v3, v2
    v_mul_f32_e64 v20, v34, v20
    v_mul_f32_e32 v21, v35, v21
    v_mfma_f32_32x32x16_bf16 v[48:63], a[176:179], v[128:131], v[48:63]
    s_waitcnt lgkmcnt(4)
    s_add_u32 m0, s83, 0x5000
    s_add_u32 s81, s84, 0x2c000
    buffer_load_dwordx4 v252, s[36:39], s81 offen lds
    ds_read_b64_tr_b16 a[192:193], v9 offset:36864
    ds_read_b64_tr_b16 a[194:195], v9 offset:37376
    v_mfma_f32_32x32x16_bf16 v[48:63], a[180:183], v[132:135], v[48:63]
    s_waitcnt lgkmcnt(4)
    ds_read_b64_tr_b16 a[196:197], v9 offset:37888
    ds_read_b64_tr_b16 a[198:199], v9 offset:38400
    v_exp_f32_e32 v20, v20
    v_exp_f32_e32 v21, v21
    v_mfma_f32_32x32x16_bf16 v[48:63], a[184:187], v[136:139], v[48:63]
    s_waitcnt lgkmcnt(4)
    s_add_u32 m0, s83, 0x5800
    s_add_u32 s81, s84, 0x30000
    buffer_load_dwordx4 v252, s[36:39], s81 offen lds
    ds_read_b64_tr_b16 a[176:177], v9 offset:38912
    ds_read_b64_tr_b16 a[178:179], v9 offset:39424
    v_mfma_f32_32x32x16_bf16 v[48:63], a[188:191], v[140:143], v[48:63]
    s_waitcnt lgkmcnt(4)
    ds_read_b64_tr_b16 a[180:181], v9 offset:39936
    ds_read_b64_tr_b16 a[182:183], v9 offset:40448
    v_mul_f32_e32 v22, v34, v42
    v_mul_f32_e64 v23, v35, v43
    v_fma_f32 v20, v20, v4, v4
    v_fma_f32 v21, v21, v4, v4
    v_add_u32_e32 v239, 0x20000, v7
    v_mfma_f32_32x32x16_bf16 v[48:63], a[192:195], v[144:147], v[48:63]
    s_waitcnt lgkmcnt(4)
    ds_read_b64_tr_b16 a[184:185], v239 offset:0
    ds_read_b64_tr_b16 a[186:187], v239 offset:512
    v_rcp_f32_e32 v20, v20
    v_rcp_f32_e64 v21, v21
    v_mul_f32_e32 v22, v22, v20
    v_mfma_f32_32x32x16_bf16 v[48:63], a[196:199], v[148:151], v[48:63]
    s_waitcnt lgkmcnt(4)
    ds_read_b64_tr_b16 a[188:189], v239 offset:1024
    ds_read_b64_tr_b16 a[190:191], v239 offset:1536
    v_mul_f32_e64 v23, v23, v21
    v_cvt_pk_bf16_f32 v25, v22, v23
    v_mul_f32_e64 v20, v36, v36
    v_mul_f32_e32 v21, v37, v37
    v_mfma_f32_32x32x16_bf16 v[48:63], a[176:179], v[152:155], v[48:63]
    s_waitcnt lgkmcnt(4)
    ds_read_b64_tr_b16 a[192:193], v239 offset:2048
    ds_read_b64_tr_b16 a[194:195], v239 offset:2560
    v_fma_f32 v20, v20, v3, v2
    v_fma_f32 v21, v21, v3, v2
    v_mul_f32_e64 v20, v36, v20
    v_mul_f32_e32 v21, v37, v21
    v_mfma_f32_32x32x16_bf16 v[48:63], a[180:183], v[156:159], v[48:63]
    s_waitcnt lgkmcnt(4)
    ds_read_b64_tr_b16 a[196:197], v239 offset:3072
    ds_read_b64_tr_b16 a[198:199], v239 offset:3584
    v_exp_f32_e32 v20, v20
    v_exp_f32_e32 v21, v21
    v_mul_f32_e32 v22, v36, v44
    v_mfma_f32_32x32x16_bf16 v[48:63], a[184:187], v[160:163], v[48:63]
    s_waitcnt lgkmcnt(4)
    ds_read_b64_tr_b16 a[176:177], v239 offset:4096
    ds_read_b64_tr_b16 a[178:179], v239 offset:4608
    v_mul_f32_e64 v23, v37, v45
    v_fma_f32 v20, v20, v4, v4
    v_fma_f32 v21, v21, v4, v4
    v_rcp_f32_e32 v20, v20
    v_mfma_f32_32x32x16_bf16 v[48:63], a[188:191], v[164:167], v[48:63]
    s_waitcnt lgkmcnt(4)
    ds_read_b64_tr_b16 a[180:181], v239 offset:5120
    ds_read_b64_tr_b16 a[182:183], v239 offset:5632
    v_rcp_f32_e32 v21, v21
    v_mul_f32_e32 v22, v22, v20
    v_mul_f32_e64 v23, v23, v21
    v_cvt_pk_bf16_f32 v26, v22, v23
    v_mfma_f32_32x32x16_bf16 v[48:63], a[192:195], v[168:171], v[48:63]
    s_waitcnt lgkmcnt(4)
    ds_read_b64_tr_b16 a[184:185], v239 offset:6144
    ds_read_b64_tr_b16 a[186:187], v239 offset:6656
    v_mul_f32_e32 v20, v38, v38
    v_mul_f32_e64 v21, v39, v39
    v_fma_f32 v20, v20, v3, v2
    v_fma_f32 v21, v21, v3, v2
    v_mfma_f32_32x32x16_bf16 v[48:63], a[196:199], v[172:175], v[48:63]
    s_waitcnt lgkmcnt(4)
    ds_read_b64_tr_b16 a[188:189], v239 offset:7168
    ds_read_b64_tr_b16 a[190:191], v239 offset:7680
    v_mul_f32_e32 v20, v38, v20
    v_mul_f32_e32 v21, v39, v21
    v_exp_f32_e32 v20, v20
    v_mfma_f32_32x32x16_bf16 v[48:63], a[176:179], v[176:179], v[48:63]
    s_waitcnt lgkmcnt(4)
    v_exp_f32_e32 v21, v21
    v_mul_f32_e32 v22, v38, v46
    v_mul_f32_e32 v23, v39, v47
    v_fma_f32 v20, v20, v4, v4
    v_mfma_f32_32x32x16_bf16 v[48:63], a[180:183], v[180:183], v[48:63]
    s_waitcnt vmcnt(11) lgkmcnt(0)
    s_barrier
    ds_read_b64_tr_b16 a[192:193], v6 offset:49152
    ds_read_b64_tr_b16 a[194:195], v6 offset:49664
    ds_read_b64_tr_b16 a[196:197], v6 offset:50176
    ds_read_b64_tr_b16 a[198:199], v6 offset:50688
    v_fma_f32 v21, v21, v4, v4
    v_rcp_f32_e32 v20, v20
    v_rcp_f32_e32 v21, v21
    v_mfma_f32_32x32x16_bf16 v[48:63], a[184:187], v[184:187], v[48:63]
    ds_read_b64_tr_b16 a[176:177], v6 offset:51200
    ds_read_b64_tr_b16 a[178:179], v6 offset:51712
    v_mul_f32_e64 v22, v22, v20
    v_mul_f32_e32 v23, v23, v21
    v_cvt_pk_bf16_f32 v27, v22, v23
    s_add_u32 s82, s77, 0x1800
    v_mfma_f32_32x32x16_bf16 v[48:63], a[188:191], v[188:191], v[48:63]
    s_waitcnt lgkmcnt(4)
    buffer_store_dwordx4 v[24:27], v1, s[44:47], s82 offen sc1
    ds_read_b64_tr_b16 a[180:181], v6 offset:52224
    ds_read_b64_tr_b16 a[182:183], v6 offset:52736
    v_mfma_f32_32x32x16_bf16 v[32:47], a[192:195], v[64:67], 0
    s_waitcnt lgkmcnt(4)
    ds_read_b64_tr_b16 a[184:185], v6 offset:53248
    ds_read_b64_tr_b16 a[186:187], v6 offset:53760
    v_mfma_f32_32x32x16_bf16 v[32:47], a[196:199], v[68:71], v[32:47]
    s_waitcnt lgkmcnt(4)
    ds_read_b64_tr_b16 a[188:189], v6 offset:54272
    ds_read_b64_tr_b16 a[190:191], v6 offset:54784
    v_mfma_f32_32x32x16_bf16 v[32:47], a[176:179], v[72:75], v[32:47]
    s_waitcnt lgkmcnt(4)
    ds_read_b64_tr_b16 a[192:193], v6 offset:55296
    ds_read_b64_tr_b16 a[194:195], v6 offset:55808
    v_mfma_f32_32x32x16_bf16 v[32:47], a[180:183], v[76:79], v[32:47]
    s_waitcnt lgkmcnt(4)
    s_add_u32 m0, s83, 0x8000
    s_add_u32 s81, s84, 0x34000
    buffer_load_dwordx4 v252, s[36:39], s81 offen lds
    ds_read_b64_tr_b16 a[196:197], v6 offset:56320
    ds_read_b64_tr_b16 a[198:199], v6 offset:56832
    v_add_u32_e32 v9, 0x10000, v6
    v_mfma_f32_32x32x16_bf16 v[32:47], a[184:187], v[80:83], v[32:47]
    s_waitcnt lgkmcnt(4)
    ds_read_b64_tr_b16 a[176:177], v9 offset:16384
    ds_read_b64_tr_b16 a[178:179], v9 offset:16896
    v_mul_f32_e32 v20, v48, v48
    v_mul_f32_e64 v21, v49, v49
    v_fma_f32 v20, v20, v3, v2
    v_fma_f32 v21, v21, v3, v2
    v_mfma_f32_32x32x16_bf16 v[32:47], a[188:191], v[84:87], v[32:47]
    s_waitcnt lgkmcnt(4)
    s_add_u32 m0, s83, 0x8800
    s_add_u32 s81, s84, 0x38000
    buffer_load_dwordx4 v252, s[36:39], s81 offen lds
    ds_read_b64_tr_b16 a[180:181], v9 offset:17408
    ds_read_b64_tr_b16 a[182:183], v9 offset:17920
    v_mfma_f32_32x32x16_bf16 v[32:47], a[192:195], v[88:91], v[32:47]
    s_waitcnt lgkmcnt(4)
    ds_read_b64_tr_b16 a[184:185], v9 offset:18432
    ds_read_b64_tr_b16 a[186:187], v9 offset:18944
    v_mul_f32_e32 v20, v48, v20
    v_mul_f32_e32 v21, v49, v21
    v_exp_f32_e32 v20, v20
    v_mfma_f32_32x32x16_bf16 v[32:47], a[196:199], v[92:95], v[32:47]
    s_waitcnt lgkmcnt(4)
    s_add_u32 m0, s83, 0x9000
    s_add_u32 s81, s84, 0x50000
    buffer_load_dwordx4 v252, s[36:39], s81 offen lds
    ds_read_b64_tr_b16 a[188:189], v9 offset:19456
    ds_read_b64_tr_b16 a[190:191], v9 offset:19968
    v_mfma_f32_32x32x16_bf16 v[32:47], a[176:179], v[96:99], v[32:47]
    s_waitcnt lgkmcnt(4)
    ds_read_b64_tr_b16 a[192:193], v9 offset:20480
    ds_read_b64_tr_b16 a[194:195], v9 offset:20992
    v_exp_f32_e32 v21, v21
    v_mul_f32_e32 v22, v48, v56
    v_mul_f32_e32 v23, v49, v57
    v_mfma_f32_32x32x16_bf16 v[32:47], a[180:183], v[100:103], v[32:47]
    s_waitcnt lgkmcnt(4)
    s_add_u32 m0, s83, 0x9800
    s_add_u32 s81, s84, 0x54000
    buffer_load_dwordx4 v252, s[36:39], s81 offen lds
    ds_read_b64_tr_b16 a[196:197], v9 offset:21504
    ds_read_b64_tr_b16 a[198:199], v9 offset:22016
    v_mfma_f32_32x32x16_bf16 v[32:47], a[184:187], v[104:107], v[32:47]
    s_waitcnt lgkmcnt(4)
    ds_read_b64_tr_b16 a[176:177], v9 offset:22528
    ds_read_b64_tr_b16 a[178:179], v9 offset:23040
    v_fma_f32 v20, v20, v4, v4
    v_fma_f32 v21, v21, v4, v4
    v_rcp_f32_e32 v20, v20
    v_mfma_f32_32x32x16_bf16 v[32:47], a[188:191], v[108:111], v[32:47]
    s_waitcnt lgkmcnt(4)
    s_add_u32 m0, s83, 0x10000
    s_add_u32 s81, s84, 0x58000
    buffer_load_dwordx4 v252, s[36:39], s81 offen lds
    ds_read_b64_tr_b16 a[180:181], v9 offset:23552
    ds_read_b64_tr_b16 a[182:183], v9 offset:24064
    v_mfma_f32_32x32x16_bf16 v[32:47], a[192:195], v[112:115], v[32:47]
    s_waitcnt lgkmcnt(4)
    ds_read_b64_tr_b16 a[184:185], v9 offset:49152
    ds_read_b64_tr_b16 a[186:187], v9 offset:49664
    v_rcp_f32_e32 v21, v21
    v_mul_f32_e32 v22, v22, v20
    v_mul_f32_e32 v23, v23, v21
    v_mfma_f32_32x32x16_bf16 v[32:47], a[196:199], v[116:119], v[32:47]
    s_waitcnt lgkmcnt(4)
    s_add_u32 m0, s83, 0x10800
    s_add_u32 s81, s84, 0x5c000
    buffer_load_dwordx4 v252, s[36:39], s81 offen lds
    ds_read_b64_tr_b16 a[188:189], v9 offset:50176
    ds_read_b64_tr_b16 a[190:191], v9 offset:50688
    v_mfma_f32_32x32x16_bf16 v[32:47], a[176:179], v[120:123], v[32:47]
    s_waitcnt lgkmcnt(4)
    ds_read_b64_tr_b16 a[192:193], v9 offset:51200
    ds_read_b64_tr_b16 a[194:195], v9 offset:51712
    v_cvt_pk_bf16_f32 v24, v22, v23
    v_mul_f32_e32 v20, v50, v50
    v_mul_f32_e32 v21, v51, v51
    v_fma_f32 v20, v20, v3, v2
    v_fma_f32 v21, v21, v3, v2
    v_mfma_f32_32x32x16_bf16 v[32:47], a[180:183], v[124:127], v[32:47]
    s_waitcnt lgkmcnt(4)
    s_add_u32 m0, s83, 0x11000
    s_add_u32 s81, s84, 0x60000
    buffer_load_dwordx4 v252, s[36:39], s81 offen lds
    ds_read_b64_tr_b16 a[196:197], v9 offset:52224
    ds_read_b64_tr_b16 a[198:199], v9 offset:52736
    v_mfma_f32_32x32x16_bf16 v[32:47], a[184:187], v[128:131], v[32:47]
    s_waitcnt lgkmcnt(4)
    ds_read_b64_tr_b16 a[176:177], v9 offset:53248
    ds_read_b64_tr_b16 a[178:179], v9 offset:53760
    v_mul_f32_e32 v20, v50, v20
    v_mul_f32_e32 v21, v51, v21
    v_exp_f32_e32 v20, v20
    v_mfma_f32_32x32x16_bf16 v[32:47], a[188:191], v[132:135], v[32:47]
    s_waitcnt lgkmcnt(4)
    s_add_u32 m0, s83, 0x11800
    s_add_u32 s81, s84, 0x78000
    buffer_load_dwordx4 v252, s[36:39], s81 offen lds
    ds_read_b64_tr_b16 a[180:181], v9 offset:54272
    ds_read_b64_tr_b16 a[182:183], v9 offset:54784
    v_mfma_f32_32x32x16_bf16 v[32:47], a[192:195], v[136:139], v[32:47]
    s_waitcnt lgkmcnt(4)
    ds_read_b64_tr_b16 a[184:185], v9 offset:55296
    ds_read_b64_tr_b16 a[186:187], v9 offset:55808
    v_exp_f32_e32 v21, v21
    v_mul_f32_e64 v22, v50, v58
    v_mul_f32_e32 v23, v51, v59
    v_mfma_f32_32x32x16_bf16 v[32:47], a[196:199], v[140:143], v[32:47]
    s_waitcnt lgkmcnt(4)
    ds_read_b64_tr_b16 a[188:189], v9 offset:56320
    ds_read_b64_tr_b16 a[190:191], v9 offset:56832
    v_fma_f32 v20, v20, v4, v4
    v_fma_f32 v21, v21, v4, v4
    v_rcp_f32_e64 v20, v20
    v_add_u32_e32 v239, 0x20000, v6
    v_mfma_f32_32x32x16_bf16 v[32:47], a[176:179], v[144:147], v[32:47]
    s_waitcnt lgkmcnt(4)
    ds_read_b64_tr_b16 a[192:193], v239 offset:16384
    ds_read_b64_tr_b16 a[194:195], v239 offset:16896
    v_rcp_f32_e32 v21, v21
    v_mul_f32_e32 v22, v22, v20
    v_mul_f32_e32 v23, v23, v21
    v_cvt_pk_bf16_f32 v25, v22, v23
    v_mfma_f32_32x32x16_bf16 v[32:47], a[180:183], v[148:151], v[32:47]
    s_waitcnt lgkmcnt(4)
    ds_read_b64_tr_b16 a[196:197], v239 offset:17408
    ds_read_b64_tr_b16 a[198:199], v239 offset:17920
    v_mul_f32_e32 v20, v52, v52
    v_mul_f32_e64 v21, v53, v53
    v_fma_f32 v20, v20, v3, v2
    v_fma_f32 v21, v21, v3, v2
    v_mfma_f32_32x32x16_bf16 v[32:47], a[184:187], v[152:155], v[32:47]
    s_waitcnt lgkmcnt(4)
    ds_read_b64_tr_b16 a[176:177], v239 offset:18432
    ds_read_b64_tr_b16 a[178:179], v239 offset:18944
    v_mul_f32_e32 v20, v52, v20
    v_mul_f32_e64 v21, v53, v21
    v_exp_f32_e32 v20, v20
    v_mfma_f32_32x32x16_bf16 v[32:47], a[188:191], v[156:159], v[32:47]
    s_waitcnt lgkmcnt(4)
    ds_read_b64_tr_b16 a[180:181], v239 offset:19456
    ds_read_b64_tr_b16 a[182:183], v239 offset:19968
    v_exp_f32_e32 v21, v21
    v_mul_f32_e32 v22, v52, v60
    v_mul_f32_e32 v23, v53, v61
    v_fma_f32 v20, v20, v4, v4
    v_mfma_f32_32x32x16_bf16 v[32:47], a[192:195], v[160:163], v[32:47]
    s_waitcnt lgkmcnt(4)
    ds_read_b64_tr_b16 a[184:185], v239 offset:20480
    ds_read_b64_tr_b16 a[186:187], v239 offset:20992
    v_fma_f32 v21, v21, v4, v4
    v_rcp_f32_e64 v20, v20
    v_rcp_f32_e32 v21, v21
    v_mfma_f32_32x32x16_bf16 v[32:47], a[196:199], v[164:167], v[32:47]
    s_waitcnt lgkmcnt(4)
    ds_read_b64_tr_b16 a[188:189], v239 offset:21504
    ds_read_b64_tr_b16 a[190:191], v239 offset:22016
    v_mul_f32_e32 v22, v22, v20
    v_mul_f32_e32 v23, v23, v21
    v_cvt_pk_bf16_f32 v26, v22, v23
    v_mul_f32_e32 v20, v54, v54
    v_mfma_f32_32x32x16_bf16 v[32:47], a[176:179], v[168:171], v[32:47]
    s_waitcnt lgkmcnt(4)
    ds_read_b64_tr_b16 a[192:193], v239 offset:22528
    ds_read_b64_tr_b16 a[194:195], v239 offset:23040
    v_mul_f32_e64 v21, v55, v55
    v_fma_f32 v20, v20, v3, v2
    v_fma_f32 v21, v21, v3, v2
    v_mul_f32_e32 v20, v54, v20
    v_mfma_f32_32x32x16_bf16 v[32:47], a[180:183], v[172:175], v[32:47]
    s_waitcnt lgkmcnt(4)
    ds_read_b64_tr_b16 a[196:197], v239 offset:23552
    ds_read_b64_tr_b16 a[198:199], v239 offset:24064
    v_mul_f32_e64 v21, v55, v21
    v_exp_f32_e32 v20, v20
    v_mfma_f32_32x32x16_bf16 v[32:47], a[184:187], v[176:179], v[32:47]
    s_waitcnt lgkmcnt(4)
    ds_read_b64_tr_b16 a[176:177], v7 offset:49152
    ds_read_b64_tr_b16 a[178:179], v7 offset:49664
    v_exp_f32_e32 v21, v21
    v_mul_f32_e32 v22, v54, v62
    v_mul_f32_e32 v23, v55, v63
    v_fma_f32 v20, v20, v4, v4
    v_mfma_f32_32x32x16_bf16 v[32:47], a[188:191], v[180:183], v[32:47]
    s_waitcnt lgkmcnt(4)
    ds_read_b64_tr_b16 a[180:181], v7 offset:50176
    ds_read_b64_tr_b16 a[182:183], v7 offset:50688
    v_fma_f32 v21, v21, v4, v4
    v_rcp_f32_e64 v20, v20
    v_rcp_f32_e32 v21, v21
    v_mfma_f32_32x32x16_bf16 v[32:47], a[192:195], v[184:187], v[32:47]
    s_waitcnt lgkmcnt(4)
    ds_read_b64_tr_b16 a[184:185], v7 offset:51200
    ds_read_b64_tr_b16 a[186:187], v7 offset:51712
    v_mul_f32_e32 v22, v22, v20
    v_mul_f32_e32 v23, v23, v21
    v_cvt_pk_bf16_f32 v27, v22, v23
    s_add_u32 s82, s77, 0x1c00
    v_mfma_f32_32x32x16_bf16 v[32:47], a[196:199], v[188:191], v[32:47]
    s_waitcnt lgkmcnt(4)
    buffer_store_dwordx4 v[24:27], v1, s[44:47], s82 offen sc1
    ds_read_b64_tr_b16 a[188:189], v7 offset:52224
    ds_read_b64_tr_b16 a[190:191], v7 offset:52736
    v_mfma_f32_32x32x16_bf16 v[48:63], a[176:179], v[64:67], 0
    s_waitcnt lgkmcnt(4)
    ds_read_b64_tr_b16 a[192:193], v7 offset:53248
    ds_read_b64_tr_b16 a[194:195], v7 offset:53760
    s_lshl_b32 s11, s64, 8
    s_add_u32 s11, s11, 0x1000
    v_and_b32_e32 v19, 15, v0
    v_lshlrev_b32_e32 v19, 2, v19
    v_mfma_f32_32x32x16_bf16 v[48:63], a[180:183], v[68:71], v[48:63]
    s_waitcnt lgkmcnt(4)
    ds_read_b64_tr_b16 a[196:197], v7 offset:54272
    ds_read_b64_tr_b16 a[198:199], v7 offset:54784
    v_mfma_f32_32x32x16_bf16 v[48:63], a[184:187], v[72:75], v[48:63]
    s_waitcnt lgkmcnt(4)
    ds_read_b64_tr_b16 a[176:177], v7 offset:55296
    ds_read_b64_tr_b16 a[178:179], v7 offset:55808
    v_mfma_f32_32x32x16_bf16 v[48:63], a[188:191], v[76:79], v[48:63]
    s_waitcnt lgkmcnt(4)
    buffer_load_dword v19, v19, s[44:47], s11 offen sc1
    ds_read_b64_tr_b16 a[180:181], v7 offset:56320
    ds_read_b64_tr_b16 a[182:183], v7 offset:56832
    v_mul_f32_e32 v20, v32, v32
    v_mul_f32_e32 v21, v33, v33
    v_add_u32_e32 v9, 0x10000, v7
    v_mfma_f32_32x32x16_bf16 v[48:63], a[192:195], v[80:83], v[48:63]
    s_waitcnt lgkmcnt(4)
    s_add_u32 m0, s83, 0x18000
    s_add_u32 s81, s84, 0x7c000
    buffer_load_dwordx4 v252, s[36:39], s81 offen lds
    ds_read_b64_tr_b16 a[184:185], v9 offset:16384
    ds_read_b64_tr_b16 a[186:187], v9 offset:16896
    v_mfma_f32_32x32x16_bf16 v[48:63], a[196:199], v[84:87], v[48:63]
    s_waitcnt lgkmcnt(4)
    ds_read_b64_tr_b16 a[188:189], v9 offset:17408
    ds_read_b64_tr_b16 a[190:191], v9 offset:17920
    v_fma_f32 v20, v20, v3, v2
    v_fma_f32 v21, v21, v3, v2
    v_mul_f32_e32 v20, v32, v20
    v_mul_f32_e32 v21, v33, v21
    v_exp_f32_e32 v20, v20
    v_mfma_f32_32x32x16_bf16 v[48:63], a[176:179], v[88:91], v[48:63]
    s_waitcnt lgkmcnt(4)
    s_add_u32 m0, s83, 0x18800
    s_add_u32 s81, s84, 0x80000
    buffer_load_dwordx4 v252, s[36:39], s81 offen lds
    ds_read_b64_tr_b16 a[192:193], v9 offset:18432
    ds_read_b64_tr_b16 a[194:195], v9 offset:18944
    v_mfma_f32_32x32x16_bf16 v[48:63], a[180:183], v[92:95], v[48:63]
    s_waitcnt lgkmcnt(4)
    ds_read_b64_tr_b16 a[196:197], v9 offset:19456
    ds_read_b64_tr_b16 a[198:199], v9 offset:19968
    v_exp_f32_e32 v21, v21
    v_mul_f32_e32 v22, v32, v40
    v_mul_f32_e32 v23, v33, v41
    v_fma_f32 v20, v20, v4, v4
    v_mfma_f32_32x32x16_bf16 v[48:63], a[184:187], v[96:99], v[48:63]
    s_waitcnt lgkmcnt(4)
    s_add_u32 m0, s83, 0x19000
    s_add_u32 s81, s84, 0x84000
    buffer_load_dwordx4 v252, s[36:39], s81 offen lds
    ds_read_b64_tr_b16 a[176:177], v9 offset:20480
    ds_read_b64_tr_b16 a[178:179], v9 offset:20992
    v_mfma_f32_32x32x16_bf16 v[48:63], a[188:191], v[100:103], v[48:63]
    s_waitcnt lgkmcnt(4)
    ds_read_b64_tr_b16 a[180:181], v9 offset:21504
    ds_read_b64_tr_b16 a[182:183], v9 offset:22016
    v_fma_f32 v21, v21, v4, v4
    v_rcp_f32_e64 v20, v20
    v_rcp_f32_e32 v21, v21
    v_mfma_f32_32x32x16_bf16 v[48:63], a[192:195], v[104:107], v[48:63]
    s_waitcnt lgkmcnt(4)
    s_add_u32 m0, s83, 0x19800
    s_add_u32 s81, s84, 0x88000
    buffer_load_dwordx4 v252, s[36:39], s81 offen lds
    ds_read_b64_tr_b16 a[184:185], v9 offset:22528
    ds_read_b64_tr_b16 a[186:187], v9 offset:23040
    v_mul_f32_e32 v22, v22, v20
    v_mfma_f32_32x32x16_bf16 v[48:63], a[196:199], v[108:111], v[48:63]
    s_waitcnt lgkmcnt(4)
    ds_read_b64_tr_b16 a[188:189], v9 offset:23552
    ds_read_b64_tr_b16 a[190:191], v9 offset:24064
    v_mul_f32_e64 v23, v23, v21
    v_cvt_pk_bf16_f32 v24, v22, v23
    v_mul_f32_e32 v20, v34, v34
    v_mul_f32_e32 v21, v35, v35
    v_fma_f32 v20, v20, v3, v2
    v_mfma_f32_32x32x16_bf16 v[48:63], a[176:179], v[112:115], v[48:63]
    s_waitcnt lgkmcnt(4)
    s_add_u32 m0, s83, 0x20000
    s_add_u32 s81, s84, 0x14000
    buffer_load_dwordx4 v252, s[36:39], s81 offen lds
    ds_read_b64_tr_b16 a[192:193], v9 offset:49152
    ds_read_b64_tr_b16 a[194:195], v9 offset:49664
    v_mfma_f32_32x32x16_bf16 v[48:63], a[180:183], v[116:119], v[48:63]
    s_waitcnt lgkmcnt(4)
    ds_read_b64_tr_b16 a[196:197], v9 offset:50176
    ds_read_b64_tr_b16 a[198:199], v9 offset:50688
    v_fma_f32 v21, v21, v3, v2
    v_mul_f32_e32 v20, v34, v20
    v_mul_f32_e32 v21, v35, v21
    v_exp_f32_e32 v20, v20
    v_mfma_f32_32x32x16_bf16 v[48:63], a[184:187], v[120:123], v[48:63]
    s_waitcnt lgkmcnt(4)
    s_add_u32 m0, s83, 0x20800
    s_add_u32 s81, s84, 0x18000
    buffer_load_dwordx4 v252, s[36:39], s81 offen lds
    ds_read_b64_tr_b16 a[176:177], v9 offset:51200
    ds_read_b64_tr_b16 a[178:179], v9 offset:51712
    s_waitcnt vmcnt(6)
    v_mfma_f32_32x32x16_bf16 v[48:63], a[188:191], v[124:127], v[48:63]
    s_waitcnt lgkmcnt(4)
    ds_read_b64_tr_b16 a[180:181], v9 offset:52224
    ds_read_b64_tr_b16 a[182:183], v9 offset:52736
    v_exp_f32_e32 v21, v21
    v_mul_f32_e32 v22, v34, v42
    v_mul_f32_e64 v23, v35, v43
    v_fma_f32 v20, v20, v4, v4
    v_mfma_f32_32x32x16_bf16 v[48:63], a[192:195], v[128:131], v[48:63]
    s_waitcnt lgkmcnt(4)
    s_add_u32 m0, s83, 0x21000
    s_add_u32 s81, s84, 0x1c000
    buffer_load_dwordx4 v252, s[36:39], s81 offen lds
    ds_read_b64_tr_b16 a[184:185], v9 offset:53248
    ds_read_b64_tr_b16 a[186:187], v9 offset:53760
    v_mfma_f32_32x32x16_bf16 v[48:63], a[196:199], v[132:135], v[48:63]
    s_waitcnt lgkmcnt(4)
    ds_read_b64_tr_b16 a[188:189], v9 offset:54272
    ds_read_b64_tr_b16 a[190:191], v9 offset:54784
    v_fma_f32 v21, v21, v4, v4
    v_rcp_f32_e64 v20, v20
    v_rcp_f32_e32 v21, v21
    v_mfma_f32_32x32x16_bf16 v[48:63], a[176:179], v[136:139], v[48:63]
    s_waitcnt lgkmcnt(4)
    s_add_u32 m0, s83, 0x21800
    s_add_u32 s81, s84, 0x3c000
    buffer_load_dwordx4 v252, s[36:39], s81 offen lds
    ds_read_b64_tr_b16 a[192:193], v9 offset:55296
    ds_read_b64_tr_b16 a[194:195], v9 offset:55808
    v_mfma_f32_32x32x16_bf16 v[48:63], a[180:183], v[140:143], v[48:63]
    s_waitcnt lgkmcnt(4)
    ds_read_b64_tr_b16 a[196:197], v9 offset:56320
    ds_read_b64_tr_b16 a[198:199], v9 offset:56832
    v_mul_f32_e32 v22, v22, v20
    v_mul_f32_e64 v23, v23, v21
    v_cvt_pk_bf16_f32 v25, v22, v23
    v_mul_f32_e32 v20, v36, v36
    v_mul_f32_e32 v21, v37, v37
    v_fma_f32 v20, v20, v3, v2
    v_add_u32_e32 v239, 0x20000, v7
    v_mfma_f32_32x32x16_bf16 v[48:63], a[184:187], v[144:147], v[48:63]
    s_waitcnt lgkmcnt(4)
    ds_read_b64_tr_b16 a[176:177], v239 offset:16384
    ds_read_b64_tr_b16 a[178:179], v239 offset:16896
    v_fma_f32 v21, v21, v3, v2
    v_mul_f32_e32 v20, v36, v20
    v_mul_f32_e64 v21, v37, v21
    v_exp_f32_e32 v20, v20
    v_mfma_f32_32x32x16_bf16 v[48:63], a[188:191], v[148:151], v[48:63]
    s_waitcnt lgkmcnt(4)
    ds_read_b64_tr_b16 a[180:181], v239 offset:17408
    ds_read_b64_tr_b16 a[182:183], v239 offset:17920
    v_exp_f32_e32 v21, v21
    v_mul_f32_e32 v22, v36, v44
    v_mul_f32_e32 v23, v37, v45
    v_fma_f32 v20, v20, v4, v4
    v_mfma_f32_32x32x16_bf16 v[48:63], a[192:195], v[152:155], v[48:63]
    s_waitcnt lgkmcnt(4)
    ds_read_b64_tr_b16 a[184:185], v239 offset:18432
    ds_read_b64_tr_b16 a[186:187], v239 offset:18944
    v_fma_f32 v21, v21, v4, v4
    v_rcp_f32_e64 v20, v20
    v_rcp_f32_e32 v21, v21
    v_mfma_f32_32x32x16_bf16 v[48:63], a[196:199], v[156:159], v[48:63]
    s_waitcnt lgkmcnt(4)
    ds_read_b64_tr_b16 a[188:189], v239 offset:19456
    ds_read_b64_tr_b16 a[190:191], v239 offset:19968
    v_mul_f32_e32 v22, v22, v20
    v_mul_f32_e32 v23, v23, v21
    v_cvt_pk_bf16_f32 v26, v22, v23
    v_mul_f32_e64 v20, v38, v38
    v_mul_f32_e32 v21, v39, v39
    v_fma_f32 v20, v20, v3, v2
    v_mfma_f32_32x32x16_bf16 v[48:63], a[176:179], v[160:163], v[48:63]
    s_waitcnt lgkmcnt(4)
    ds_read_b64_tr_b16 a[192:193], v239 offset:20480
    ds_read_b64_tr_b16 a[194:195], v239 offset:20992
    v_fma_f32 v21, v21, v3, v2
    v_mul_f32_e32 v20, v38, v20
    v_mul_f32_e32 v21, v39, v21
    v_exp_f32_e32 v20, v20
    v_mfma_f32_32x32x16_bf16 v[48:63], a[180:183], v[164:167], v[48:63]
    s_waitcnt lgkmcnt(4)
    ds_read_b64_tr_b16 a[196:197], v239 offset:21504
    ds_read_b64_tr_b16 a[198:199], v239 offset:22016
    v_exp_f32_e32 v21, v21
    v_mul_f32_e32 v22, v38, v46
    v_mul_f32_e32 v23, v39, v47
    v_fma_f32 v20, v20, v4, v4
    v_mfma_f32_32x32x16_bf16 v[48:63], a[184:187], v[168:171], v[48:63]
    s_waitcnt lgkmcnt(4)
    ds_read_b64_tr_b16 a[176:177], v239 offset:22528
    ds_read_b64_tr_b16 a[178:179], v239 offset:23040
    v_cmp_ne_u32 vcc, s67, v19
    s_nop 1
    s_cmp_lg_u64 vcc, 0
    s_cbranch_scc1 L_slow_22
L_back_23:
    v_mfma_f32_32x32x16_bf16 v[48:63], a[188:191], v[172:175], v[48:63]
    s_waitcnt lgkmcnt(4)
    s_add_u32 s9, s87, 0x0
    buffer_load_dwordx4 a[64:67], v1, s[44:47], s9 offen offset:0 sc1
    ds_read_b64_tr_b16 a[180:181], v239 offset:23552
    ds_read_b64_tr_b16 a[182:183], v239 offset:24064
    v_fma_f32 v21, v21, v4, v4
    v_mfma_f32_32x32x16_bf16 v[48:63], a[192:195], v[176:179], v[48:63]
    s_waitcnt lgkmcnt(4)
    v_rcp_f32_e32 v20, v20
    v_rcp_f32_e32 v21, v21
    v_mul_f32_e32 v22, v22, v20
    v_mul_f32_e64 v23, v23, v21
    v_mfma_f32_32x32x16_bf16 v[48:63], a[196:199], v[180:183], v[48:63]
    s_waitcnt lgkmcnt(0)
    s_barrier
    buffer_load_dwordx4 a[68:71], v1, s[44:47], s9 offen offset:1024 sc1
    ds_read_b64_tr_b16 a[128:129], v251 offset:0
    ds_read_b64_tr_b16 a[130:131], v251 offset:512
    ds_read_b64_tr_b16 a[132:133], v248 offset:0
    ds_read_b64_tr_b16 a[134:135], v248 offset:512
    v_cvt_pk_bf16_f32 v27, v22, v23
    s_add_u32 s82, s77, 0x2000
    v_mfma_f32_32x32x16_bf16 v[48:63], a[176:179], v[184:187], v[48:63]
    ds_read_b64_tr_b16 a[136:137], v251 offset:2048
    ds_read_b64_tr_b16 a[138:139], v251 offset:2560
    ds_read_b64_tr_b16 a[140:141], v248 offset:2048
    ds_read_b64_tr_b16 a[142:143], v248 offset:2560
    v_mfma_f32_32x32x16_bf16 v[48:63], a[180:183], v[188:191], v[48:63]
    buffer_store_dwordx4 v[24:27], v1, s[44:47], s82 offen sc1
    s_lshl_b32 s69, s60, 1
    s_add_u32 s69, s69, s57
    s_lshl_b32 s90, s62, 8
    s_lshl_b32 s69, s69, 2
    s_add_u32 s90, s90, s69
    s_add_u32 s90, s90, 0x3000
    buffer_store_dword v253, v18, s[44:47], s90 offen sc1
    buffer_load_dwordx4 a[72:75], v1, s[44:47], s9 offen offset:2048 sc1
    buffer_load_dwordx4 a[76:79], v1, s[44:47], s9 offen offset:3072 sc1
    s_add_u32 s9, s9, 0x1000
    buffer_load_dwordx4 a[80:83], v1, s[44:47], s9 offen offset:0 sc1
    s_add_u32 s9, s87, 0x2800
    buffer_load_dwordx4 a[84:87], v1, s[44:47], s9 offen offset:0 sc1
    buffer_load_dwordx4 a[88:91], v1, s[44:47], s9 offen offset:1024 sc1
    buffer_load_dwordx4 a[92:95], v1, s[44:47], s9 offen offset:2048 sc1
    s_waitcnt vmcnt(9) lgkmcnt(6)
    v_mfma_f32_32x32x16_bf16 v[64:79], a[128:131], a[64:67], 0
    s_waitcnt lgkmcnt(4)
    ds_read_b64_tr_b16 a[144:145], v251 offset:4096
    ds_read_b64_tr_b16 a[146:147], v251 offset:4608
    v_mul_f32_e32 v20, v48, v48
    v_mul_f32_e64 v21, v49, v49
    v_fma_f32 v20, v20, v3, v2
    v_fma_f32 v21, v21, v3, v2
    v_mul_f32_e32 v20, v48, v20
    v_mul_f32_e32 v21, v49, v21
    v_exp_f32_e32 v20, v20
    v_exp_f32_e32 v21, v21
    v_mul_f32_e64 v22, v48, v56
    v_mfma_f32_32x32x16_bf16 v[80:95], a[132:135], a[64:67], 0
    buffer_load_dwordx4 a[96:99], v1, s[44:47], s9 offen offset:3072 sc1
    s_add_u32 s9, s9, 0x1000
    buffer_load_dwordx4 a[100:103], v1, s[44:47], s9 offen offset:0 sc1
    s_add_u32 m0, s83, 0xc000
    s_add_u32 s81, s84, 0x40000
    buffer_load_dwordx4 v252, s[36:39], s81 offen lds
    ds_read_b64_tr_b16 a[148:149], v248 offset:4096
    ds_read_b64_tr_b16 a[150:151], v248 offset:4608
    v_mul_f32_e64 v23, v49, v57
    v_fma_f32 v20, v20, v4, v4
    v_fma_f32 v21, v21, v4, v4
    v_rcp_f32_e32 v20, v20
    v_rcp_f32_e32 v21, v21
    v_mul_f32_e32 v22, v22, v20
    v_mul_f32_e32 v23, v23, v21
    v_cvt_pk_bf16_f32 v24, v22, v23
    v_mul_f32_e64 v20, v50, v50
    s_waitcnt vmcnt(11) lgkmcnt(6)
    v_mfma_f32_32x32x16_bf16 v[64:79], a[136:139], a[68:71], v[64:79]
    s_waitcnt lgkmcnt(4)
    ds_read_b64_tr_b16 a[128:129], v251 offset:6144
    ds_read_b64_tr_b16 a[130:131], v251 offset:6656
    v_mul_f32_e64 v21, v51, v51
    v_fma_f32 v20, v20, v3, v2
    v_fma_f32 v21, v21, v3, v2
    v_mul_f32_e32 v20, v50, v20
    v_mul_f32_e32 v21, v51, v21
    v_exp_f32_e32 v20, v20
    v_exp_f32_e32 v21, v21
    v_mul_f32_e32 v22, v50, v58
    v_mul_f32_e32 v23, v51, v59
    v_mfma_f32_32x32x16_bf16 v[80:95], a[140:143], a[68:71], v[80:95]
    s_add_u32 s9, s87, 0x5000
    buffer_load_dwordx4 a[104:107], v1, s[44:47], s9 offen offset:0 sc1
    buffer_load_dwordx4 a[108:111], v1, s[44:47], s9 offen offset:1024 sc1
    s_add_u32 m0, s83, 0xc800
    s_add_u32 s81, s84, 0x44000
    buffer_load_dwordx4 v252, s[36:39], s81 offen lds
    ds_read_b64_tr_b16 a[132:133], v248 offset:6144
    ds_read_b64_tr_b16 a[134:135], v248 offset:6656
    v_fma_f32 v20, v20, v4, v4
    v_fma_f32 v21, v21, v4, v4
    v_rcp_f32_e32 v20, v20
    v_rcp_f32_e32 v21, v21
    v_mul_f32_e32 v22, v22, v20
    v_mul_f32_e32 v23, v23, v21
    v_cvt_pk_bf16_f32 v25, v22, v23
    v_mul_f32_e32 v20, v52, v52
    v_mul_f32_e32 v21, v53, v53
    s_waitcnt vmcnt(11) lgkmcnt(6)
    v_mfma_f32_32x32x16_bf16 v[64:79], a[144:147], a[72:75], v[64:79]
    s_waitcnt lgkmcnt(4)
    ds_read_b64_tr_b16 a[136:137], v251 offset:16384
    ds_read_b64_tr_b16 a[138:139], v251 offset:16896
    v_fma_f32 v20, v20, v3, v2
    v_fma_f32 v21, v21, v3, v2
    v_mul_f32_e32 v20, v52, v20
    v_mul_f32_e32 v21, v53, v21
    v_exp_f32_e32 v20, v20
    v_exp_f32_e32 v21, v21
    v_mul_f32_e32 v22, v52, v60
    v_mul_f32_e32 v23, v53, v61
    v_fma_f32 v20, v20, v4, v4
    v_mfma_f32_32x32x16_bf16 v[80:95], a[148:151], a[72:75], v[80:95]
    buffer_load_dwordx4 a[112:115], v1, s[44:47], s9 offen offset:2048 sc1
    buffer_load_dwordx4 a[116:119], v1, s[44:47], s9 offen offset:3072 sc1
    s_add_u32 m0, s83, 0xd000
    s_add_u32 s81, s84, 0x64000
    buffer_load_dwordx4 v252, s[36:39], s81 offen lds
    ds_read_b64_tr_b16 a[140:141], v248 offset:16384
    ds_read_b64_tr_b16 a[142:143], v248 offset:16896
    v_fma_f32 v21, v21, v4, v4
    v_rcp_f32_e32 v20, v20
    v_rcp_f32_e32 v21, v21
    v_mul_f32_e32 v22, v22, v20
    v_mul_f32_e32 v23, v23, v21
    v_cvt_pk_bf16_f32 v26, v22, v23
    v_mul_f32_e32 v20, v54, v54
    v_mul_f32_e32 v21, v55, v55
    v_fma_f32 v20, v20, v3, v2
    s_waitcnt vmcnt(13) lgkmcnt(6)
    v_mfma_f32_32x32x16_bf16 v[64:79], a[128:131], a[76:79], v[64:79]
    s_waitcnt lgkmcnt(4)
    ds_read_b64_tr_b16 a[144:145], v251 offset:18432
    ds_read_b64_tr_b16 a[146:147], v251 offset:18944
    v_fma_f32 v21, v21, v3, v2
    v_mul_f32_e32 v20, v54, v20
    v_mul_f32_e32 v21, v55, v21
    v_exp_f32_e32 v20, v20
    v_exp_f32_e32 v21, v21
    v_mul_f32_e32 v22, v54, v62
    v_mul_f32_e32 v23, v55, v63
    v_fma_f32 v20, v20, v4, v4
    v_fma_f32 v21, v21, v4, v4
    v_mfma_f32_32x32x16_bf16 v[80:95], a[132:135], a[76:79], v[80:95]
    s_add_u32 s9, s9, 0x1000
    buffer_load_dwordx4 a[120:123], v1, s[44:47], s9 offen offset:0 sc1
    s_add_u32 s9, s87, 0x7800
    buffer_load_dwordx4 a[124:127], v1, s[44:47], s9 offen offset:0 sc1
    s_add_u32 m0, s83, 0xd800
    s_add_u32 s81, s84, 0x68000
    buffer_load_dwordx4 v252, s[36:39], s81 offen lds
    ds_read_b64_tr_b16 a[148:149], v248 offset:18432
    ds_read_b64_tr_b16 a[150:151], v248 offset:18944
    v_rcp_f32_e32 v20, v20
    v_rcp_f32_e32 v21, v21
    v_mul_f32_e32 v22, v22, v20
    v_mul_f32_e32 v23, v23, v21
    v_cvt_pk_bf16_f32 v27, v22, v23
    s_add_u32 s82, s77, 0x2400
    buffer_store_dwordx4 v[24:27], v1, s[44:47], s82 offen sc1
    s_waitcnt vmcnt(16) lgkmcnt(6)
    v_mfma_f32_32x32x16_bf16 v[64:79], a[136:139], a[80:83], v[64:79]
    s_waitcnt lgkmcnt(4)
    ds_read_b64_tr_b16 a[128:129], v251 offset:20480
    ds_read_b64_tr_b16 a[130:131], v251 offset:20992
    v_mfma_f32_32x32x16_bf16 v[80:95], a[140:143], a[80:83], v[80:95]
    buffer_load_dwordx4 a[64:67], v1, s[44:47], s9 offen offset:1024 sc1
    buffer_load_dwordx4 a[68:71], v1, s[44:47], s9 offen offset:2048 sc1
    s_add_u32 m0, s83, 0x14000
    s_add_u32 s81, s84, 0x6c000
    buffer_load_dwordx4 v252, s[36:39], s81 offen lds
    ds_read_b64_tr_b16 a[132:133], v248 offset:20480
    ds_read_b64_tr_b16 a[134:135], v248 offset:20992
    s_waitcnt vmcnt(18) lgkmcnt(6)
    v_mfma_f32_32x32x16_bf16 v[64:79], a[144:147], a[84:87], v[64:79]
    s_waitcnt lgkmcnt(4)
    ds_read_b64_tr_b16 a[136:137], v251 offset:22528
    ds_read_b64_tr_b16 a[138:139], v251 offset:23040
    v_mfma_f32_32x32x16_bf16 v[80:95], a[148:151], a[84:87], v[80:95]
    buffer_load_dwordx4 a[72:75], v1, s[44:47], s9 offen offset:3072 sc1
    s_add_u32 s9, s9, 0x1000
    buffer_load_dwordx4 a[76:79], v1, s[44:47], s9 offen offset:0 sc1
    s_add_u32 m0, s83, 0x14800
    s_add_u32 s81, s84, 0x8c000
    buffer_load_dwordx4 v252, s[36:39], s81 offen lds
    ds_read_b64_tr_b16 a[140:141], v248 offset:22528
    ds_read_b64_tr_b16 a[142:143], v248 offset:23040
    s_waitcnt vmcnt(20) lgkmcnt(6)
    v_mfma_f32_32x32x16_bf16 v[64:79], a[128:131], a[88:91], v[64:79]
    s_waitcnt lgkmcnt(0)
    s_barrier
    ds_read_b64_tr_b16 a[144:145], v251 offset:32768
    ds_read_b64_tr_b16 a[146:147], v251 offset:33280
    v_mfma_f32_32x32x16_bf16 v[80:95], a[132:135], a[88:91], v[80:95]
    s_add_u32 m0, s83, 0x15000
    s_add_u32 s81, s84, 0x90000
    buffer_load_dwordx4 v252, s[36:39], s81 offen lds
    ds_read_b64_tr_b16 a[148:149], v248 offset:32768
    ds_read_b64_tr_b16 a[150:151], v248 offset:33280
    s_waitcnt vmcnt(20)
    v_mfma_f32_32x32x16_bf16 v[64:79], a[136:139], a[92:95], v[64:79]
    ds_read_b64_tr_b16 a[128:129], v251 offset:34816
    ds_read_b64_tr_b16 a[130:131], v251 offset:35328
    v_mfma_f32_32x32x16_bf16 v[80:95], a[140:143], a[92:95], v[80:95]
    s_add_u32 m0, s83, 0x15800
    s_add_u32 s81, s84, 0x94000
    buffer_load_dwordx4 v252, s[36:39], s81 offen lds
    ds_read_b64_tr_b16 a[132:133], v248 offset:34816
    ds_read_b64_tr_b16 a[134:135], v248 offset:35328
    s_waitcnt vmcnt(20) lgkmcnt(6)
    v_mfma_f32_32x32x16_bf16 v[64:79], a[144:147], a[96:99], v[64:79]
    s_waitcnt lgkmcnt(4)
    ds_read_b64_tr_b16 a[136:137], v251 offset:36864
    ds_read_b64_tr_b16 a[138:139], v251 offset:37376
    s_lshl_b32 s11, s64, 8
    s_add_u32 s11, s11, 0x3000
    v_and_b32_e32 v19, 31, v0
    v_lshlrev_b32_e64 v19, 2, v19
    v_mfma_f32_32x32x16_bf16 v[80:95], a[148:151], a[96:99], v[80:95]
    s_add_u32 m0, s83, 0x1c000
    s_add_u32 s81, s85, 0x140000
    buffer_load_dwordx4 v252, s[36:39], s81 offen lds
    buffer_load_dword v19, v19, s[44:47], s11 offen sc1
    ds_read_b64_tr_b16 a[140:141], v248 offset:36864
    ds_read_b64_tr_b16 a[142:143], v248 offset:37376
    s_waitcnt vmcnt(21) lgkmcnt(6)
    v_mfma_f32_32x32x16_bf16 v[64:79], a[128:131], a[100:103], v[64:79]
    s_waitcnt lgkmcnt(4)
    ds_read_b64_tr_b16 a[144:145], v251 offset:38912
    ds_read_b64_tr_b16 a[146:147], v251 offset:39424
    v_mfma_f32_32x32x16_bf16 v[80:95], a[132:135], a[100:103], v[80:95]
    s_add_u32 m0, s83, 0x1c800
    s_add_u32 s81, s85, 0x144000
    buffer_load_dwordx4 v252, s[36:39], s81 offen lds
    ds_read_b64_tr_b16 a[148:149], v248 offset:38912
    ds_read_b64_tr_b16 a[150:151], v248 offset:39424
    s_waitcnt vmcnt(20) lgkmcnt(6)
    v_mfma_f32_32x32x16_bf16 v[64:79], a[136:139], a[104:107], v[64:79]
    s_waitcnt lgkmcnt(4)
    ds_read_b64_tr_b16 a[128:129], v250 offset:0
    ds_read_b64_tr_b16 a[130:131], v250 offset:512
    s_waitcnt vmcnt(11)
    v_mfma_f32_32x32x16_bf16 v[80:95], a[140:143], a[104:107], v[80:95]
    s_add_u32 m0, s83, 0x1d000
    s_add_u32 s81, s85, 0x148000
    buffer_load_dwordx4 v252, s[36:39], s81 offen lds
    ds_read_b64_tr_b16 a[132:133], v247 offset:0
    ds_read_b64_tr_b16 a[134:135], v247 offset:512
    s_lshl_b32 s69, s60, 1
    s_add_u32 s69, s69, s57
    s_lshl_b32 s90, s62, 8
    s_lshl_b32 s69, s69, 2
    s_add_u32 s90, s90, s69
    s_add_u32 s90, s90, 0x9000
    buffer_store_dword v253, v18, s[44:47], s90 offen sc1
    s_waitcnt lgkmcnt(6)
    v_mfma_f32_32x32x16_bf16 v[64:79], a[144:147], a[108:111], v[64:79]
    s_waitcnt lgkmcnt(4)
    ds_read_b64_tr_b16 a[136:137], v250 offset:2048
    ds_read_b64_tr_b16 a[138:139], v250 offset:2560
    v_mfma_f32_32x32x16_bf16 v[80:95], a[148:151], a[108:111], v[80:95]
    ds_read_b64_tr_b16 a[140:141], v247 offset:2048
    ds_read_b64_tr_b16 a[142:143], v247 offset:2560
    s_waitcnt lgkmcnt(6)
    v_mfma_f32_32x32x16_bf16 v[64:79], a[128:131], a[112:115], v[64:79]
    s_waitcnt lgkmcnt(4)
    ds_read_b64_tr_b16 a[144:145], v250 offset:4096
    ds_read_b64_tr_b16 a[146:147], v250 offset:4608
    v_mfma_f32_32x32x16_bf16 v[80:95], a[132:135], a[112:115], v[80:95]
    s_add_u32 m0, s83, 0x1d800
    s_add_u32 s81, s85, 0x14c000
    buffer_load_dwordx4 v252, s[36:39], s81 offen lds
    ds_read_b64_tr_b16 a[148:149], v247 offset:4096
    ds_read_b64_tr_b16 a[150:151], v247 offset:4608
    s_waitcnt lgkmcnt(6)
    v_mfma_f32_32x32x16_bf16 v[64:79], a[136:139], a[116:119], v[64:79]
    s_waitcnt lgkmcnt(4)
    ds_read_b64_tr_b16 a[128:129], v250 offset:6144
    ds_read_b64_tr_b16 a[130:131], v250 offset:6656
    v_mfma_f32_32x32x16_bf16 v[80:95], a[140:143], a[116:119], v[80:95]
    s_waitcnt vmcnt(4)
    v_cmp_ne_u32 vcc, s67, v19
    s_nop 1
    s_cmp_lg_u64 vcc, 0
    s_cbranch_scc1 L_slow_25
L_back_26:
    s_add_u32 s9, s87, 0x1400
    buffer_load_dwordx4 a[80:83], v1, s[44:47], s9 offen offset:0 sc1
    buffer_load_dwordx4 a[84:87], v1, s[44:47], s9 offen offset:1024 sc1
    s_add_u32 m0, s83, 0x24000
    s_add_u32 s81, s85, 0x150000
    buffer_load_dwordx4 v252, s[36:39], s81 offen lds
    ds_read_b64_tr_b16 a[132:133], v247 offset:6144
    ds_read_b64_tr_b16 a[134:135], v247 offset:6656
    s_waitcnt lgkmcnt(6)
    v_mfma_f32_32x32x16_bf16 v[64:79], a[144:147], a[120:123], v[64:79]
    s_waitcnt lgkmcnt(0)
    s_barrier
    ds_read_b64_tr_b16 a[136:137], v250 offset:32768
    ds_read_b64_tr_b16 a[138:139], v250 offset:33280
    v_mfma_f32_32x32x16_bf16 v[80:95], a[148:151], a[120:123], v[80:95]
    buffer_load_dwordx4 a[88:91], v1, s[44:47], s9 offen offset:2048 sc1
    s_add_u32 s9, s87, 0x3c00
    buffer_load_dwordx4 a[92:95], v1, s[44:47], s9 offen offset:0 sc1
    s_add_u32 m0, s83, 0x24800
    s_add_u32 s81, s85, 0x154000
    buffer_load_dwordx4 v252, s[36:39], s81 offen lds
    ds_read_b64_tr_b16 a[140:141], v247 offset:32768
    ds_read_b64_tr_b16 a[142:143], v247 offset:33280
    v_mfma_f32_32x32x16_bf16 v[64:79], a[128:131], a[124:127], v[64:79]
    ds_read_b64_tr_b16 a[144:145], v250 offset:34816
    ds_read_b64_tr_b16 a[146:147], v250 offset:35328
    v_mfma_f32_32x32x16_bf16 v[80:95], a[132:135], a[124:127], v[80:95]
    buffer_load_dwordx4 a[96:99], v1, s[44:47], s9 offen offset:1024 sc1
    buffer_load_dwordx4 a[100:103], v1, s[44:47], s9 offen offset:2048 sc1
    s_add_u32 m0, s83, 0x25000
    s_add_u32 s81, s85, 0x158000
    buffer_load_dwordx4 v252, s[36:39], s81 offen lds
    ds_read_b64_tr_b16 a[148:149], v247 offset:34816
    ds_read_b64_tr_b16 a[150:151], v247 offset:35328
    s_waitcnt lgkmcnt(6)
    v_mfma_f32_32x32x16_bf16 v[64:79], a[136:139], a[64:67], v[64:79]
    s_waitcnt lgkmcnt(4)
    ds_read_b64_tr_b16 a[128:129], v250 offset:36864
    ds_read_b64_tr_b16 a[130:131], v250 offset:37376
    v_mfma_f32_32x32x16_bf16 v[80:95], a[140:143], a[64:67], v[80:95]
    s_add_u32 s9, s87, 0x6400
    buffer_load_dwordx4 a[104:107], v1, s[44:47], s9 offen offset:0 sc1
    buffer_load_dwordx4 a[108:111], v1, s[44:47], s9 offen offset:1024 sc1
    s_add_u32 m0, s83, 0x25800
    s_add_u32 s81, s85, 0x15c000
    buffer_load_dwordx4 v252, s[36:39], s81 offen lds
    ds_read_b64_tr_b16 a[132:133], v247 offset:36864
    ds_read_b64_tr_b16 a[134:135], v247 offset:37376
    s_waitcnt lgkmcnt(6)
    v_mfma_f32_32x32x16_bf16 v[64:79], a[144:147], a[68:71], v[64:79]
    s_waitcnt lgkmcnt(4)
    ds_read_b64_tr_b16 a[136:137], v250 offset:38912
    ds_read_b64_tr_b16 a[138:139], v250 offset:39424
    v_mfma_f32_32x32x16_bf16 v[80:95], a[148:151], a[68:71], v[80:95]
    buffer_load_dwordx4 a[112:115], v1, s[44:47], s9 offen offset:2048 sc1
    s_add_u32 s9, s87, 0x8c00
    buffer_load_dwordx4 a[116:119], v1, s[44:47], s9 offen offset:0 sc1
    s_add_u32 m0, s83, 0x0
    s_add_u32 s81, s85, 0x160000
    buffer_load_dwordx4 v252, s[36:39], s81 offen lds
    ds_read_b64_tr_b16 a[140:141], v247 offset:38912
    ds_read_b64_tr_b16 a[142:143], v247 offset:39424
    s_waitcnt lgkmcnt(6)
    v_mfma_f32_32x32x16_bf16 v[64:79], a[128:131], a[72:75], v[64:79]
    s_waitcnt lgkmcnt(4)
    ds_read_b64_tr_b16 a[144:145], v249 offset:0
    ds_read_b64_tr_b16 a[146:147], v249 offset:512
    v_mfma_f32_32x32x16_bf16 v[80:95], a[132:135], a[72:75], v[80:95]
    s_nop 0
    buffer_load_dwordx4 a[120:123], v1, s[44:47], s9 offen offset:1024 sc1
    buffer_load_dwordx4 a[124:127], v1, s[44:47], s9 offen offset:2048 sc1
    s_add_u32 m0, s83, 0x800
    s_add_u32 s81, s85, 0x164000
    buffer_load_dwordx4 v252, s[36:39], s81 offen lds
    ds_read_b64_tr_b16 a[148:149], v246 offset:0
    ds_read_b64_tr_b16 a[150:151], v246 offset:512
    s_waitcnt lgkmcnt(6)
    v_mfma_f32_32x32x16_bf16 v[64:79], a[136:139], a[76:79], v[64:79]
    s_waitcnt lgkmcnt(4)
    ds_read_b64_tr_b16 a[128:129], v249 offset:2048
    ds_read_b64_tr_b16 a[130:131], v249 offset:2560
    v_mfma_f32_32x32x16_bf16 v[80:95], a[140:143], a[76:79], v[80:95]
    s_add_u32 s9, s88, 0x14000
    buffer_load_dwordx4 a[64:67], v1, s[44:47], s9 offen offset:0 sc1
    buffer_load_dwordx4 a[68:71], v1, s[44:47], s9 offen offset:1024 sc1
    s_add_u32 m0, s83, 0x1000
    s_add_u32 s81, s85, 0x168000
    buffer_load_dwordx4 v252, s[36:39], s81 offen lds
    ds_read_b64_tr_b16 a[132:133], v246 offset:2048
    ds_read_b64_tr_b16 a[134:135], v246 offset:2560
    s_waitcnt vmcnt(20) lgkmcnt(6)
    v_mfma_f32_32x32x16_bf16 v[64:79], a[144:147], a[80:83], v[64:79]
    s_waitcnt lgkmcnt(4)
    ds_read_b64_tr_b16 a[136:137], v249 offset:4096
    ds_read_b64_tr_b16 a[138:139], v249 offset:4608
    v_mfma_f32_32x32x16_bf16 v[80:95], a[148:151], a[80:83], v[80:95]
    buffer_load_dwordx4 a[72:75], v1, s[44:47], s9 offen offset:2048 sc1
    s_add_u32 m0, s83, 0x1800
    s_add_u32 s81, s85, 0x16c000
    buffer_load_dwordx4 v252, s[36:39], s81 offen lds
    ds_read_b64_tr_b16 a[140:141], v246 offset:4096
    ds_read_b64_tr_b16 a[142:143], v246 offset:4608
    s_waitcnt vmcnt(21) lgkmcnt(6)
    v_mfma_f32_32x32x16_bf16 v[64:79], a[128:131], a[84:87], v[64:79]
    s_waitcnt lgkmcnt(4)
    ds_read_b64_tr_b16 a[144:145], v249 offset:6144
    ds_read_b64_tr_b16 a[146:147], v249 offset:6656
    v_mfma_f32_32x32x16_bf16 v[80:95], a[132:135], a[84:87], v[80:95]
    buffer_load_dwordx4 a[76:79], v1, s[44:47], s9 offen offset:3072 sc1
    ds_read_b64_tr_b16 a[148:149], v246 offset:6144
    ds_read_b64_tr_b16 a[150:151], v246 offset:6656
    s_waitcnt vmcnt(20) lgkmcnt(6)
    v_mfma_f32_32x32x16_bf16 v[64:79], a[136:139], a[88:91], v[64:79]
    s_waitcnt lgkmcnt(0)
    s_barrier
    ds_read_b64_tr_b16 a[128:129], v251 offset:49152
    ds_read_b64_tr_b16 a[130:131], v251 offset:49664
    v_mfma_f32_32x32x16_bf16 v[80:95], a[140:143], a[88:91], v[80:95]
    s_nop 0
    s_add_u32 s9, s88, 0x15000
    buffer_load_dwordx4 a[80:83], v1, s[44:47], s9 offen offset:0 sc1
    s_add_u32 m0, s83, 0x4000
    s_add_u32 s81, s85, 0x170000
    buffer_load_dwordx4 v252, s[36:39], s81 offen lds
    ds_read_b64_tr_b16 a[132:133], v248 offset:49152
    ds_read_b64_tr_b16 a[134:135], v248 offset:49664
    s_waitcnt vmcnt(21)
    v_mfma_f32_32x32x16_bf16 v[64:79], a[144:147], a[92:95], v[64:79]
    s_nop 0
    ds_read_b64_tr_b16 a[136:137], v251 offset:51200
    ds_read_b64_tr_b16 a[138:139], v251 offset:51712
    v_mfma_f32_32x32x16_bf16 v[80:95], a[148:151], a[92:95], v[80:95]
    buffer_load_dwordx4 a[84:87], v1, s[44:47], s9 offen offset:1024 sc1
    s_add_u32 m0, s83, 0x4800
    s_add_u32 s81, s85, 0x174000
    buffer_load_dwordx4 v252, s[36:39], s81 offen lds
    ds_read_b64_tr_b16 a[140:141], v248 offset:51200
    ds_read_b64_tr_b16 a[142:143], v248 offset:51712
    s_waitcnt vmcnt(21) lgkmcnt(6)
    v_mfma_f32_32x32x16_bf16 v[64:79], a[128:131], a[96:99], v[64:79]
    s_waitcnt lgkmcnt(4)
    ds_read_b64_tr_b16 a[144:145], v251 offset:53248
    ds_read_b64_tr_b16 a[146:147], v251 offset:53760
    v_mfma_f32_32x32x16_bf16 v[80:95], a[132:135], a[96:99], v[80:95]
    buffer_load_dwordx4 a[88:91], v1, s[44:47], s9 offen offset:2048 sc1
    s_add_u32 m0, s83, 0x5000
    s_add_u32 s81, s85, 0x178000
    buffer_load_dwordx4 v252, s[36:39], s81 offen lds
    ds_read_b64_tr_b16 a[148:149], v248 offset:53248
    ds_read_b64_tr_b16 a[150:151], v248 offset:53760
    s_waitcnt vmcnt(22) lgkmcnt(6)
    v_mfma_f32_32x32x16_bf16 v[64:79], a[136:139], a[100:103], v[64:79]
    s_waitcnt lgkmcnt(4)
    ds_read_b64_tr_b16 a[128:129], v251 offset:55296
    ds_read_b64_tr_b16 a[130:131], v251 offset:55808
    v_mfma_f32_32x32x16_bf16 v[80:95], a[140:143], a[100:103], v[80:95]
    buffer_load_dwordx4 a[92:95], v1, s[44:47], s9 offen offset:3072 sc1
    s_add_u32 m0, s83, 0x5800
    s_add_u32 s81, s85, 0x17c000
    buffer_load_dwordx4 v252, s[36:39], s81 offen lds
    ds_read_b64_tr_b16 a[132:133], v248 offset:55296
    ds_read_b64_tr_b16 a[134:135], v248 offset:55808
    s_waitcnt vmcnt(22) lgkmcnt(6)
    v_mfma_f32_32x32x16_bf16 v[64:79], a[144:147], a[104:107], v[64:79]
    s_waitcnt lgkmcnt(4)
    ds_read_b64_tr_b16 a[136:137], v250 offset:16384
    ds_read_b64_tr_b16 a[138:139], v250 offset:16896
    v_mfma_f32_32x32x16_bf16 v[80:95], a[148:151], a[104:107], v[80:95]
    s_add_u32 s9, s88, 0x16000
    buffer_load_dwordx4 a[96:99], v1, s[44:47], s9 offen offset:0 sc1
    s_add_u32 m0, s83, 0x8000
    s_add_u32 s81, s84, 0x20000
    buffer_load_dwordx4 v252, s[36:39], s81 offen lds
    ds_read_b64_tr_b16 a[140:141], v247 offset:16384
    ds_read_b64_tr_b16 a[142:143], v247 offset:16896
    s_waitcnt vmcnt(23) lgkmcnt(6)
    v_mfma_f32_32x32x16_bf16 v[64:79], a[128:131], a[108:111], v[64:79]
    s_waitcnt lgkmcnt(4)
    ds_read_b64_tr_b16 a[144:145], v250 offset:18432
    ds_read_b64_tr_b16 a[146:147], v250 offset:18944
    v_mfma_f32_32x32x16_bf16 v[80:95], a[132:135], a[108:111], v[80:95]
    buffer_load_dwordx4 a[100:103], v1, s[44:47], s9 offen offset:1024 sc1
    s_add_u32 m0, s83, 0x8800
    s_add_u32 s81, s84, 0x24000
    buffer_load_dwordx4 v252, s[36:39], s81 offen lds
    ds_read_b64_tr_b16 a[148:149], v247 offset:18432
    ds_read_b64_tr_b16 a[150:151], v247 offset:18944
    s_waitcnt vmcnt(23) lgkmcnt(6)
    v_mfma_f32_32x32x16_bf16 v[64:79], a[136:139], a[112:115], v[64:79]
    s_waitcnt lgkmcnt(4)
    ds_read_b64_tr_b16 a[128:129], v250 offset:20480
    ds_read_b64_tr_b16 a[130:131], v250 offset:20992
    v_mfma_f32_32x32x16_bf16 v[80:95], a[140:143], a[112:115], v[80:95]
    buffer_load_dwordx4 a[104:107], v1, s[44:47], s9 offen offset:2048 sc1
    s_add_u32 m0, s83, 0x9000
    s_add_u32 s81, s84, 0x48000
    buffer_load_dwordx4 v252, s[36:39], s81 offen lds
    ds_read_b64_tr_b16 a[132:133], v247 offset:20480
    ds_read_b64_tr_b16 a[134:135], v247 offset:20992
    s_waitcnt vmcnt(24) lgkmcnt(6)
    v_mfma_f32_32x32x16_bf16 v[64:79], a[144:147], a[116:119], v[64:79]
    s_waitcnt lgkmcnt(4)
    ds_read_b64_tr_b16 a[136:137], v250 offset:22528
    ds_read_b64_tr_b16 a[138:139], v250 offset:23040
    s_lshl_b32 s11, s64, 8
    s_add_u32 s11, s11, 0x9000
    v_and_b32_e32 v19, 15, v0
    v_lshlrev_b32_e64 v19, 2, v19
    v_mfma_f32_32x32x16_bf16 v[80:95], a[148:151], a[116:119], v[80:95]
    buffer_load_dwordx4 a[108:111], v1, s[44:47], s9 offen offset:3072 sc1
    s_add_u32 m0, s83, 0x9800
    s_add_u32 s81, s84, 0x4c000
    buffer_load_dwordx4 v252, s[36:39], s81 offen lds
    buffer_load_dword v19, v19, s[44:47], s11 offen sc1
    ds_read_b64_tr_b16 a[140:141], v247 offset:22528
    ds_read_b64_tr_b16 a[142:143], v247 offset:23040
    s_waitcnt vmcnt(25) lgkmcnt(6)
    v_mfma_f32_32x32x16_bf16 v[64:79], a[128:131], a[120:123], v[64:79]
    s_waitcnt lgkmcnt(0)
    s_barrier
    ds_read_b64_tr_b16 a[144:145], v250 offset:49152
    ds_read_b64_tr_b16 a[146:147], v250 offset:49664
    v_lshrrev_b32_e32 v245, 3, v0
    v_lshlrev_b32_e32 v245, 10, v245
    v_and_b32_e32 v20, 7, v0
    v_lshl_add_u32 v245, v20, 4, v245
    s_lshl_b32 s68, s64, 6
    s_lshl_b32 s69, s56, 4
    s_add_u32 s68, s68, s69
    s_lshl_b32 s68, s68, 10
    v_mfma_f32_32x32x16_bf16 v[80:95], a[132:135], a[120:123], v[80:95]
    s_add_u32 s9, s88, 0x17000
    buffer_load_dwordx4 a[112:115], v1, s[44:47], s9 offen offset:0 sc1
    s_add_u32 m0, s83, 0x10000
    s_add_u32 s81, s84, 0x70000
    buffer_load_dwordx4 v252, s[36:39], s81 offen lds
    ds_read_b64_tr_b16 a[148:149], v247 offset:49152
    ds_read_b64_tr_b16 a[150:151], v247 offset:49664
    s_lshl_b32 s69, s65, 7
    s_add_u32 s4, s68, s69
    s_add_u32 s5, s4, 8192
    buffer_load_dwordx4 v[192:195], v245, s[24:27], s4 offen
    buffer_load_dwordx4 v[196:199], v245, s[24:27], s5 offen
    s_waitcnt vmcnt(28)
    v_mfma_f32_32x32x16_bf16 v[64:79], a[136:139], a[124:127], v[64:79]
    s_nop 0
    ds_read_b64_tr_b16 a[128:129], v250 offset:51200
    ds_read_b64_tr_b16 a[130:131], v250 offset:51712
    v_mfma_f32_32x32x16_bf16 v[80:95], a[140:143], a[124:127], v[80:95]
    buffer_load_dwordx4 a[116:119], v1, s[44:47], s9 offen offset:1024 sc1
    s_add_u32 m0, s83, 0x10800
    s_add_u32 s81, s84, 0x74000
    buffer_load_dwordx4 v252, s[36:39], s81 offen lds
    ds_read_b64_tr_b16 a[132:133], v247 offset:51200
    ds_read_b64_tr_b16 a[134:135], v247 offset:51712
    s_waitcnt vmcnt(28) lgkmcnt(6)
    v_mfma_f32_32x32x16_bf16 v[64:79], a[144:147], a[64:67], v[64:79]
    s_waitcnt lgkmcnt(4)
    ds_read_b64_tr_b16 a[136:137], v250 offset:53248
    ds_read_b64_tr_b16 a[138:139], v250 offset:53760
    v_mfma_f32_32x32x16_bf16 v[80:95], a[148:151], a[64:67], v[80:95]
    buffer_load_dwordx4 a[120:123], v1, s[44:47], s9 offen offset:2048 sc1
    ds_read_b64_tr_b16 a[140:141], v247 offset:53248
    ds_read_b64_tr_b16 a[142:143], v247 offset:53760
    s_waitcnt vmcnt(28) lgkmcnt(6)
    v_mfma_f32_32x32x16_bf16 v[64:79], a[128:131], a[68:71], v[64:79]
    s_waitcnt lgkmcnt(4)
    ds_read_b64_tr_b16 a[144:145], v250 offset:55296
    ds_read_b64_tr_b16 a[146:147], v250 offset:55808
    v_mfma_f32_32x32x16_bf16 v[80:95], a[132:135], a[68:71], v[80:95]
    buffer_load_dwordx4 a[124:127], v1, s[44:47], s9 offen offset:3072 sc1
    s_add_u32 m0, s83, 0x11000
    s_add_u32 s81, s84, 0x98000
    buffer_load_dwordx4 v252, s[36:39], s81 offen lds
    ds_read_b64_tr_b16 a[148:149], v247 offset:55296
    ds_read_b64_tr_b16 a[150:151], v247 offset:55808
    s_waitcnt vmcnt(28) lgkmcnt(6)
    v_mfma_f32_32x32x16_bf16 v[64:79], a[136:139], a[72:75], v[64:79]
    s_waitcnt lgkmcnt(4)
    ds_read_b64_tr_b16 a[128:129], v249 offset:16384
    ds_read_b64_tr_b16 a[130:131], v249 offset:16896
    v_mfma_f32_32x32x16_bf16 v[80:95], a[140:143], a[72:75], v[80:95]
    s_waitcnt vmcnt(9)
    v_cmp_ne_u32 vcc, s67, v19
    s_nop 1
    s_cmp_lg_u64 vcc, 0
    s_cbranch_scc1 L_slow_28
L_back_29:
    s_add_u32 s9, s87, 0x2000
    buffer_load_dwordx4 a[64:67], v1, s[44:47], s9 offen offset:0 sc1
    s_add_u32 m0, s83, 0x11800
    s_add_u32 s81, s84, 0x9c000
    buffer_load_dwordx4 v252, s[36:39], s81 offen lds
    ds_read_b64_tr_b16 a[132:133], v246 offset:16384
    ds_read_b64_tr_b16 a[134:135], v246 offset:16896
    s_waitcnt lgkmcnt(6)
    v_mfma_f32_32x32x16_bf16 v[64:79], a[144:147], a[76:79], v[64:79]
    s_waitcnt lgkmcnt(4)
    ds_read_b64_tr_b16 a[136:137], v249 offset:18432
    ds_read_b64_tr_b16 a[138:139], v249 offset:18944
    v_mfma_f32_32x32x16_bf16 v[80:95], a[148:151], a[76:79], v[80:95]
    buffer_load_dwordx4 a[68:71], v1, s[44:47], s9 offen offset:1024 sc1
    s_add_u32 m0, s83, 0x18000
    s_add_u32 s81, s86, 0x0
    buffer_load_dwordx4 v252, s[40:43], s81 offen lds
    ds_read_b64_tr_b16 a[140:141], v246 offset:18432
    ds_read_b64_tr_b16 a[142:143], v246 offset:18944
    s_waitcnt lgkmcnt(6)
    v_mfma_f32_32x32x16_bf16 v[64:79], a[128:131], a[80:83], v[64:79]
    s_waitcnt lgkmcnt(4)
    ds_read_b64_tr_b16 a[144:145], v249 offset:20480
    ds_read_b64_tr_b16 a[146:147], v249 offset:20992
    v_mfma_f32_32x32x16_bf16 v[80:95], a[132:135], a[80:83], v[80:95]
    s_add_u32 s9, s87, 0x4800
    buffer_load_dwordx4 a[72:75], v1, s[44:47], s9 offen offset:0 sc1
    s_add_u32 m0, s83, 0x18800
    s_add_u32 s81, s86, 0x4000
    buffer_load_dwordx4 v252, s[40:43], s81 offen lds
    ds_read_b64_tr_b16 a[148:149], v246 offset:20480
    ds_read_b64_tr_b16 a[150:151], v246 offset:20992
    s_waitcnt lgkmcnt(6)
    v_mfma_f32_32x32x16_bf16 v[64:79], a[136:139], a[84:87], v[64:79]
    s_waitcnt lgkmcnt(4)
    ds_read_b64_tr_b16 a[128:129], v249 offset:22528
    ds_read_b64_tr_b16 a[130:131], v249 offset:23040
    s_lshl_b32 s11, s64, 8
    s_add_u32 s11, s11, 0x5000
    v_and_b32_e32 v19, 15, v0
    v_lshlrev_b32_e64 v19, 2, v19
    v_mfma_f32_32x32x16_bf16 v[80:95], a[140:143], a[84:87], v[80:95]
    buffer_load_dwordx4 a[76:79], v1, s[44:47], s9 offen offset:1024 sc1
    s_add_u32 m0, s83, 0x19000
    s_add_u32 s81, s86, 0x8000
    buffer_load_dwordx4 v252, s[40:43], s81 offen lds
    buffer_load_dword v19, v19, s[44:47], s11 offen sc1
    ds_read_b64_tr_b16 a[132:133], v246 offset:22528
    ds_read_b64_tr_b16 a[134:135], v246 offset:23040
    s_waitcnt lgkmcnt(6)
    v_mfma_f32_32x32x16_bf16 v[64:79], a[144:147], a[88:91], v[64:79]
    s_waitcnt lgkmcnt(0)
    s_barrier
    ds_read_b64_tr_b16 a[136:137], v251 offset:0
    ds_read_b64_tr_b16 a[138:139], v251 offset:512
    v_mfma_f32_32x32x16_bf16 v[80:95], a[148:151], a[88:91], v[80:95]
    s_nop 0
    s_add_u32 s9, s87, 0x7000
    buffer_load_dwordx4 a[80:83], v1, s[44:47], s9 offen offset:0 sc1
    s_add_u32 m0, s83, 0x19800
    s_add_u32 s81, s86, 0xc000
    buffer_load_dwordx4 v252, s[40:43], s81 offen lds
    ds_read_b64_tr_b16 a[140:141], v248 offset:0
    ds_read_b64_tr_b16 a[142:143], v248 offset:512
    v_mfma_f32_32x32x16_bf16 v[64:79], a[128:131], a[92:95], v[64:79]
    ds_read_b64_tr_b16 a[144:145], v251 offset:2048
    ds_read_b64_tr_b16 a[146:147], v251 offset:2560
    v_mfma_f32_32x32x16_bf16 v[80:95], a[132:135], a[92:95], v[80:95]
    buffer_load_dwordx4 a[84:87], v1, s[44:47], s9 offen offset:1024 sc1
    s_add_u32 m0, s83, 0x20000
    s_add_u32 s81, s86, 0x10000
    buffer_load_dwordx4 v252, s[40:43], s81 offen lds
    ds_read_b64_tr_b16 a[148:149], v248 offset:2048
    ds_read_b64_tr_b16 a[150:151], v248 offset:2560
    s_waitcnt lgkmcnt(6)
    v_mfma_f32_32x32x16_bf16 v[64:79], a[136:139], a[96:99], v[64:79]
    s_waitcnt lgkmcnt(4)
    ds_read_b64_tr_b16 a[128:129], v251 offset:4096
    ds_read_b64_tr_b16 a[130:131], v251 offset:4608
    v_mfma_f32_32x32x16_bf16 v[80:95], a[140:143], a[96:99], v[80:95]
    s_add_u32 s9, s87, 0x9800
    buffer_load_dwordx4 a[88:91], v1, s[44:47], s9 offen offset:0 sc1
    s_add_u32 m0, s83, 0x20800
    s_add_u32 s81, s86, 0x14000
    buffer_load_dwordx4 v252, s[40:43], s81 offen lds
    ds_read_b64_tr_b16 a[132:133], v248 offset:4096
    ds_read_b64_tr_b16 a[134:135], v248 offset:4608
    s_waitcnt lgkmcnt(6)
    v_mfma_f32_32x32x16_bf16 v[64:79], a[144:147], a[100:103], v[64:79]
    s_waitcnt lgkmcnt(4)
    ds_read_b64_tr_b16 a[136:137], v251 offset:6144
    ds_read_b64_tr_b16 a[138:139], v251 offset:6656
    v_mfma_f32_32x32x16_bf16 v[80:95], a[148:151], a[100:103], v[80:95]
    buffer_load_dwordx4 a[92:95], v1, s[44:47], s9 offen offset:1024 sc1
    s_add_u32 m0, s83, 0x21000
    s_add_u32 s81, s86, 0x18000
    buffer_load_dwordx4 v252, s[40:43], s81 offen lds
    ds_read_b64_tr_b16 a[140:141], v248 offset:6144
    ds_read_b64_tr_b16 a[142:143], v248 offset:6656
    s_waitcnt lgkmcnt(6)
    v_mfma_f32_32x32x16_bf16 v[64:79], a[128:131], a[104:107], v[64:79]
    s_waitcnt lgkmcnt(4)
    ds_read_b64_tr_b16 a[144:145], v251 offset:16384
    ds_read_b64_tr_b16 a[146:147], v251 offset:16896
    v_mfma_f32_32x32x16_bf16 v[80:95], a[132:135], a[104:107], v[80:95]
    s_waitcnt vmcnt(8)
    v_cmp_ne_u32 vcc, s67, v19
    s_nop 1
    s_cmp_lg_u64 vcc, 0
    s_cbranch_scc1 L_slow_31
L_back_32:
    s_add_u32 s9, s89, 0x0
    buffer_load_dwordx4 a[96:99], v1, s[44:47], s9 offen offset:0 sc1
    s_add_u32 m0, s83, 0x21800
    s_add_u32 s81, s86, 0x1c000
    buffer_load_dwordx4 v252, s[40:43], s81 offen lds
    ds_read_b64_tr_b16 a[148:149], v248 offset:16384
    ds_read_b64_tr_b16 a[150:151], v248 offset:16896
    s_waitcnt lgkmcnt(6)
    v_mfma_f32_32x32x16_bf16 v[64:79], a[136:139], a[108:111], v[64:79]
    s_waitcnt lgkmcnt(4)
    ds_read_b64_tr_b16 a[128:129], v251 offset:18432
    ds_read_b64_tr_b16 a[130:131], v251 offset:18944
    v_mfma_f32_32x32x16_bf16 v[80:95], a[140:143], a[108:111], v[80:95]
    buffer_load_dwordx4 a[100:103], v1, s[44:47], s9 offen offset:1024 sc1
    ds_read_b64_tr_b16 a[132:133], v248 offset:18432
    ds_read_b64_tr_b16 a[134:135], v248 offset:18944
    s_waitcnt lgkmcnt(6)
    v_mfma_f32_32x32x16_bf16 v[64:79], a[144:147], a[112:115], v[64:79]
    s_waitcnt lgkmcnt(4)
    ds_read_b64_tr_b16 a[136:137], v251 offset:20480
    ds_read_b64_tr_b16 a[138:139], v251 offset:20992
    v_lshlrev_b32_e64 v32, 16, v192
    v_and_b32_e32 v33, 0xffff0000, v192
    v_lshlrev_b32_e64 v34, 16, v193
    v_and_b32_e32 v35, 0xffff0000, v193
    v_lshlrev_b32_e64 v36, 16, v194
    v_and_b32_e32 v37, 0xffff0000, v194
    v_lshlrev_b32_e64 v38, 16, v195
    v_mfma_f32_32x32x16_bf16 v[80:95], a[148:151], a[112:115], v[80:95]
    buffer_load_dwordx4 a[104:107], v1, s[44:47], s9 offen offset:2048 sc1
    s_add_u32 m0, s83, 0xc000
    s_add_u32 s81, s86, 0x20000
    buffer_load_dwordx4 v252, s[40:43], s81 offen lds
    ds_read_b64_tr_b16 a[140:141], v248 offset:20480
    ds_read_b64_tr_b16 a[142:143], v248 offset:20992
    v_and_b32_e32 v39, 0xffff0000, v195
    v_lshlrev_b32_e64 v40, 16, v196
    v_and_b32_e32 v41, 0xffff0000, v196
    v_lshlrev_b32_e64 v42, 16, v197
    v_and_b32_e32 v43, 0xffff0000, v197
    v_lshlrev_b32_e64 v44, 16, v198
    v_and_b32_e32 v45, 0xffff0000, v198
    v_lshlrev_b32_e64 v46, 16, v199
    v_and_b32_e32 v47, 0xffff0000, v199
    s_waitcnt lgkmcnt(6)
    v_mfma_f32_32x32x16_bf16 v[64:79], a[128:131], a[116:119], v[64:79]
    s_waitcnt lgkmcnt(4)
    ds_read_b64_tr_b16 a[144:145], v251 offset:22528
    ds_read_b64_tr_b16 a[146:147], v251 offset:23040
    v_mfma_f32_32x32x16_bf16 v[80:95], a[132:135], a[116:119], v[80:95]
    buffer_load_dwordx4 a[108:111], v1, s[44:47], s9 offen offset:3072 sc1
    s_add_u32 m0, s83, 0xc800
    s_add_u32 s81, s86, 0x24000
    buffer_load_dwordx4 v252, s[40:43], s81 offen lds
    ds_read_b64_tr_b16 a[148:149], v248 offset:22528
    ds_read_b64_tr_b16 a[150:151], v248 offset:23040
    s_waitcnt lgkmcnt(6)
    v_mfma_f32_32x32x16_bf16 v[64:79], a[136:139], a[120:123], v[64:79]
    s_waitcnt lgkmcnt(0)
    s_barrier
    ds_read_b64_tr_b16 a[128:129], v251 offset:32768
    ds_read_b64_tr_b16 a[130:131], v251 offset:33280
    v_mfma_f32_32x32x16_bf16 v[80:95], a[140:143], a[120:123], v[80:95]
    s_nop 0
    s_add_u32 s9, s89, 0x1000
    buffer_load_dwordx4 a[112:115], v1, s[44:47], s9 offen offset:0 sc1
    s_add_u32 m0, s83, 0xd000
    s_add_u32 s81, s86, 0x28000
    buffer_load_dwordx4 v252, s[40:43], s81 offen lds
    ds_read_b64_tr_b16 a[132:133], v248 offset:32768
    ds_read_b64_tr_b16 a[134:135], v248 offset:33280
    v_mfma_f32_32x32x16_bf16 v[64:79], a[144:147], a[124:127], v[64:79]
    ds_read_b64_tr_b16 a[136:137], v251 offset:34816
    ds_read_b64_tr_b16 a[138:139], v251 offset:35328
    v_mfma_f32_32x32x16_bf16 v[80:95], a[148:151], a[124:127], v[80:95]
    buffer_load_dwordx4 a[116:119], v1, s[44:47], s9 offen offset:1024 sc1
    s_add_u32 m0, s83, 0xd800
    s_add_u32 s81, s86, 0x2c000
    buffer_load_dwordx4 v252, s[40:43], s81 offen lds
    ds_read_b64_tr_b16 a[140:141], v248 offset:34816
    ds_read_b64_tr_b16 a[142:143], v248 offset:35328
    s_waitcnt lgkmcnt(6)
    v_mfma_f32_32x32x16_bf16 v[64:79], a[128:131], a[64:67], v[64:79]
    s_waitcnt lgkmcnt(4)
    ds_read_b64_tr_b16 a[144:145], v251 offset:36864
    ds_read_b64_tr_b16 a[146:147], v251 offset:37376
    v_add_u32_e64 v244, s74, v1
    v_add_u32_e32 v244, 0x1c000, v244
    s_xor_b32 s68, s74, 0x2000
    v_add_u32_e64 v243, s68, v1
    v_add_u32_e32 v243, 0x1c000, v243
    v_and_b32_e32 v20, 31, v0
    v_lshlrev_b32_e32 v21, 1, v20
    v_add_u32_e32 v21, s57, v21
    v_lshlrev_b32_e32 v21, 7, v21
    v_lshrrev_b32_e64 v22, 5, v0
    v_lshl_add_u32 v21, v22, 3, v21
    v_and_b32_e32 v20, 7, v20
    s_lshl_b32 s68, s66, 2
    v_xor_b32_e32 v20, s68, v20
    v_xor_b32_e32 v22, 0, v20
    v_lshl_add_u32 v224, v22, 4, v21
    v_xor_b32_e64 v22, 1, v20
    v_lshl_add_u32 v225, v22, 4, v21
    v_mfma_f32_32x32x16_bf16 v[80:95], a[132:135], a[64:67], v[80:95]
    buffer_load_dwordx4 a[120:123], v1, s[44:47], s9 offen offset:2048 sc1
    s_add_u32 m0, s83, 0x14000
    s_add_u32 s81, s86, 0x30000
    buffer_load_dwordx4 v252, s[40:43], s81 offen lds
    ds_read_b64_tr_b16 a[148:149], v248 offset:36864
    ds_read_b64_tr_b16 a[150:151], v248 offset:37376
    v_xor_b32_e64 v22, 2, v20
    v_lshl_add_u32 v226, v22, 4, v21
    v_xor_b32_e64 v22, 3, v20
    v_lshl_add_u32 v227, v22, 4, v21
    v_lshrrev_b32_e32 v20, 3, v0
    s_lshl_b32 s68, s56, 4
    v_add_u32_e32 v20, s68, v20
    v_and_b32_e32 v21, 7, v0
    v_add_u32_e64 v22, 0, v20
    v_bfe_u32 v23, v22, 1, 3
    v_xor_b32_e32 v23, v23, v21
    v_lshlrev_b32_e32 v22, 7, v22
    v_lshl_add_u32 v228, v23, 4, v22
    v_add_u32_e64 v22, 8, v20
    v_bfe_u32 v23, v22, 1, 3
    v_xor_b32_e32 v23, v23, v21
    v_lshlrev_b32_e32 v22, 7, v22
    v_lshl_add_u32 v229, v23, 4, v22
    s_waitcnt lgkmcnt(6)
    v_mfma_f32_32x32x16_bf16 v[64:79], a[136:139], a[68:71], v[64:79]
    s_waitcnt lgkmcnt(4)
    ds_read_b64_tr_b16 a[128:129], v251 offset:38912
    ds_read_b64_tr_b16 a[130:131], v251 offset:39424
    v_mfma_f32_32x32x16_bf16 v[80:95], a[140:143], a[68:71], v[80:95]
    buffer_load_dwordx4 a[124:127], v1, s[44:47], s9 offen offset:3072 sc1
    s_add_u32 m0, s83, 0x14800
    s_add_u32 s81, s86, 0x34000
    buffer_load_dwordx4 v252, s[40:43], s81 offen lds
    ds_read_b64_tr_b16 a[132:133], v248 offset:38912
    ds_read_b64_tr_b16 a[134:135], v248 offset:39424
    s_waitcnt lgkmcnt(6)
    v_mfma_f32_32x32x16_bf16 v[64:79], a[144:147], a[72:75], v[64:79]
    s_waitcnt lgkmcnt(4)
    ds_read_b64_tr_b16 a[136:137], v250 offset:0
    ds_read_b64_tr_b16 a[138:139], v250 offset:512
    v_mfma_f32_32x32x16_bf16 v[80:95], a[148:151], a[72:75], v[80:95]
    s_add_u32 s9, s89, 0x2000
    buffer_load_dwordx4 a[64:67], v1, s[44:47], s9 offen offset:0 sc1
    s_add_u32 m0, s83, 0x15000
    s_add_u32 s81, s86, 0x38000
    buffer_load_dwordx4 v252, s[40:43], s81 offen lds
    ds_read_b64_tr_b16 a[140:141], v247 offset:0
    ds_read_b64_tr_b16 a[142:143], v247 offset:512
    s_waitcnt lgkmcnt(6)
    v_mfma_f32_32x32x16_bf16 v[64:79], a[128:131], a[76:79], v[64:79]
    s_waitcnt lgkmcnt(4)
    ds_read_b64_tr_b16 a[144:145], v250 offset:2048
    ds_read_b64_tr_b16 a[146:147], v250 offset:2560
    v_mfma_f32_32x32x16_bf16 v[80:95], a[132:135], a[76:79], v[80:95]
    buffer_load_dwordx4 a[68:71], v1, s[44:47], s9 offen offset:1024 sc1
    s_add_u32 m0, s83, 0x15800
    s_add_u32 s81, s86, 0x3c000
    buffer_load_dwordx4 v252, s[40:43], s81 offen lds
    ds_read_b64_tr_b16 a[148:149], v247 offset:2048
    ds_read_b64_tr_b16 a[150:151], v247 offset:2560
    s_waitcnt vmcnt(26) lgkmcnt(6)
    v_mfma_f32_32x32x16_bf16 v[64:79], a[136:139], a[80:83], v[64:79]
    s_waitcnt lgkmcnt(4)
    ds_read_b64_tr_b16 a[128:129], v250 offset:4096
    ds_read_b64_tr_b16 a[130:131], v250 offset:4608
    v_mfma_f32_32x32x16_bf16 v[80:95], a[140:143], a[80:83], v[80:95]
    buffer_load_dwordx4 a[72:75], v1, s[44:47], s9 offen offset:2048 sc1
    ds_read_b64_tr_b16 a[132:133], v247 offset:4096
    ds_read_b64_tr_b16 a[134:135], v247 offset:4608
    s_waitcnt vmcnt(25) lgkmcnt(6)
    v_mfma_f32_32x32x16_bf16 v[64:79], a[144:147], a[84:87], v[64:79]
    s_waitcnt lgkmcnt(4)
    ds_read_b64_tr_b16 a[136:137], v250 offset:6144
    ds_read_b64_tr_b16 a[138:139], v250 offset:6656
    v_mfma_f32_32x32x16_bf16 v[80:95], a[148:151], a[84:87], v[80:95]
    buffer_load_dwordx4 a[76:79], v1, s[44:47], s9 offen offset:3072 sc1
    ds_read_b64_tr_b16 a[140:141], v247 offset:6144
    ds_read_b64_tr_b16 a[142:143], v247 offset:6656
    s_waitcnt vmcnt(24) lgkmcnt(6)
    v_mfma_f32_32x32x16_bf16 v[64:79], a[128:131], a[88:91], v[64:79]
    s_waitcnt vmcnt(19) lgkmcnt(0)
    s_barrier
    ds_read_b64_tr_b16 a[144:145], v250 offset:32768
    ds_read_b64_tr_b16 a[146:147], v250 offset:33280
    v_mfma_f32_32x32x16_bf16 v[80:95], a[132:135], a[88:91], v[80:95]
    s_nop 0
    s_add_u32 s9, s89, 0x3000
    buffer_load_dwordx4 a[80:83], v1, s[44:47], s9 offen offset:0 sc1
    ds_read_b64_tr_b16 a[148:149], v247 offset:32768
    ds_read_b64_tr_b16 a[150:151], v247 offset:33280
    v_mfma_f32_32x32x16_bf16 v[64:79], a[136:139], a[92:95], v[64:79]
    ds_read_b64_tr_b16 a[128:129], v250 offset:34816
    ds_read_b64_tr_b16 a[130:131], v250 offset:35328
    v_mfma_f32_32x32x16_bf16 v[80:95], a[140:143], a[92:95], v[80:95]
    buffer_load_dwordx4 a[84:87], v1, s[44:47], s9 offen offset:1024 sc1
    ds_read_b64_tr_b16 a[132:133], v247 offset:34816
    ds_read_b64_tr_b16 a[134:135], v247 offset:35328
    s_waitcnt lgkmcnt(6)
    v_mfma_f32_32x32x16_bf16 v[96:111], a[144:147], a[96:99], 0
    s_waitcnt lgkmcnt(4)
    ds_read_b64_tr_b16 a[136:137], v250 offset:36864
    ds_read_b64_tr_b16 a[138:139], v250 offset:37376
    v_mfma_f32_32x32x16_bf16 v[112:127], a[148:151], a[96:99], 0
    buffer_load_dwordx4 a[88:91], v1, s[44:47], s9 offen offset:2048 sc1
    ds_read_b64_tr_b16 a[140:141], v247 offset:36864
    ds_read_b64_tr_b16 a[142:143], v247 offset:37376
    s_waitcnt vmcnt(21) lgkmcnt(6)
    v_mfma_f32_32x32x16_bf16 v[96:111], a[128:131], a[100:103], v[96:111]
    s_waitcnt lgkmcnt(4)
    ds_read_b64_tr_b16 a[144:145], v250 offset:38912
    ds_read_b64_tr_b16 a[146:147], v250 offset:39424
    ds_write_b128 v244, v[80:83] offset:0
    ds_write_b128 v244, v[84:87] offset:1024
    v_mfma_f32_32x32x16_bf16 v[112:127], a[132:135], a[100:103], v[112:127]
    buffer_load_dwordx4 a[92:95], v1, s[44:47], s9 offen offset:3072 sc1
    ds_read_b64_tr_b16 a[148:149], v247 offset:38912
    ds_read_b64_tr_b16 a[150:151], v247 offset:39424
    s_waitcnt vmcnt(21) lgkmcnt(8)
    v_mfma_f32_32x32x16_bf16 v[96:111], a[136:139], a[104:107], v[96:111]
    s_waitcnt lgkmcnt(6)
    ds_read_b64_tr_b16 a[128:129], v249 offset:0
    ds_read_b64_tr_b16 a[130:131], v249 offset:512
    ds_write_b128 v244, v[88:91] offset:2048
    ds_write_b128 v244, v[92:95] offset:3072
    v_mfma_f32_32x32x16_bf16 v[112:127], a[140:143], a[104:107], v[112:127]
    ds_read_b64_tr_b16 a[132:133], v246 offset:0
    ds_read_b64_tr_b16 a[134:135], v246 offset:512
    s_waitcnt vmcnt(19) lgkmcnt(10)
    v_mfma_f32_32x32x16_bf16 v[96:111], a[144:147], a[108:111], v[96:111]
    s_waitcnt lgkmcnt(6)
    ds_read_b64_tr_b16 a[136:137], v249 offset:2048
    ds_read_b64_tr_b16 a[138:139], v249 offset:2560
    v_mfma_f32_32x32x16_bf16 v[112:127], a[148:151], a[108:111], v[112:127]
    ds_read_b64_tr_b16 a[140:141], v246 offset:2048
    ds_read_b64_tr_b16 a[142:143], v246 offset:2560
    s_waitcnt vmcnt(17) lgkmcnt(8)
    v_mfma_f32_32x32x16_bf16 v[96:111], a[128:131], a[112:115], v[96:111]
    s_waitcnt lgkmcnt(4)
    ds_read_b64_tr_b16 a[144:145], v249 offset:4096
    ds_read_b64_tr_b16 a[146:147], v249 offset:4608
    v_mfma_f32_32x32x16_bf16 v[112:127], a[132:135], a[112:115], v[112:127]
    ds_read_b64_tr_b16 a[148:149], v246 offset:4096
    ds_read_b64_tr_b16 a[150:151], v246 offset:4608
    s_waitcnt vmcnt(15) lgkmcnt(6)
    v_mfma_f32_32x32x16_bf16 v[96:111], a[136:139], a[116:119], v[96:111]
    s_waitcnt lgkmcnt(4)
    ds_read_b64_tr_b16 a[128:129], v249 offset:6144
    ds_read_b64_tr_b16 a[130:131], v249 offset:6656
    v_mfma_f32_32x32x16_bf16 v[112:127], a[140:143], a[116:119], v[112:127]
    ds_read_b64_tr_b16 a[132:133], v246 offset:6144
    ds_read_b64_tr_b16 a[134:135], v246 offset:6656
    s_waitcnt vmcnt(13) lgkmcnt(6)
    v_mfma_f32_32x32x16_bf16 v[96:111], a[144:147], a[120:123], v[96:111]
    s_waitcnt vmcnt(6) lgkmcnt(0)
    s_barrier
    ds_read_b64_tr_b16 a[136:137], v251 offset:49152
    ds_read_b64_tr_b16 a[138:139], v251 offset:49664
    ds_read_b128 v[208:211], v243 offset:0
    ds_read_b128 v[212:215], v243 offset:1024
    ds_read_b128 v[216:219], v243 offset:2048
    v_mfma_f32_32x32x16_bf16 v[112:127], a[148:151], a[120:123], v[112:127]
    s_nop 0
    ds_read_b64_tr_b16 a[140:141], v248 offset:49152
    ds_read_b64_tr_b16 a[142:143], v248 offset:49664
    ds_read_b128 v[220:223], v243 offset:3072
    v_mfma_f32_32x32x16_bf16 v[96:111], a[128:131], a[124:127], v[96:111]
    ds_read_b64_tr_b16 a[144:145], v251 offset:51200
    ds_read_b64_tr_b16 a[146:147], v251 offset:51712
    s_waitcnt lgkmcnt(2)
    s_mov_b32 s6, 0xbfb8aa3b
    v_add_f32_e32 v64, v64, v208
    v_add_f32_e32 v65, v65, v209
    v_mul_f32_e32 v20, s6, v64
    v_mul_f32_e32 v21, s6, v65
    v_exp_f32_e32 v20, v20
    v_mfma_f32_32x32x16_bf16 v[112:127], a[132:135], a[124:127], v[112:127]
    ds_read_b64_tr_b16 a[148:149], v248 offset:51200
    ds_read_b64_tr_b16 a[150:151], v248 offset:51712
    v_exp_f32_e32 v21, v21
    s_nop 0
    v_add_f32_e32 v20, 1.0, v20
    v_add_f32_e32 v21, 1.0, v21
    v_rcp_f32_e32 v20, v20
    v_rcp_f32_e32 v21, v21
    s_nop 0
    v_mul_f32_e32 v64, v64, v20
    v_mfma_f32_32x32x16_bf16 v[96:111], a[136:139], a[64:67], v[96:111]
    ds_read_b64_tr_b16 a[128:129], v251 offset:53248
    ds_read_b64_tr_b16 a[130:131], v251 offset:53760
    v_mul_f32_e32 v65, v65, v21
    v_add_f32_e32 v66, v66, v210
    v_add_f32_e32 v67, v67, v211
    v_mul_f32_e32 v20, s6, v66
    v_mul_f32_e32 v21, s6, v67
    v_exp_f32_e32 v20, v20
    v_mfma_f32_32x32x16_bf16 v[112:127], a[140:143], a[64:67], v[112:127]
    ds_read_b64_tr_b16 a[132:133], v248 offset:53248
    ds_read_b64_tr_b16 a[134:135], v248 offset:53760
    v_exp_f32_e32 v21, v21
    s_nop 0
    v_add_f32_e32 v20, 1.0, v20
    v_add_f32_e32 v21, 1.0, v21
    v_rcp_f32_e32 v20, v20
    v_rcp_f32_e32 v21, v21
    s_nop 0
    v_mul_f32_e32 v66, v66, v20
    v_mul_f32_e64 v67, v67, v21
    s_waitcnt lgkmcnt(6)
    v_mfma_f32_32x32x16_bf16 v[96:111], a[144:147], a[68:71], v[96:111]
    s_waitcnt lgkmcnt(4)
    ds_read_b64_tr_b16 a[136:137], v251 offset:55296
    ds_read_b64_tr_b16 a[138:139], v251 offset:55808
    v_add_f32_e32 v68, v68, v212
    v_add_f32_e32 v69, v69, v213
    v_mul_f32_e32 v20, s6, v68
    v_mul_f32_e32 v21, s6, v69
    v_exp_f32_e64 v20, v20
    v_exp_f32_e32 v21, v21
    s_nop 0
    v_mfma_f32_32x32x16_bf16 v[112:127], a[148:151], a[68:71], v[112:127]
    ds_read_b64_tr_b16 a[140:141], v248 offset:55296
    ds_read_b64_tr_b16 a[142:143], v248 offset:55808
    v_add_f32_e32 v20, 1.0, v20
    v_add_f32_e32 v21, 1.0, v21
    v_rcp_f32_e32 v20, v20
    v_rcp_f32_e32 v21, v21
    s_nop 0
    v_mul_f32_e32 v68, v68, v20
    v_mul_f32_e32 v69, v69, v21
    v_add_f32_e32 v70, v70, v214
    s_waitcnt vmcnt(5) lgkmcnt(6)
    v_mfma_f32_32x32x16_bf16 v[96:111], a[128:131], a[72:75], v[96:111]
    s_waitcnt lgkmcnt(4)
    ds_read_b64_tr_b16 a[144:145], v250 offset:16384
    ds_read_b64_tr_b16 a[146:147], v250 offset:16896
    v_add_f32_e32 v71, v71, v215
    v_mul_f32_e32 v20, s6, v70
    v_mul_f32_e32 v21, s6, v71
    v_exp_f32_e32 v20, v20
    v_exp_f32_e32 v21, v21
    s_nop 0
    v_add_f32_e64 v20, 1.0, v20
    v_mfma_f32_32x32x16_bf16 v[112:127], a[132:135], a[72:75], v[112:127]
    ds_read_b64_tr_b16 a[148:149], v247 offset:16384
    ds_read_b64_tr_b16 a[150:151], v247 offset:16896
    v_add_f32_e32 v21, 1.0, v21
    v_rcp_f32_e32 v20, v20
    v_rcp_f32_e32 v21, v21
    s_nop 0
    v_mul_f32_e32 v70, v70, v20
    v_mul_f32_e32 v71, v71, v21
    v_add_f32_e32 v72, v72, v216
    v_add_f32_e32 v73, v73, v217
    s_waitcnt vmcnt(4) lgkmcnt(6)
    v_mfma_f32_32x32x16_bf16 v[96:111], a[136:139], a[76:79], v[96:111]
    s_waitcnt lgkmcnt(4)
    ds_read_b64_tr_b16 a[128:129], v250 offset:18432
    ds_read_b64_tr_b16 a[130:131], v250 offset:18944
    v_mul_f32_e32 v20, s6, v72
    v_mul_f32_e32 v21, s6, v73
    v_exp_f32_e32 v20, v20
    v_exp_f32_e32 v21, v21
    s_nop 0
    v_add_f32_e32 v20, 1.0, v20
    v_add_f32_e64 v21, 1.0, v21
    v_mfma_f32_32x32x16_bf16 v[112:127], a[140:143], a[76:79], v[112:127]
    ds_read_b64_tr_b16 a[132:133], v247 offset:18432
    ds_read_b64_tr_b16 a[134:135], v247 offset:18944
    v_rcp_f32_e32 v20, v20
    v_rcp_f32_e32 v21, v21
    s_nop 0
    v_mul_f32_e32 v72, v72, v20
    v_mul_f32_e32 v73, v73, v21
    v_add_f32_e32 v74, v74, v218
    v_add_f32_e32 v75, v75, v219
    v_mul_f32_e32 v20, s6, v74
    s_waitcnt vmcnt(3) lgkmcnt(6)
    v_mfma_f32_32x32x16_bf16 v[96:111], a[144:147], a[80:83], v[96:111]
    s_waitcnt lgkmcnt(4)
    ds_read_b64_tr_b16 a[136:137], v250 offset:20480
    ds_read_b64_tr_b16 a[138:139], v250 offset:20992
    v_mul_f32_e32 v21, s6, v75
    v_exp_f32_e32 v20, v20
    v_exp_f32_e32 v21, v21
    s_nop 0
    v_add_f32_e32 v20, 1.0, v20
    v_add_f32_e32 v21, 1.0, v21
    v_mfma_f32_32x32x16_bf16 v[112:127], a[148:151], a[80:83], v[112:127]
    ds_read_b64_tr_b16 a[140:141], v247 offset:20480
    ds_read_b64_tr_b16 a[142:143], v247 offset:20992
    v_rcp_f32_e32 v20, v20
    v_rcp_f32_e32 v21, v21
    s_nop 0
    v_mul_f32_e32 v74, v74, v20
    v_mul_f32_e32 v75, v75, v21
    v_add_f32_e32 v76, v76, v220
    v_add_f32_e32 v77, v77, v221
    v_mul_f32_e32 v20, s6, v76
    v_mul_f32_e64 v21, s6, v77
    s_waitcnt vmcnt(2) lgkmcnt(6)
    v_mfma_f32_32x32x16_bf16 v[96:111], a[128:131], a[84:87], v[96:111]
    s_waitcnt lgkmcnt(4)
    ds_read_b64_tr_b16 a[144:145], v250 offset:22528
    ds_read_b64_tr_b16 a[146:147], v250 offset:23040
    v_exp_f32_e32 v20, v20
    v_exp_f32_e32 v21, v21
    s_nop 0
    v_add_f32_e32 v20, 1.0, v20
    v_add_f32_e32 v21, 1.0, v21
    v_rcp_f32_e32 v20, v20
    v_mfma_f32_32x32x16_bf16 v[112:127], a[132:135], a[84:87], v[112:127]
    ds_read_b64_tr_b16 a[148:149], v247 offset:22528
    ds_read_b64_tr_b16 a[150:151], v247 offset:23040
    v_rcp_f32_e32 v21, v21
    s_nop 0
    v_mul_f32_e32 v76, v76, v20
    v_mul_f32_e32 v77, v77, v21
    v_add_f32_e32 v78, v78, v222
    v_add_f32_e32 v79, v79, v223
    v_mul_f32_e32 v20, s6, v78
    v_mul_f32_e32 v21, s6, v79
    v_exp_f32_e32 v20, v20
    s_waitcnt vmcnt(1) lgkmcnt(6)
    v_mfma_f32_32x32x16_bf16 v[96:111], a[136:139], a[88:91], v[96:111]
    s_waitcnt lgkmcnt(4)
    v_exp_f32_e32 v21, v21
    s_nop 0
    v_add_f32_e32 v20, 1.0, v20
    v_add_f32_e64 v21, 1.0, v21
    v_mfma_f32_32x32x16_bf16 v[112:127], a[140:143], a[88:91], v[112:127]
    v_rcp_f32_e32 v20, v20
    v_rcp_f32_e32 v21, v21
    s_nop 0
    v_mul_f32_e32 v78, v78, v20
    v_mul_f32_e32 v79, v79, v21
    s_waitcnt vmcnt(0) lgkmcnt(0)
    v_mfma_f32_32x32x16_bf16 v[112:127], a[148:151], a[92:95], v[112:127]
    v_mfma_f32_32x32x16_bf16 v[96:111], a[144:147], a[92:95], v[96:111]
    v_add_u32_e32 v244, 0x8000, v244
    v_add_u32_e32 v243, 0x8000, v243
    s_nop 8
    ds_write_b128 v244, v[112:115] offset:0
    ds_write_b128 v244, v[116:119] offset:1024
    ds_write_b128 v244, v[120:123] offset:2048
    ds_write_b128 v244, v[124:127] offset:3072
    s_waitcnt lgkmcnt(0)
    s_barrier
    ds_read_b128 v[208:211], v243 offset:0
    ds_read_b128 v[212:215], v243 offset:1024
    ds_read_b128 v[216:219], v243 offset:2048
    ds_read_b128 v[220:223], v243 offset:3072
    s_waitcnt lgkmcnt(3)
    v_add_f32_e32 v96, v96, v208
    v_add_f32_e32 v97, v97, v209
    v_add_f32_e32 v98, v98, v210
    v_add_f32_e32 v99, v99, v211
    v_mul_f32_e32 v96, v96, v64
    v_mul_f32_e32 v97, v97, v65
    v_mul_f32_e32 v98, v98, v66
    v_mul_f32_e32 v99, v99, v67
    v_cvt_pk_bf16_f32 v200, v96, v97
    v_cvt_pk_bf16_f32 v201, v98, v99
    ds_write_b64 v224, v[200:201] offset:0
    s_waitcnt lgkmcnt(3)
    v_add_f32_e32 v100, v100, v212
    v_add_f32_e32 v101, v101, v213
    v_add_f32_e32 v102, v102, v214
    v_add_f32_e32 v103, v103, v215
    v_mul_f32_e32 v100, v100, v68
    v_mul_f32_e32 v101, v101, v69
    v_mul_f32_e32 v102, v102, v70
    v_mul_f32_e64 v103, v103, v71
    v_cvt_pk_bf16_f32 v202, v100, v101
    v_cvt_pk_bf16_f32 v203, v102, v103
    ds_write_b64 v225, v[202:203] offset:0
    s_waitcnt lgkmcnt(3)
    v_add_f32_e32 v104, v104, v216
    v_add_f32_e32 v105, v105, v217
    v_add_f32_e32 v106, v106, v218
    v_add_f32_e32 v107, v107, v219
    v_mul_f32_e32 v104, v104, v72
    v_mul_f32_e32 v105, v105, v73
    v_mul_f32_e32 v106, v106, v74
    v_mul_f32_e64 v107, v107, v75
    v_cvt_pk_bf16_f32 v204, v104, v105
    v_cvt_pk_bf16_f32 v205, v106, v107
    ds_write_b64 v226, v[204:205] offset:0
    s_waitcnt lgkmcnt(3)
    v_add_f32_e32 v108, v108, v220
    v_add_f32_e32 v109, v109, v221
    v_add_f32_e32 v110, v110, v222
    v_add_f32_e32 v111, v111, v223
    v_mul_f32_e32 v108, v108, v76
    v_mul_f32_e32 v109, v109, v77
    v_mul_f32_e32 v110, v110, v78
    v_mul_f32_e64 v111, v111, v79
    v_cvt_pk_bf16_f32 v206, v108, v109
    v_cvt_pk_bf16_f32 v207, v110, v111
    ds_write_b64 v227, v[206:207] offset:0
    s_waitcnt lgkmcnt(0)
    s_barrier
    ds_read_b128 v[208:211], v228 offset:0
    ds_read_b128 v[212:215], v229 offset:0
    s_waitcnt lgkmcnt(1)
    v_lshlrev_b32_e32 v20, 16, v208
    v_and_b32_e32 v21, 0xffff0000, v208
    v_add_f32_e32 v20, v20, v32
    v_add_f32_e32 v21, v21, v33
    v_cvt_pk_bf16_f32 v192, v20, v21
    v_lshlrev_b32_e64 v22, 16, v209
    v_and_b32_e32 v23, 0xffff0000, v209
    v_add_f32_e32 v22, v22, v34
    v_add_f32_e32 v23, v23, v35
    v_cvt_pk_bf16_f32 v193, v22, v23
    v_lshlrev_b32_e64 v20, 16, v210
    v_and_b32_e32 v21, 0xffff0000, v210
    v_add_f32_e32 v20, v20, v36
    v_add_f32_e32 v21, v21, v37
    v_cvt_pk_bf16_f32 v194, v20, v21
    v_lshlrev_b32_e64 v22, 16, v211
    v_and_b32_e32 v23, 0xffff0000, v211
    v_add_f32_e32 v22, v22, v38
    v_add_f32_e32 v23, v23, v39
    v_cvt_pk_bf16_f32 v195, v22, v23
    buffer_store_dwordx4 v[192:195], v245, s[48:51], s4 offen
    s_waitcnt lgkmcnt(0)
    v_lshlrev_b32_e32 v20, 16, v212
    v_and_b32_e32 v21, 0xffff0000, v212
    v_add_f32_e32 v20, v20, v40
    v_add_f32_e32 v21, v21, v41
    v_cvt_pk_bf16_f32 v196, v20, v21
    v_lshlrev_b32_e64 v22, 16, v213
    v_and_b32_e32 v23, 0xffff0000, v213
    v_add_f32_e32 v22, v22, v42
    v_add_f32_e32 v23, v23, v43
    v_cvt_pk_bf16_f32 v197, v22, v23
    v_lshlrev_b32_e64 v20, 16, v214
    v_and_b32_e32 v21, 0xffff0000, v214
    v_add_f32_e32 v20, v20, v44
    v_add_f32_e32 v21, v21, v45
    v_cvt_pk_bf16_f32 v198, v20, v21
    v_lshlrev_b32_e64 v22, 16, v215
    v_and_b32_e32 v23, 0xffff0000, v215
    v_add_f32_e32 v22, v22, v46
    v_add_f32_e32 v23, v23, v47
    v_cvt_pk_bf16_f32 v199, v22, v23
    buffer_store_dwordx4 v[196:199], v245, s[48:51], s5 offen
    s_endpgm
L_nslow_1:
    s_mov_b32 s91, 0
L_nspin_3:
    s_add_u32 s91, s91, 1
    s_cmp_gt_u32 s91, 0x8000
    s_cbranch_scc1 L_nback_2
    s_sleep 2
    buffer_load_dword v253, v254, s[52:55], 0 offen sc1
    s_waitcnt vmcnt(0)
    v_readfirstlane_b32 s67, v253
    s_nop 1
    s_cmp_eq_u32 s67, 0
    s_cbranch_scc1 L_nspin_3
    s_branch L_nback_2
L_slow_4:
    s_mov_b32 s91, 0
L_spin_6:
    s_add_u32 s91, s91, 1
    s_cmp_gt_u32 s91, 0x8000
    s_cbranch_scc1 L_back_5
    s_sleep 2
    v_and_b32_e32 v19, 0, v0
    v_lshlrev_b32_e64 v19, 2, v19
    buffer_load_dword v19, v19, s[44:47], s11 offen sc1
    s_waitcnt vmcnt(0)
    v_cmp_ne_u32 vcc, s67, v19
    s_nop 1
    s_cmp_lg_u64 vcc, 0
    s_cbranch_scc1 L_spin_6
    s_branch L_back_5
L_slow_7:
    s_mov_b32 s91, 0
L_spin_9:
    s_add_u32 s91, s91, 1
    s_cmp_gt_u32 s91, 0x8000
    s_cbranch_scc1 L_back_8
    s_sleep 2
    v_and_b32_e32 v19, 15, v0
    v_lshlrev_b32_e32 v19, 2, v19
    buffer_load_dword v19, v19, s[44:47], s11 offen sc1
    s_waitcnt vmcnt(0)
    v_cmp_ne_u32 vcc, s67, v19
    s_nop 1
    s_cmp_lg_u64 vcc, 0
    s_cbranch_scc1 L_spin_9
    s_branch L_back_8
L_slow_10:
    s_mov_b32 s91, 0
L_spin_12:
    s_add_u32 s91, s91, 1
    s_cmp_gt_u32 s91, 0x8000
    s_cbranch_scc1 L_back_11
    s_sleep 2
    v_and_b32_e32 v19, 31, v0
    v_lshlrev_b32_e32 v19, 2, v19
    buffer_load_dword v19, v19, s[44:47], s11 offen sc1
    s_waitcnt vmcnt(0)
    v_cmp_ne_u32 vcc, s67, v19
    s_nop 1
    s_cmp_lg_u64 vcc, 0
    s_cbranch_scc1 L_spin_12
    s_branch L_back_11
L_slow_13:
    s_mov_b32 s91, 0
L_spin_15:
    s_add_u32 s91, s91, 1
    s_cmp_gt_u32 s91, 0x8000
    s_cbranch_scc1 L_back_14
    s_sleep 2
    v_and_b32_e32 v19, 15, v0
    v_lshlrev_b32_e32 v19, 2, v19
    buffer_load_dword v19, v19, s[44:47], s11 offen sc1
    s_waitcnt vmcnt(0)
    v_cmp_ne_u32 vcc, s67, v19
    s_nop 1
    s_cmp_lg_u64 vcc, 0
    s_cbranch_scc1 L_spin_15
    s_branch L_back_14
L_slow_16:
    s_mov_b32 s91, 0
L_spin_18:
    s_add_u32 s91, s91, 1
    s_cmp_gt_u32 s91, 0x8000
    s_cbranch_scc1 L_back_17
    s_sleep 2
    v_and_b32_e32 v19, 15, v0
    v_lshlrev_b32_e32 v19, 2, v19
    buffer_load_dword v19, v19, s[44:47], s11 offen sc1
    s_waitcnt vmcnt(0)
    v_cmp_ne_u32 vcc, s67, v19
    s_nop 1
    s_cmp_lg_u64 vcc, 0
    s_cbranch_scc1 L_spin_18
    s_branch L_back_17
L_nslow_19:
    s_mov_b32 s91, 0
L_nspin_21:
    s_add_u32 s91, s91, 1
    s_cmp_gt_u32 s91, 0x8000
    s_cbranch_scc1 L_nback_20
    s_sleep 2
    buffer_load_dword v253, v254, s[52:55], 0 offen sc1
    s_waitcnt vmcnt(0)
    v_readfirstlane_b32 s67, v253
    s_nop 1
    s_cmp_eq_u32 s67, 0
    s_cbranch_scc1 L_nspin_21
    s_branch L_nback_20
L_slow_22:
    s_mov_b32 s91, 0
L_spin_24:
    s_add_u32 s91, s91, 1
    s_cmp_gt_u32 s91, 0x8000
    s_cbranch_scc1 L_back_23
    s_sleep 2
    v_and_b32_e32 v19, 15, v0
    v_lshlrev_b32_e32 v19, 2, v19
    buffer_load_dword v19, v19, s[44:47], s11 offen sc1
    s_waitcnt vmcnt(0)
    v_cmp_ne_u32 vcc, s67, v19
    s_nop 1
    s_cmp_lg_u64 vcc, 0
    s_cbranch_scc1 L_spin_24
    s_branch L_back_23
L_slow_25:
    s_mov_b32 s91, 0
L_spin_27:
    s_add_u32 s91, s91, 1
    s_cmp_gt_u32 s91, 0x8000
    s_cbranch_scc1 L_back_26
    s_sleep 2
    v_and_b32_e32 v19, 31, v0
    v_lshlrev_b32_e32 v19, 2, v19
    buffer_load_dword v19, v19, s[44:47], s11 offen sc1
    s_waitcnt vmcnt(0)
    v_cmp_ne_u32 vcc, s67, v19
    s_nop 1
    s_cmp_lg_u64 vcc, 0
    s_cbranch_scc1 L_spin_27
    s_branch L_back_26
L_slow_28:
    s_mov_b32 s91, 0
L_spin_30:
    s_add_u32 s91, s91, 1
    s_cmp_gt_u32 s91, 0x8000
    s_cbranch_scc1 L_back_29
    s_sleep 2
    v_and_b32_e32 v19, 15, v0
    v_lshlrev_b32_e32 v19, 2, v19
    buffer_load_dword v19, v19, s[44:47], s11 offen sc1
    s_waitcnt vmcnt(0)
    v_cmp_ne_u32 vcc, s67, v19
    s_nop 1
    s_cmp_lg_u64 vcc, 0
    s_cbranch_scc1 L_spin_30
    s_branch L_back_29
L_slow_31:
    s_mov_b32 s91, 0
L_spin_33:
    s_add_u32 s91, s91, 1
    s_cmp_gt_u32 s91, 0x8000
    s_cbranch_scc1 L_back_32
    s_sleep 2
    v_and_b32_e32 v19, 15, v0
    v_lshlrev_b32_e32 v19, 2, v19
    buffer_load_dword v19, v19, s[44:47], s11 offen sc1
    s_waitcnt vmcnt(0)
    v_cmp_ne_u32 vcc, s67, v19
    s_nop 1
    s_cmp_lg_u64 vcc, 0
    s_cbranch_scc1 L_spin_33
    s_branch L_back_32
L_end:
    s_endpgm
L_codeend:
.section .rodata,"a"
.p2align 6
.amdhsa_kernel recurrent_scan__sliding_local_dilated__glu_gated_geglu__prompt_kernel
  .amdhsa_next_free_vgpr 512
  .amdhsa_next_free_sgpr 102
  .amdhsa_accum_offset 256
  .amdhsa_group_segment_fixed_size 0
  .amdhsa_kernarg_size 80
  .amdhsa_user_sgpr_count 2
  .amdhsa_user_sgpr_kernarg_segment_ptr 1
  .amdhsa_system_sgpr_workgroup_id_x 1
.end_amdhsa_kernel
```
